```python
import torch

def _softmax(x, axis=-1):
    return torch.softmax(x, dim=axis)
def _gelu(x):
    return torch.nn.functional.gelu(x, approximate="tanh")
def _silu(x):
    return torch.nn.functional.silu(x)
def _sigmoid(x):
    return torch.sigmoid(x)
def _layernorm(x, axis=-1, eps=1e-5):
    m = x.mean(dim=axis, keepdim=True)
    v = x.var(dim=axis, keepdim=True, unbiased=False)
    return (x - m) / torch.sqrt(v + eps)
def _scatter_add(tgt, idx, src, axis=0):
    return tgt.clone().index_add_(axis, idx, src)
def _segment_sum(src, seg, n):
    out = torch.zeros((n,) + src.shape[1:], dtype=src.dtype)
    return out.index_add_(0, seg, src)
def _pad(x, pw):
    flat = tuple(v for pair in reversed(pw) for v in pair)
    return torch.nn.functional.pad(x, flat)

kernel_name = 'standalone__mha_block_cached__near_ridge'

def setup_inputs():

    _w = (lambda a: (lambda t: t.to(torch.bfloat16) if t.is_floating_point() else t)(torch.as_tensor(a)))
    B, Sq, D = 16, 128, 512
    H, Sk, Dh = 32, 1024, 128
    return {
        "x": _w((lambda *s: torch.randn(*s, dtype=torch.bfloat16) * 0.8)(B, Sq, D)),
        "k_cache": _w((lambda *s: torch.randn(*s, dtype=torch.bfloat16) * 0.8)(B, H, Sk, Dh)),
        "v_cache": _w((lambda *s: torch.randn(*s, dtype=torch.bfloat16) * 0.05)(B, H, Sk, Dh)),
        "wq": _w((lambda *s: torch.randn(*s, dtype=torch.bfloat16) * 0.8)(D, H * Dh) * (D ** -0.5)),
        "wo": _w((lambda *s: torch.randn(*s, dtype=torch.bfloat16) * 0.05)(H * Dh, D) * ((H * Dh) ** -0.5)),
    }

def reference(x, k_cache, v_cache, wq, wo):
    B, Sq, D = x.shape
    H, Dh = 32, 128
    q = (lambda x, *d: x.permute(*d))((x @ wq).reshape(B, Sq, H, Dh), 0, 2, 1, 3)
    scores = torch.einsum("bhqd,bhkd->bhqk", q, k_cache) * (Dh ** -0.5)
    p = _softmax(scores, axis=-1)
    o = torch.einsum("bhqk,bhkd->bhqd", p, v_cache)
    return (lambda x, *d: x.permute(*d))(o, 0, 2, 1, 3).reshape(B, Sq, H * Dh) @ wo
```

```asm
; @launch grid=(256,1,1) block=(512,1,1) lds=163840
.amdgcn_target "amdgcn-amd-amdhsa--gfx950"
.text
.globl standalone__mha_block_cached__near_ridge_kernel
.p2align 8
.type standalone__mha_block_cached__near_ridge_kernel,@function
standalone__mha_block_cached__near_ridge_kernel:
s_cmp_ge_u32 s2, 256
s_cbranch_scc1 L_end
s_load_dwordx16 s[48:63], s[0:1], 0
v_and_b32 v1, 63, v0
v_lshrrev_b32 v2, 6, v0
s_nop 0
v_readfirstlane_b32 s3, v2
v_lshrrev_b32 v16, 4, v1
v_and_b32 v17, 15, v1
v_lshlrev_b32 v18, 1, v16
v_xor_b32 v18, v18, v17
v_lshlrev_b32 v18, 4, v18
v_lshl_add_u32 v166, v16, 13, v18
v_xor_b32 v167, 128, v166
v_lshrrev_b32 v19, 3, v1
v_and_b32 v168, 7, v1
v_lshrrev_b32 v18, 1, v19
v_xor_b32 v18, v18, v168
v_lshlrev_b32 v18, 4, v18
v_lshl_add_u32 v168, v19, 10, v18
v_xor_b32 v169, 64, v168
s_and_b32 s4, s3, 3
s_lshl_b32 s5, s4, 12
s_lshr_b32 s6, s3, 2
s_bfe_u32 s32, s2, 0x10002
s_lshl_b32 s32, s32, 3
s_lshr_b32 s36, s2, 5
s_add_u32 s32, s32, s36
s_and_b32 s34, s2, 3
s_lshl_b32 s33, s34, 3
s_bfe_u32 s36, s2, 0x20003
s_lshl_b32 s36, s36, 1
s_add_u32 s33, s33, s36
s_lshl_b32 s43, s33, 8
s_lshl_b32 s36, s4, 17
s_add_u32 s43, s43, s36
s_lshl_b32 s42, s32, 17
s_lshl_b32 s36, s4, 15
s_add_u32 s42, s42, s36
s_mul_i32 s44, s6, 81920
s_add_u32 s44, s44, s5
s_lshl_b32 s45, s6, 11
s_add_u32 s45, s45, s5
s_lshl_b32 s46, s6, 8
s_add_u32 s46, s46, s43
s_lshl_b32 s65, s6, 14
s_add_u32 s65, s65, s42
s_lshr_b32 s36, s2, 3
s_and_b32 s37, s36, 15
s_lshl_b32 s38, s37, 15
s_lshl_b32 s39, s3, 19
s_add_u32 s38, s38, s39
s_lshl_b32 s39, s34, 11
s_add_u32 s38, s38, s39
s_lshl_b32 s37, s37, 16
s_lshl_b32 s39, s3, 7
s_add_u32 s37, s37, s39
s_and_b32 s39, s32, 8
s_lshl_b32 s39, s39, 17
s_add_u32 s37, s37, s39
v_lshlrev_b32 v28, 7, v17
v_lshl_add_u32 v28, v16, 13, v28
v_lshlrev_b32 v29, 10, v1
s_cmp_ge_u32 s36, 16
s_cselect_b32 s88, s37, s38
s_cselect_b64 vcc, -1, 0
v_cndmask_b32 v28, v28, v29, vcc
s_waitcnt lgkmcnt(0)
s_add_u32 s96, s62, 33619968
s_addc_u32 s97, s63, 0
s_load_dword s7, s[96:97], 0
s_mov_b32 s16, s48
s_and_b32 s17, s49, 0xffff
s_mov_b32 s18, 0x200000
s_mov_b32 s19, 0x20000
s_mov_b32 s20, s54
s_and_b32 s21, s55, 0xffff
s_mov_b32 s22, 0x400000
s_mov_b32 s23, 0x20000
s_cmp_lg_u64 vcc, 0
s_cselect_b32 s84, s16, s20
s_cselect_b32 s85, s17, s21
s_cselect_b32 s86, s18, s22
s_mov_b32 s87, 0x20000
s_sub_u32 s36, s3, 0
s_cmp_ge_u32 s36, 2
s_cbranch_scc1 L_tsa
buffer_load_dword v0, v28, s[84:87], s88 offen
L_tsa:
s_add_u32 m0, s44, 32768
s_add_u32 s37, s46, 0
buffer_load_dwordx4 v166, s[20:23], s37 offen lds
s_add_u32 m0, s44, 33792
s_add_u32 s37, s46, 32768
buffer_load_dwordx4 v166, s[20:23], s37 offen lds
s_add_u32 m0, s44, 34816
s_add_u32 s37, s46, 65536
buffer_load_dwordx4 v167, s[20:23], s37 offen lds
s_add_u32 m0, s44, 35840
s_add_u32 s37, s46, 98304
buffer_load_dwordx4 v167, s[20:23], s37 offen lds
s_add_u32 m0, s45, 65536
s_add_u32 s37, s65, 0
buffer_load_dwordx4 v168, s[16:19], s37 offen lds
s_add_u32 m0, s45, 66560
s_add_u32 s37, s65, 8192
buffer_load_dwordx4 v169, s[16:19], s37 offen lds
s_sub_u32 s36, s3, 2
s_cmp_ge_u32 s36, 2
s_cbranch_scc1 L_tsb
buffer_load_dword v0, v28, s[84:87], s88 offen
L_tsb:
s_add_u32 m0, s44, 49152
s_add_u32 s37, s46, 524288
buffer_load_dwordx4 v166, s[20:23], s37 offen lds
s_add_u32 m0, s44, 50176
s_add_u32 s37, s46, 557056
buffer_load_dwordx4 v166, s[20:23], s37 offen lds
s_add_u32 m0, s44, 51200
s_add_u32 s37, s46, 589824
buffer_load_dwordx4 v167, s[20:23], s37 offen lds
s_add_u32 m0, s44, 52224
s_add_u32 s37, s46, 622592
buffer_load_dwordx4 v167, s[20:23], s37 offen lds
s_add_u32 m0, s45, 147456
s_add_u32 s37, s65, 128
buffer_load_dwordx4 v168, s[16:19], s37 offen lds
s_add_u32 m0, s45, 148480
s_add_u32 s37, s65, 8320
buffer_load_dwordx4 v169, s[16:19], s37 offen lds
s_sub_u32 s36, s3, 4
s_cmp_ge_u32 s36, 4
s_cbranch_scc1 L_tsc
buffer_load_dword v0, v28, s[84:87], s88 offen
L_tsc:
s_cmp_lg_u32 s3, 7
s_cbranch_scc1 L_cp0_e
s_getpc_b64 s[92:93]
L_cp0_p:
s_sub_u32 s92, s92, L_cp0_p-standalone__mha_block_cached__near_ridge_kernel
s_subb_u32 s93, s93, 0
s_and_b32 s93, s93, 0xffff
s_mov_b32 s94, L_code_end-standalone__mha_block_cached__near_ridge_kernel
s_mov_b32 s95, 0x20000
s_lshr_b32 s36, s2, 3
s_lshl_b32 s36, s36, 7
v_lshlrev_b32 v31, 12, v1
s_mov_b64 exec, 0xffff
buffer_load_dword v30, v31, s[92:95], s36 offen
s_mov_b64 exec, -1
L_cp0_e:
s_mov_b32 s8, s50
s_and_b32 s9, s51, 0xffff
s_mov_b32 s10, 0x8000000
s_mov_b32 s11, 0x20000
s_mov_b32 s12, s52
s_and_b32 s13, s53, 0xffff
s_mov_b32 s14, 0x8000000
s_mov_b32 s15, 0x20000
v_and_b32 v18, 0x1fff, v166
v_lshl_add_u32 v164, v16, 8, v18
v_xor_b32 v165, 128, v164
v_lshl_add_u32 v170, v16, 10, v18
v_xor_b32 v171, 128, v170
s_lshl_b32 s36, s32, 5
s_add_u32 s36, s36, s33
s_lshl_b32 s40, s36, 18
s_add_u32 s40, s40, s5
s_add_u32 s41, s40, 0x40000
s_mov_b32 s24, s62
s_and_b32 s25, s63, 0xffff
s_mov_b32 s26, 0x2800000
s_mov_b32 s27, 0x20000
v_lshrrev_b32 v16, 4, v1
v_bfe_u32 v17, v1, 2, 3
v_and_b32 v19, 3, v1
v_lshlrev_b32 v19, 3, v19
v_lshl_add_u32 v19, v17, 5, v19
v_bfe_u32 v17, v1, 2, 2
v_lshl_add_u32 v19, v17, 8, v19
v_lshl_add_u32 v174, v16, 10, v19
v_lshlrev_b32 v20, 4, v1
v_and_b32 v17, 15, v1
s_waitcnt lgkmcnt(0)
s_add_u32 s7, s7, 1
s_cmp_ge_u32 s3, 4
s_cbranch_scc1 L_H
s_mov_b32 s98, 0x3e0293ee
s_mov_b32 s99, s98
s_mov_b32 s69, 0xffff8000
s_mov_b32 s70, 0x3f803f80
s_lshr_b32 s36, s4, 1
s_mul_i32 s36, s36, 81920
s_add_u32 s36, s36, 16384
v_lshl_add_u32 v19, v16, 11, v19
v_add_u32 v19, s36, v19
v_add_u32 v14, 81920, v174
v_xor_b32 v24, 0, v19
v_xor_b32 v6, 0, v14
v_xor_b32 v25, 32, v19
v_xor_b32 v7, 32, v14
v_xor_b32 v26, 64, v19
v_xor_b32 v8, 64, v14
v_xor_b32 v27, 96, v19
v_xor_b32 v9, 96, v14
v_xor_b32 v28, 128, v19
v_xor_b32 v10, 128, v14
v_xor_b32 v29, 160, v19
v_xor_b32 v11, 160, v14
v_xor_b32 v30, 192, v19
v_xor_b32 v12, 192, v14
v_xor_b32 v31, 224, v19
v_xor_b32 v13, 224, v14
v_xor_b32 v19, v16, v17
v_lshlrev_b32 v19, 4, v19
v_lshl_add_u32 v19, v17, 8, v19
v_xor_b32 v2, 0, v19
v_xor_b32 v3, 64, v19
v_xor_b32 v4, 128, v19
v_xor_b32 v5, 192, v19
v_lshrrev_b32 v19, 1, v17
v_xor_b32 v19, v19, v16
v_lshlrev_b32 v19, 4, v19
v_lshl_add_u32 v19, v17, 7, v19
s_and_b32 s36, s4, 1
s_lshl_b32 s36, s36, 13
s_add_u32 s36, s36, 65536
v_add_u32 v14, s36, v19
v_xor_b32 v15, 64, v14
v_add_u32 v21, 81920, v14
v_add_u32 v22, 81920, v15
s_mov_b32 s47, 0
s_mov_b32 s64, 0
s_mov_b32 s66, 99
v_lshrrev_b32 v19, 1, v16
v_lshlrev_b32 v19, 8, v19
v_lshl_add_u32 v19, v17, 4, v19
v_and_b32 v16, 1, v16
v_lshl_add_u32 v19, v16, 3, v19
s_and_b32 s38, s4, 1
s_lshl_b32 s38, s38, 1
s_add_u32 s38, s38, 0
s_cmp_ge_u32 s4, 2
s_cselect_b32 s39, s34, 0
s_xor_b32 s38, s38, s39
s_cmp_ge_u32 s4, 2
s_cselect_b32 s39, 16384, 0
s_add_u32 s39, s39, 49152
s_and_b32 s36, s38, 1
s_lshl_b32 s36, s36, 13
s_lshr_b32 s37, s38, 1
s_mul_i32 s37, s37, 81920
s_add_u32 s36, s36, s37
s_add_u32 s36, s36, s39
v_add_u32 v16, s36, v19
s_and_b32 s38, s4, 1
s_lshl_b32 s38, s38, 1
s_add_u32 s38, s38, 1
s_cmp_ge_u32 s4, 2
s_cselect_b32 s39, s34, 0
s_xor_b32 s38, s38, s39
s_cmp_ge_u32 s4, 2
s_cselect_b32 s39, 16384, 0
s_add_u32 s39, s39, 49152
s_and_b32 s36, s38, 1
s_lshl_b32 s36, s36, 13
s_lshr_b32 s37, s38, 1
s_mul_i32 s37, s37, 81920
s_add_u32 s36, s36, s37
s_add_u32 s36, s36, s39
v_add_u32 v17, s36, v19
v_mov_b32 v64, 0
v_mov_b32 v65, 0
v_mov_b32 v66, 0
v_mov_b32 v67, 0
v_mov_b32 v68, 0
v_mov_b32 v69, 0
v_mov_b32 v70, 0
v_mov_b32 v71, 0
v_mov_b32 v72, 0
v_mov_b32 v73, 0
v_mov_b32 v74, 0
v_mov_b32 v75, 0
v_mov_b32 v76, 0
v_mov_b32 v77, 0
v_mov_b32 v78, 0
v_mov_b32 v79, 0
v_mov_b32 v80, 0
v_mov_b32 v81, 0
v_mov_b32 v82, 0
v_mov_b32 v83, 0
v_mov_b32 v84, 0
v_mov_b32 v85, 0
v_mov_b32 v86, 0
v_mov_b32 v87, 0
v_mov_b32 v88, 0
v_mov_b32 v89, 0
v_mov_b32 v90, 0
v_mov_b32 v91, 0
v_mov_b32 v92, 0
v_mov_b32 v93, 0
v_mov_b32 v94, 0
v_mov_b32 v95, 0
v_mov_b32 v96, 0
v_mov_b32 v97, 0
v_mov_b32 v98, 0
v_mov_b32 v99, 0
v_mov_b32 v100, 0
v_mov_b32 v101, 0
v_mov_b32 v102, 0
v_mov_b32 v103, 0
v_mov_b32 v104, 0
v_mov_b32 v105, 0
v_mov_b32 v106, 0
v_mov_b32 v107, 0
v_mov_b32 v108, 0
v_mov_b32 v109, 0
v_mov_b32 v110, 0
v_mov_b32 v111, 0
v_mov_b32 v112, 0
v_mov_b32 v113, 0
v_mov_b32 v114, 0
v_mov_b32 v115, 0
v_mov_b32 v116, 0
v_mov_b32 v117, 0
v_mov_b32 v118, 0
v_mov_b32 v119, 0
v_mov_b32 v120, 0
v_mov_b32 v121, 0
v_mov_b32 v122, 0
v_mov_b32 v123, 0
v_mov_b32 v124, 0
v_mov_b32 v125, 0
v_mov_b32 v126, 0
v_mov_b32 v127, 0
v_mov_b32 v128, 0
v_mov_b32 v129, 0
v_mov_b32 v130, 0
v_mov_b32 v131, 0
v_mov_b32 v132, 0
v_mov_b32 v133, 0
v_mov_b32 v134, 0
v_mov_b32 v135, 0
v_mov_b32 v136, 0
v_mov_b32 v137, 0
v_mov_b32 v138, 0
v_mov_b32 v139, 0
v_mov_b32 v140, 0
v_mov_b32 v141, 0
v_mov_b32 v142, 0
v_mov_b32 v143, 0
v_mov_b32 v144, 0
v_mov_b32 v145, 0
v_mov_b32 v146, 0
v_mov_b32 v147, 0
v_mov_b32 v148, 0
v_mov_b32 v149, 0
v_mov_b32 v150, 0
v_mov_b32 v151, 0
v_mov_b32 v152, 0
v_mov_b32 v153, 0
v_mov_b32 v154, 0
v_mov_b32 v155, 0
v_mov_b32 v156, 0
v_mov_b32 v157, 0
v_mov_b32 v158, 0
v_mov_b32 v159, 0
v_mov_b32 v160, 0
v_mov_b32 v161, 0
v_mov_b32 v162, 0
v_mov_b32 v163, 0
v_mov_b32 v164, 0
v_mov_b32 v165, 0
v_mov_b32 v166, 0
v_mov_b32 v167, 0
v_mov_b32 v168, 0
v_mov_b32 v169, 0
v_mov_b32 v170, 0
v_mov_b32 v171, 0
v_mov_b32 v172, 0
v_mov_b32 v173, 0
v_mov_b32 v174, 0
v_mov_b32 v175, 0
v_mov_b32 v176, 0
v_mov_b32 v177, 0
v_mov_b32 v178, 0
v_mov_b32 v179, 0
v_mov_b32 v180, 0
v_mov_b32 v181, 0
v_mov_b32 v182, 0
v_mov_b32 v183, 0
v_mov_b32 v184, 0
v_mov_b32 v185, 0
v_mov_b32 v186, 0
v_mov_b32 v187, 0
v_mov_b32 v188, 0
v_mov_b32 v189, 0
v_mov_b32 v190, 0
v_mov_b32 v191, 0
s_waitcnt vmcnt(6)
s_barrier
ds_read_b128 v[32:35], v14 offset:0
ds_read_b128 v[36:39], v14 offset:2048
ds_read_b128 v[40:43], v14 offset:4096
ds_read_b128 v[44:47], v14 offset:6144
ds_read_b64_tr_b16 v[192:193], v24 offset:16384
ds_read_b64_tr_b16 v[194:195], v24 offset:17408
ds_read_b64_tr_b16 v[196:197], v25 offset:16384
ds_read_b64_tr_b16 v[198:199], v25 offset:17408
ds_read_b64_tr_b16 v[200:201], v26 offset:16384
ds_read_b64_tr_b16 v[202:203], v26 offset:17408
ds_read_b64_tr_b16 v[204:205], v27 offset:16384
ds_read_b64_tr_b16 v[206:207], v27 offset:17408
ds_read_b64_tr_b16 v[208:209], v28 offset:16384
ds_read_b64_tr_b16 v[210:211], v28 offset:17408
ds_read_b64_tr_b16 v[212:213], v29 offset:16384
ds_read_b64_tr_b16 v[214:215], v29 offset:17408
ds_read_b64_tr_b16 v[216:217], v30 offset:16384
ds_read_b64_tr_b16 v[218:219], v30 offset:17408
ds_read_b64_tr_b16 v[220:221], v31 offset:16384
ds_read_b64_tr_b16 v[222:223], v31 offset:17408
s_waitcnt lgkmcnt(8)
v_mfma_f32_16x16x32_bf16 v[64:67], v[192:195], v[32:35], v[64:67]
v_mfma_f32_16x16x32_bf16 v[68:71], v[192:195], v[36:39], v[68:71]
ds_read_b128 v[48:51], v15 offset:0
v_mfma_f32_16x16x32_bf16 v[72:75], v[192:195], v[40:43], v[72:75]
ds_read_b128 v[52:55], v15 offset:2048
v_mfma_f32_16x16x32_bf16 v[76:79], v[192:195], v[44:47], v[76:79]
ds_read_b128 v[56:59], v15 offset:4096
v_mfma_f32_16x16x32_bf16 v[80:83], v[196:199], v[32:35], v[80:83]
v_mfma_f32_16x16x32_bf16 v[84:87], v[196:199], v[36:39], v[84:87]
ds_read_b128 v[60:63], v15 offset:6144
v_mfma_f32_16x16x32_bf16 v[88:91], v[196:199], v[40:43], v[88:91]
ds_read_b64_tr_b16 v[224:225], v24 offset:24576
v_mfma_f32_16x16x32_bf16 v[92:95], v[196:199], v[44:47], v[92:95]
ds_read_b64_tr_b16 v[226:227], v24 offset:25600
v_mfma_f32_16x16x32_bf16 v[96:99], v[200:203], v[32:35], v[96:99]
v_mfma_f32_16x16x32_bf16 v[100:103], v[200:203], v[36:39], v[100:103]
ds_read_b64_tr_b16 v[228:229], v25 offset:24576
v_mfma_f32_16x16x32_bf16 v[104:107], v[200:203], v[40:43], v[104:107]
ds_read_b64_tr_b16 v[230:231], v25 offset:25600
v_mfma_f32_16x16x32_bf16 v[108:111], v[200:203], v[44:47], v[108:111]
ds_read_b64_tr_b16 v[232:233], v26 offset:24576
v_mfma_f32_16x16x32_bf16 v[112:115], v[204:207], v[32:35], v[112:115]
v_mfma_f32_16x16x32_bf16 v[116:119], v[204:207], v[36:39], v[116:119]
ds_read_b64_tr_b16 v[234:235], v26 offset:25600
v_mfma_f32_16x16x32_bf16 v[120:123], v[204:207], v[40:43], v[120:123]
ds_read_b64_tr_b16 v[236:237], v27 offset:24576
v_mfma_f32_16x16x32_bf16 v[124:127], v[204:207], v[44:47], v[124:127]
ds_read_b64_tr_b16 v[238:239], v27 offset:25600
s_waitcnt lgkmcnt(12)
v_mfma_f32_16x16x32_bf16 v[128:131], v[208:211], v[32:35], v[128:131]
v_mfma_f32_16x16x32_bf16 v[132:135], v[208:211], v[36:39], v[132:135]
ds_read_b64_tr_b16 v[240:241], v28 offset:24576
v_mfma_f32_16x16x32_bf16 v[136:139], v[208:211], v[40:43], v[136:139]
v_mfma_f32_16x16x32_bf16 v[140:143], v[208:211], v[44:47], v[140:143]
ds_read_b64_tr_b16 v[242:243], v28 offset:25600
v_mfma_f32_16x16x32_bf16 v[144:147], v[212:215], v[32:35], v[144:147]
v_mfma_f32_16x16x32_bf16 v[148:151], v[212:215], v[36:39], v[148:151]
ds_read_b64_tr_b16 v[244:245], v29 offset:24576
v_mfma_f32_16x16x32_bf16 v[152:155], v[212:215], v[40:43], v[152:155]
v_mfma_f32_16x16x32_bf16 v[156:159], v[212:215], v[44:47], v[156:159]
ds_read_b64_tr_b16 v[246:247], v29 offset:25600
v_mfma_f32_16x16x32_bf16 v[160:163], v[216:219], v[32:35], v[160:163]
v_mfma_f32_16x16x32_bf16 v[164:167], v[216:219], v[36:39], v[164:167]
ds_read_b64_tr_b16 v[248:249], v30 offset:24576
v_mfma_f32_16x16x32_bf16 v[168:171], v[216:219], v[40:43], v[168:171]
v_mfma_f32_16x16x32_bf16 v[172:175], v[216:219], v[44:47], v[172:175]
ds_read_b64_tr_b16 v[250:251], v30 offset:25600
v_mfma_f32_16x16x32_bf16 v[176:179], v[220:223], v[32:35], v[176:179]
v_mfma_f32_16x16x32_bf16 v[180:183], v[220:223], v[36:39], v[180:183]
ds_read_b64_tr_b16 v[252:253], v31 offset:24576
v_mfma_f32_16x16x32_bf16 v[184:187], v[220:223], v[40:43], v[184:187]
v_mfma_f32_16x16x32_bf16 v[188:191], v[220:223], v[44:47], v[188:191]
ds_read_b64_tr_b16 v[254:255], v31 offset:25600
s_waitcnt lgkmcnt(8)
v_mfma_f32_16x16x32_bf16 v[64:67], v[224:227], v[48:51], v[64:67]
v_mfma_f32_16x16x32_bf16 v[68:71], v[224:227], v[52:55], v[68:71]
v_mfma_f32_16x16x32_bf16 v[72:75], v[224:227], v[56:59], v[72:75]
v_mfma_f32_16x16x32_bf16 v[76:79], v[224:227], v[60:63], v[76:79]
s_waitcnt vmcnt(0)
s_waitcnt lgkmcnt(0)
s_barrier
v_mfma_f32_16x16x32_bf16 v[80:83], v[228:231], v[48:51], v[80:83]
ds_read_b128 v[32:35], v21 offset:0
v_mfma_f32_16x16x32_bf16 v[84:87], v[228:231], v[52:55], v[84:87]
ds_read_b128 v[36:39], v21 offset:2048
v_mfma_f32_16x16x32_bf16 v[88:91], v[228:231], v[56:59], v[88:91]
ds_read_b128 v[40:43], v21 offset:4096
v_mfma_f32_16x16x32_bf16 v[92:95], v[228:231], v[60:63], v[92:95]
ds_read_b128 v[44:47], v21 offset:6144
v_mfma_f32_16x16x32_bf16 v[96:99], v[232:235], v[48:51], v[96:99]
ds_read_b64_tr_b16 v[192:193], v24 offset:32768
v_mfma_f32_16x16x32_bf16 v[100:103], v[232:235], v[52:55], v[100:103]
ds_read_b64_tr_b16 v[194:195], v24 offset:33792
v_mfma_f32_16x16x32_bf16 v[104:107], v[232:235], v[56:59], v[104:107]
ds_read_b64_tr_b16 v[196:197], v25 offset:32768
v_mfma_f32_16x16x32_bf16 v[108:111], v[232:235], v[60:63], v[108:111]
ds_read_b64_tr_b16 v[198:199], v25 offset:33792
v_mfma_f32_16x16x32_bf16 v[112:115], v[236:239], v[48:51], v[112:115]
ds_read_b64_tr_b16 v[200:201], v26 offset:32768
v_mfma_f32_16x16x32_bf16 v[116:119], v[236:239], v[52:55], v[116:119]
ds_read_b64_tr_b16 v[202:203], v26 offset:33792
v_mfma_f32_16x16x32_bf16 v[120:123], v[236:239], v[56:59], v[120:123]
ds_read_b64_tr_b16 v[204:205], v27 offset:32768
v_mfma_f32_16x16x32_bf16 v[124:127], v[236:239], v[60:63], v[124:127]
ds_read_b64_tr_b16 v[206:207], v27 offset:33792
v_mfma_f32_16x16x32_bf16 v[128:131], v[240:243], v[48:51], v[128:131]
v_mfma_f32_16x16x32_bf16 v[132:135], v[240:243], v[52:55], v[132:135]
ds_read_b64_tr_b16 v[208:209], v28 offset:32768
v_mfma_f32_16x16x32_bf16 v[136:139], v[240:243], v[56:59], v[136:139]
v_mfma_f32_16x16x32_bf16 v[140:143], v[240:243], v[60:63], v[140:143]
ds_read_b64_tr_b16 v[210:211], v28 offset:33792
v_mfma_f32_16x16x32_bf16 v[144:147], v[244:247], v[48:51], v[144:147]
v_mfma_f32_16x16x32_bf16 v[148:151], v[244:247], v[52:55], v[148:151]
ds_read_b64_tr_b16 v[212:213], v29 offset:32768
v_mfma_f32_16x16x32_bf16 v[152:155], v[244:247], v[56:59], v[152:155]
v_mfma_f32_16x16x32_bf16 v[156:159], v[244:247], v[60:63], v[156:159]
ds_read_b64_tr_b16 v[214:215], v29 offset:33792
v_mfma_f32_16x16x32_bf16 v[160:163], v[248:251], v[48:51], v[160:163]
v_mfma_f32_16x16x32_bf16 v[164:167], v[248:251], v[52:55], v[164:167]
ds_read_b64_tr_b16 v[216:217], v30 offset:32768
v_mfma_f32_16x16x32_bf16 v[168:171], v[248:251], v[56:59], v[168:171]
v_mfma_f32_16x16x32_bf16 v[172:175], v[248:251], v[60:63], v[172:175]
ds_read_b64_tr_b16 v[218:219], v30 offset:33792
v_mfma_f32_16x16x32_bf16 v[176:179], v[252:255], v[48:51], v[176:179]
v_mfma_f32_16x16x32_bf16 v[180:183], v[252:255], v[52:55], v[180:183]
ds_read_b64_tr_b16 v[220:221], v31 offset:32768
v_mfma_f32_16x16x32_bf16 v[184:187], v[252:255], v[56:59], v[184:187]
v_mfma_f32_16x16x32_bf16 v[188:191], v[252:255], v[60:63], v[188:191]
ds_read_b64_tr_b16 v[222:223], v31 offset:33792
s_waitcnt lgkmcnt(8)
v_mfma_f32_16x16x32_bf16 v[64:67], v[192:195], v[32:35], v[64:67]
v_mfma_f32_16x16x32_bf16 v[68:71], v[192:195], v[36:39], v[68:71]
ds_read_b128 v[48:51], v22 offset:0
v_mfma_f32_16x16x32_bf16 v[72:75], v[192:195], v[40:43], v[72:75]
ds_read_b128 v[52:55], v22 offset:2048
v_mfma_f32_16x16x32_bf16 v[76:79], v[192:195], v[44:47], v[76:79]
ds_read_b128 v[56:59], v22 offset:4096
v_mfma_f32_16x16x32_bf16 v[80:83], v[196:199], v[32:35], v[80:83]
v_mfma_f32_16x16x32_bf16 v[84:87], v[196:199], v[36:39], v[84:87]
ds_read_b128 v[60:63], v22 offset:6144
v_mfma_f32_16x16x32_bf16 v[88:91], v[196:199], v[40:43], v[88:91]
ds_read_b64_tr_b16 v[224:225], v24 offset:40960
v_mfma_f32_16x16x32_bf16 v[92:95], v[196:199], v[44:47], v[92:95]
ds_read_b64_tr_b16 v[226:227], v24 offset:41984
v_mfma_f32_16x16x32_bf16 v[96:99], v[200:203], v[32:35], v[96:99]
v_mfma_f32_16x16x32_bf16 v[100:103], v[200:203], v[36:39], v[100:103]
ds_read_b64_tr_b16 v[228:229], v25 offset:40960
v_mfma_f32_16x16x32_bf16 v[104:107], v[200:203], v[40:43], v[104:107]
ds_read_b64_tr_b16 v[230:231], v25 offset:41984
v_mfma_f32_16x16x32_bf16 v[108:111], v[200:203], v[44:47], v[108:111]
ds_read_b64_tr_b16 v[232:233], v26 offset:40960
v_mfma_f32_16x16x32_bf16 v[112:115], v[204:207], v[32:35], v[112:115]
v_mfma_f32_16x16x32_bf16 v[116:119], v[204:207], v[36:39], v[116:119]
ds_read_b64_tr_b16 v[234:235], v26 offset:41984
v_mfma_f32_16x16x32_bf16 v[120:123], v[204:207], v[40:43], v[120:123]
ds_read_b64_tr_b16 v[236:237], v27 offset:40960
v_mfma_f32_16x16x32_bf16 v[124:127], v[204:207], v[44:47], v[124:127]
ds_read_b64_tr_b16 v[238:239], v27 offset:41984
s_waitcnt lgkmcnt(12)
v_mfma_f32_16x16x32_bf16 v[128:131], v[208:211], v[32:35], v[128:131]
v_mfma_f32_16x16x32_bf16 v[132:135], v[208:211], v[36:39], v[132:135]
ds_read_b64_tr_b16 v[240:241], v28 offset:40960
v_mfma_f32_16x16x32_bf16 v[136:139], v[208:211], v[40:43], v[136:139]
v_mfma_f32_16x16x32_bf16 v[140:143], v[208:211], v[44:47], v[140:143]
ds_read_b64_tr_b16 v[242:243], v28 offset:41984
v_mfma_f32_16x16x32_bf16 v[144:147], v[212:215], v[32:35], v[144:147]
v_mfma_f32_16x16x32_bf16 v[148:151], v[212:215], v[36:39], v[148:151]
ds_read_b64_tr_b16 v[244:245], v29 offset:40960
v_mfma_f32_16x16x32_bf16 v[152:155], v[212:215], v[40:43], v[152:155]
v_mfma_f32_16x16x32_bf16 v[156:159], v[212:215], v[44:47], v[156:159]
ds_read_b64_tr_b16 v[246:247], v29 offset:41984
v_mfma_f32_16x16x32_bf16 v[160:163], v[216:219], v[32:35], v[160:163]
v_mfma_f32_16x16x32_bf16 v[164:167], v[216:219], v[36:39], v[164:167]
ds_read_b64_tr_b16 v[248:249], v30 offset:40960
v_mfma_f32_16x16x32_bf16 v[168:171], v[216:219], v[40:43], v[168:171]
v_mfma_f32_16x16x32_bf16 v[172:175], v[216:219], v[44:47], v[172:175]
ds_read_b64_tr_b16 v[250:251], v30 offset:41984
v_mfma_f32_16x16x32_bf16 v[176:179], v[220:223], v[32:35], v[176:179]
v_mfma_f32_16x16x32_bf16 v[180:183], v[220:223], v[36:39], v[180:183]
ds_read_b64_tr_b16 v[252:253], v31 offset:40960
v_mfma_f32_16x16x32_bf16 v[184:187], v[220:223], v[40:43], v[184:187]
v_mfma_f32_16x16x32_bf16 v[188:191], v[220:223], v[44:47], v[188:191]
ds_read_b64_tr_b16 v[254:255], v31 offset:41984
s_waitcnt lgkmcnt(8)
v_mfma_f32_16x16x32_bf16 v[64:67], v[224:227], v[48:51], v[64:67]
v_mfma_f32_16x16x32_bf16 v[68:71], v[224:227], v[52:55], v[68:71]
v_mfma_f32_16x16x32_bf16 v[72:75], v[224:227], v[56:59], v[72:75]
v_mfma_f32_16x16x32_bf16 v[76:79], v[224:227], v[60:63], v[76:79]
s_waitcnt lgkmcnt(0)
s_barrier
v_mfma_f32_16x16x32_bf16 v[80:83], v[228:231], v[48:51], v[80:83]
ds_read_b128 v[32:35], v14 offset:16384
v_mfma_f32_16x16x32_bf16 v[84:87], v[228:231], v[52:55], v[84:87]
ds_read_b128 v[36:39], v14 offset:18432
v_mfma_f32_16x16x32_bf16 v[88:91], v[228:231], v[56:59], v[88:91]
ds_read_b128 v[40:43], v14 offset:20480
v_mfma_f32_16x16x32_bf16 v[92:95], v[228:231], v[60:63], v[92:95]
ds_read_b128 v[44:47], v14 offset:22528
v_mfma_f32_16x16x32_bf16 v[96:99], v[232:235], v[48:51], v[96:99]
ds_read_b64_tr_b16 v[192:193], v24 offset:0
v_mfma_f32_16x16x32_bf16 v[100:103], v[232:235], v[52:55], v[100:103]
ds_read_b64_tr_b16 v[194:195], v24 offset:1024
v_mfma_f32_16x16x32_bf16 v[104:107], v[232:235], v[56:59], v[104:107]
ds_read_b64_tr_b16 v[196:197], v25 offset:0
v_mfma_f32_16x16x32_bf16 v[108:111], v[232:235], v[60:63], v[108:111]
ds_read_b64_tr_b16 v[198:199], v25 offset:1024
v_mfma_f32_16x16x32_bf16 v[112:115], v[236:239], v[48:51], v[112:115]
ds_read_b64_tr_b16 v[200:201], v26 offset:0
v_mfma_f32_16x16x32_bf16 v[116:119], v[236:239], v[52:55], v[116:119]
ds_read_b64_tr_b16 v[202:203], v26 offset:1024
v_mfma_f32_16x16x32_bf16 v[120:123], v[236:239], v[56:59], v[120:123]
ds_read_b64_tr_b16 v[204:205], v27 offset:0
v_mfma_f32_16x16x32_bf16 v[124:127], v[236:239], v[60:63], v[124:127]
ds_read_b64_tr_b16 v[206:207], v27 offset:1024
v_mfma_f32_16x16x32_bf16 v[128:131], v[240:243], v[48:51], v[128:131]
v_mfma_f32_16x16x32_bf16 v[132:135], v[240:243], v[52:55], v[132:135]
ds_read_b64_tr_b16 v[208:209], v28 offset:0
v_mfma_f32_16x16x32_bf16 v[136:139], v[240:243], v[56:59], v[136:139]
v_mfma_f32_16x16x32_bf16 v[140:143], v[240:243], v[60:63], v[140:143]
ds_read_b64_tr_b16 v[210:211], v28 offset:1024
v_mfma_f32_16x16x32_bf16 v[144:147], v[244:247], v[48:51], v[144:147]
v_mfma_f32_16x16x32_bf16 v[148:151], v[244:247], v[52:55], v[148:151]
ds_read_b64_tr_b16 v[212:213], v29 offset:0
v_mfma_f32_16x16x32_bf16 v[152:155], v[244:247], v[56:59], v[152:155]
v_mfma_f32_16x16x32_bf16 v[156:159], v[244:247], v[60:63], v[156:159]
ds_read_b64_tr_b16 v[214:215], v29 offset:1024
v_mfma_f32_16x16x32_bf16 v[160:163], v[248:251], v[48:51], v[160:163]
v_mfma_f32_16x16x32_bf16 v[164:167], v[248:251], v[52:55], v[164:167]
ds_read_b64_tr_b16 v[216:217], v30 offset:0
v_mfma_f32_16x16x32_bf16 v[168:171], v[248:251], v[56:59], v[168:171]
v_mfma_f32_16x16x32_bf16 v[172:175], v[248:251], v[60:63], v[172:175]
ds_read_b64_tr_b16 v[218:219], v30 offset:1024
v_mfma_f32_16x16x32_bf16 v[176:179], v[252:255], v[48:51], v[176:179]
v_mfma_f32_16x16x32_bf16 v[180:183], v[252:255], v[52:55], v[180:183]
ds_read_b64_tr_b16 v[220:221], v31 offset:0
v_mfma_f32_16x16x32_bf16 v[184:187], v[252:255], v[56:59], v[184:187]
v_mfma_f32_16x16x32_bf16 v[188:191], v[252:255], v[60:63], v[188:191]
ds_read_b64_tr_b16 v[222:223], v31 offset:1024
s_waitcnt lgkmcnt(8)
v_mfma_f32_16x16x32_bf16 v[64:67], v[192:195], v[32:35], v[64:67]
v_mfma_f32_16x16x32_bf16 v[68:71], v[192:195], v[36:39], v[68:71]
ds_read_b128 v[48:51], v15 offset:16384
v_mfma_f32_16x16x32_bf16 v[72:75], v[192:195], v[40:43], v[72:75]
ds_read_b128 v[52:55], v15 offset:18432
v_mfma_f32_16x16x32_bf16 v[76:79], v[192:195], v[44:47], v[76:79]
ds_read_b128 v[56:59], v15 offset:20480
v_mfma_f32_16x16x32_bf16 v[80:83], v[196:199], v[32:35], v[80:83]
v_mfma_f32_16x16x32_bf16 v[84:87], v[196:199], v[36:39], v[84:87]
ds_read_b128 v[60:63], v15 offset:22528
v_mfma_f32_16x16x32_bf16 v[88:91], v[196:199], v[40:43], v[88:91]
ds_read_b64_tr_b16 v[224:225], v24 offset:8192
v_mfma_f32_16x16x32_bf16 v[92:95], v[196:199], v[44:47], v[92:95]
ds_read_b64_tr_b16 v[226:227], v24 offset:9216
v_mfma_f32_16x16x32_bf16 v[96:99], v[200:203], v[32:35], v[96:99]
v_mfma_f32_16x16x32_bf16 v[100:103], v[200:203], v[36:39], v[100:103]
ds_read_b64_tr_b16 v[228:229], v25 offset:8192
v_mfma_f32_16x16x32_bf16 v[104:107], v[200:203], v[40:43], v[104:107]
ds_read_b64_tr_b16 v[230:231], v25 offset:9216
v_mfma_f32_16x16x32_bf16 v[108:111], v[200:203], v[44:47], v[108:111]
ds_read_b64_tr_b16 v[232:233], v26 offset:8192
v_mfma_f32_16x16x32_bf16 v[112:115], v[204:207], v[32:35], v[112:115]
v_mfma_f32_16x16x32_bf16 v[116:119], v[204:207], v[36:39], v[116:119]
ds_read_b64_tr_b16 v[234:235], v26 offset:9216
v_mfma_f32_16x16x32_bf16 v[120:123], v[204:207], v[40:43], v[120:123]
ds_read_b64_tr_b16 v[236:237], v27 offset:8192
v_mfma_f32_16x16x32_bf16 v[124:127], v[204:207], v[44:47], v[124:127]
ds_read_b64_tr_b16 v[238:239], v27 offset:9216
s_waitcnt lgkmcnt(12)
v_mfma_f32_16x16x32_bf16 v[128:131], v[208:211], v[32:35], v[128:131]
v_mfma_f32_16x16x32_bf16 v[132:135], v[208:211], v[36:39], v[132:135]
ds_read_b64_tr_b16 v[240:241], v28 offset:8192
v_mfma_f32_16x16x32_bf16 v[136:139], v[208:211], v[40:43], v[136:139]
v_mfma_f32_16x16x32_bf16 v[140:143], v[208:211], v[44:47], v[140:143]
ds_read_b64_tr_b16 v[242:243], v28 offset:9216
v_mfma_f32_16x16x32_bf16 v[144:147], v[212:215], v[32:35], v[144:147]
v_mfma_f32_16x16x32_bf16 v[148:151], v[212:215], v[36:39], v[148:151]
ds_read_b64_tr_b16 v[244:245], v29 offset:8192
v_mfma_f32_16x16x32_bf16 v[152:155], v[212:215], v[40:43], v[152:155]
v_mfma_f32_16x16x32_bf16 v[156:159], v[212:215], v[44:47], v[156:159]
ds_read_b64_tr_b16 v[246:247], v29 offset:9216
v_mfma_f32_16x16x32_bf16 v[160:163], v[216:219], v[32:35], v[160:163]
v_mfma_f32_16x16x32_bf16 v[164:167], v[216:219], v[36:39], v[164:167]
ds_read_b64_tr_b16 v[248:249], v30 offset:8192
v_mfma_f32_16x16x32_bf16 v[168:171], v[216:219], v[40:43], v[168:171]
v_mfma_f32_16x16x32_bf16 v[172:175], v[216:219], v[44:47], v[172:175]
ds_read_b64_tr_b16 v[250:251], v30 offset:9216
v_mfma_f32_16x16x32_bf16 v[176:179], v[220:223], v[32:35], v[176:179]
v_mfma_f32_16x16x32_bf16 v[180:183], v[220:223], v[36:39], v[180:183]
ds_read_b64_tr_b16 v[252:253], v31 offset:8192
v_mfma_f32_16x16x32_bf16 v[184:187], v[220:223], v[40:43], v[184:187]
v_mfma_f32_16x16x32_bf16 v[188:191], v[220:223], v[44:47], v[188:191]
ds_read_b64_tr_b16 v[254:255], v31 offset:9216
s_waitcnt lgkmcnt(8)
v_mfma_f32_16x16x32_bf16 v[64:67], v[224:227], v[48:51], v[64:67]
v_mfma_f32_16x16x32_bf16 v[68:71], v[224:227], v[52:55], v[68:71]
v_mfma_f32_16x16x32_bf16 v[72:75], v[224:227], v[56:59], v[72:75]
v_mfma_f32_16x16x32_bf16 v[76:79], v[224:227], v[60:63], v[76:79]
s_waitcnt lgkmcnt(0)
s_barrier
v_mfma_f32_16x16x32_bf16 v[80:83], v[228:231], v[48:51], v[80:83]
ds_read_b128 v[32:35], v14 offset:0
v_mfma_f32_16x16x32_bf16 v[84:87], v[228:231], v[52:55], v[84:87]
ds_read_b128 v[36:39], v14 offset:2048
v_mfma_f32_16x16x32_bf16 v[88:91], v[228:231], v[56:59], v[88:91]
ds_read_b128 v[40:43], v14 offset:4096
v_mfma_f32_16x16x32_bf16 v[92:95], v[228:231], v[60:63], v[92:95]
ds_read_b128 v[44:47], v14 offset:6144
v_mfma_f32_16x16x32_bf16 v[96:99], v[232:235], v[48:51], v[96:99]
ds_read_b64_tr_b16 v[192:193], v24 offset:16384
v_mfma_f32_16x16x32_bf16 v[100:103], v[232:235], v[52:55], v[100:103]
ds_read_b64_tr_b16 v[194:195], v24 offset:17408
v_mfma_f32_16x16x32_bf16 v[104:107], v[232:235], v[56:59], v[104:107]
ds_read_b64_tr_b16 v[196:197], v25 offset:16384
v_mfma_f32_16x16x32_bf16 v[108:111], v[232:235], v[60:63], v[108:111]
ds_read_b64_tr_b16 v[198:199], v25 offset:17408
v_mfma_f32_16x16x32_bf16 v[112:115], v[236:239], v[48:51], v[112:115]
ds_read_b64_tr_b16 v[200:201], v26 offset:16384
v_mfma_f32_16x16x32_bf16 v[116:119], v[236:239], v[52:55], v[116:119]
ds_read_b64_tr_b16 v[202:203], v26 offset:17408
v_mfma_f32_16x16x32_bf16 v[120:123], v[236:239], v[56:59], v[120:123]
ds_read_b64_tr_b16 v[204:205], v27 offset:16384
v_mfma_f32_16x16x32_bf16 v[124:127], v[236:239], v[60:63], v[124:127]
ds_read_b64_tr_b16 v[206:207], v27 offset:17408
v_mfma_f32_16x16x32_bf16 v[128:131], v[240:243], v[48:51], v[128:131]
v_mfma_f32_16x16x32_bf16 v[132:135], v[240:243], v[52:55], v[132:135]
ds_read_b64_tr_b16 v[208:209], v28 offset:16384
v_mfma_f32_16x16x32_bf16 v[136:139], v[240:243], v[56:59], v[136:139]
v_mfma_f32_16x16x32_bf16 v[140:143], v[240:243], v[60:63], v[140:143]
ds_read_b64_tr_b16 v[210:211], v28 offset:17408
v_mfma_f32_16x16x32_bf16 v[144:147], v[244:247], v[48:51], v[144:147]
v_mfma_f32_16x16x32_bf16 v[148:151], v[244:247], v[52:55], v[148:151]
ds_read_b64_tr_b16 v[212:213], v29 offset:16384
v_mfma_f32_16x16x32_bf16 v[152:155], v[244:247], v[56:59], v[152:155]
v_mfma_f32_16x16x32_bf16 v[156:159], v[244:247], v[60:63], v[156:159]
ds_read_b64_tr_b16 v[214:215], v29 offset:17408
v_mfma_f32_16x16x32_bf16 v[160:163], v[248:251], v[48:51], v[160:163]
v_mfma_f32_16x16x32_bf16 v[164:167], v[248:251], v[52:55], v[164:167]
ds_read_b64_tr_b16 v[216:217], v30 offset:16384
v_mfma_f32_16x16x32_bf16 v[168:171], v[248:251], v[56:59], v[168:171]
v_mfma_f32_16x16x32_bf16 v[172:175], v[248:251], v[60:63], v[172:175]
ds_read_b64_tr_b16 v[218:219], v30 offset:17408
v_mfma_f32_16x16x32_bf16 v[176:179], v[252:255], v[48:51], v[176:179]
v_mfma_f32_16x16x32_bf16 v[180:183], v[252:255], v[52:55], v[180:183]
ds_read_b64_tr_b16 v[220:221], v31 offset:16384
v_mfma_f32_16x16x32_bf16 v[184:187], v[252:255], v[56:59], v[184:187]
v_mfma_f32_16x16x32_bf16 v[188:191], v[252:255], v[60:63], v[188:191]
ds_read_b64_tr_b16 v[222:223], v31 offset:17408
s_waitcnt lgkmcnt(8)
v_mfma_f32_16x16x32_bf16 v[64:67], v[192:195], v[32:35], v[64:67]
v_mfma_f32_16x16x32_bf16 v[68:71], v[192:195], v[36:39], v[68:71]
ds_read_b128 v[48:51], v15 offset:0
v_mfma_f32_16x16x32_bf16 v[72:75], v[192:195], v[40:43], v[72:75]
ds_read_b128 v[52:55], v15 offset:2048
v_mfma_f32_16x16x32_bf16 v[76:79], v[192:195], v[44:47], v[76:79]
ds_read_b128 v[56:59], v15 offset:4096
v_mfma_f32_16x16x32_bf16 v[80:83], v[196:199], v[32:35], v[80:83]
v_mfma_f32_16x16x32_bf16 v[84:87], v[196:199], v[36:39], v[84:87]
ds_read_b128 v[60:63], v15 offset:6144
v_mfma_f32_16x16x32_bf16 v[88:91], v[196:199], v[40:43], v[88:91]
ds_read_b64_tr_b16 v[224:225], v24 offset:24576
v_mfma_f32_16x16x32_bf16 v[92:95], v[196:199], v[44:47], v[92:95]
ds_read_b64_tr_b16 v[226:227], v24 offset:25600
v_mfma_f32_16x16x32_bf16 v[96:99], v[200:203], v[32:35], v[96:99]
v_mfma_f32_16x16x32_bf16 v[100:103], v[200:203], v[36:39], v[100:103]
ds_read_b64_tr_b16 v[228:229], v25 offset:24576
v_mfma_f32_16x16x32_bf16 v[104:107], v[200:203], v[40:43], v[104:107]
ds_read_b64_tr_b16 v[230:231], v25 offset:25600
v_mfma_f32_16x16x32_bf16 v[108:111], v[200:203], v[44:47], v[108:111]
ds_read_b64_tr_b16 v[232:233], v26 offset:24576
v_mfma_f32_16x16x32_bf16 v[112:115], v[204:207], v[32:35], v[112:115]
v_mfma_f32_16x16x32_bf16 v[116:119], v[204:207], v[36:39], v[116:119]
ds_read_b64_tr_b16 v[234:235], v26 offset:25600
v_mfma_f32_16x16x32_bf16 v[120:123], v[204:207], v[40:43], v[120:123]
ds_read_b64_tr_b16 v[236:237], v27 offset:24576
v_mfma_f32_16x16x32_bf16 v[124:127], v[204:207], v[44:47], v[124:127]
ds_read_b64_tr_b16 v[238:239], v27 offset:25600
s_waitcnt lgkmcnt(12)
v_mfma_f32_16x16x32_bf16 v[128:131], v[208:211], v[32:35], v[128:131]
v_mfma_f32_16x16x32_bf16 v[132:135], v[208:211], v[36:39], v[132:135]
ds_read_b64_tr_b16 v[240:241], v28 offset:24576
v_mfma_f32_16x16x32_bf16 v[136:139], v[208:211], v[40:43], v[136:139]
v_mfma_f32_16x16x32_bf16 v[140:143], v[208:211], v[44:47], v[140:143]
ds_read_b64_tr_b16 v[242:243], v28 offset:25600
v_mfma_f32_16x16x32_bf16 v[144:147], v[212:215], v[32:35], v[144:147]
v_mfma_f32_16x16x32_bf16 v[148:151], v[212:215], v[36:39], v[148:151]
ds_read_b64_tr_b16 v[244:245], v29 offset:24576
v_mfma_f32_16x16x32_bf16 v[152:155], v[212:215], v[40:43], v[152:155]
v_mfma_f32_16x16x32_bf16 v[156:159], v[212:215], v[44:47], v[156:159]
ds_read_b64_tr_b16 v[246:247], v29 offset:25600
v_mfma_f32_16x16x32_bf16 v[160:163], v[216:219], v[32:35], v[160:163]
v_mfma_f32_16x16x32_bf16 v[164:167], v[216:219], v[36:39], v[164:167]
ds_read_b64_tr_b16 v[248:249], v30 offset:24576
v_mfma_f32_16x16x32_bf16 v[168:171], v[216:219], v[40:43], v[168:171]
v_mfma_f32_16x16x32_bf16 v[172:175], v[216:219], v[44:47], v[172:175]
ds_read_b64_tr_b16 v[250:251], v30 offset:25600
v_mfma_f32_16x16x32_bf16 v[176:179], v[220:223], v[32:35], v[176:179]
v_mfma_f32_16x16x32_bf16 v[180:183], v[220:223], v[36:39], v[180:183]
ds_read_b64_tr_b16 v[252:253], v31 offset:24576
v_mfma_f32_16x16x32_bf16 v[184:187], v[220:223], v[40:43], v[184:187]
v_mfma_f32_16x16x32_bf16 v[188:191], v[220:223], v[44:47], v[188:191]
ds_read_b64_tr_b16 v[254:255], v31 offset:25600
s_waitcnt lgkmcnt(8)
v_mfma_f32_16x16x32_bf16 v[64:67], v[224:227], v[48:51], v[64:67]
v_mfma_f32_16x16x32_bf16 v[68:71], v[224:227], v[52:55], v[68:71]
v_mfma_f32_16x16x32_bf16 v[72:75], v[224:227], v[56:59], v[72:75]
v_mfma_f32_16x16x32_bf16 v[76:79], v[224:227], v[60:63], v[76:79]
s_waitcnt lgkmcnt(0)
s_barrier
v_mfma_f32_16x16x32_bf16 v[80:83], v[228:231], v[48:51], v[80:83]
ds_read_b128 v[32:35], v21 offset:0
v_mfma_f32_16x16x32_bf16 v[84:87], v[228:231], v[52:55], v[84:87]
ds_read_b128 v[36:39], v21 offset:2048
v_mfma_f32_16x16x32_bf16 v[88:91], v[228:231], v[56:59], v[88:91]
ds_read_b128 v[40:43], v21 offset:4096
v_mfma_f32_16x16x32_bf16 v[92:95], v[228:231], v[60:63], v[92:95]
ds_read_b128 v[44:47], v21 offset:6144
v_mfma_f32_16x16x32_bf16 v[96:99], v[232:235], v[48:51], v[96:99]
ds_read_b64_tr_b16 v[192:193], v24 offset:32768
v_mfma_f32_16x16x32_bf16 v[100:103], v[232:235], v[52:55], v[100:103]
ds_read_b64_tr_b16 v[194:195], v24 offset:33792
v_mfma_f32_16x16x32_bf16 v[104:107], v[232:235], v[56:59], v[104:107]
ds_read_b64_tr_b16 v[196:197], v25 offset:32768
v_mfma_f32_16x16x32_bf16 v[108:111], v[232:235], v[60:63], v[108:111]
ds_read_b64_tr_b16 v[198:199], v25 offset:33792
v_mfma_f32_16x16x32_bf16 v[112:115], v[236:239], v[48:51], v[112:115]
ds_read_b64_tr_b16 v[200:201], v26 offset:32768
v_mfma_f32_16x16x32_bf16 v[116:119], v[236:239], v[52:55], v[116:119]
ds_read_b64_tr_b16 v[202:203], v26 offset:33792
v_mfma_f32_16x16x32_bf16 v[120:123], v[236:239], v[56:59], v[120:123]
ds_read_b64_tr_b16 v[204:205], v27 offset:32768
v_mfma_f32_16x16x32_bf16 v[124:127], v[236:239], v[60:63], v[124:127]
ds_read_b64_tr_b16 v[206:207], v27 offset:33792
v_mfma_f32_16x16x32_bf16 v[128:131], v[240:243], v[48:51], v[128:131]
v_mfma_f32_16x16x32_bf16 v[132:135], v[240:243], v[52:55], v[132:135]
ds_read_b64_tr_b16 v[208:209], v28 offset:32768
v_mfma_f32_16x16x32_bf16 v[136:139], v[240:243], v[56:59], v[136:139]
v_mfma_f32_16x16x32_bf16 v[140:143], v[240:243], v[60:63], v[140:143]
ds_read_b64_tr_b16 v[210:211], v28 offset:33792
v_mfma_f32_16x16x32_bf16 v[144:147], v[244:247], v[48:51], v[144:147]
v_mfma_f32_16x16x32_bf16 v[148:151], v[244:247], v[52:55], v[148:151]
ds_read_b64_tr_b16 v[212:213], v29 offset:32768
v_mfma_f32_16x16x32_bf16 v[152:155], v[244:247], v[56:59], v[152:155]
v_mfma_f32_16x16x32_bf16 v[156:159], v[244:247], v[60:63], v[156:159]
ds_read_b64_tr_b16 v[214:215], v29 offset:33792
v_mfma_f32_16x16x32_bf16 v[160:163], v[248:251], v[48:51], v[160:163]
v_mfma_f32_16x16x32_bf16 v[164:167], v[248:251], v[52:55], v[164:167]
ds_read_b64_tr_b16 v[216:217], v30 offset:32768
v_mfma_f32_16x16x32_bf16 v[168:171], v[248:251], v[56:59], v[168:171]
v_mfma_f32_16x16x32_bf16 v[172:175], v[248:251], v[60:63], v[172:175]
ds_read_b64_tr_b16 v[218:219], v30 offset:33792
v_mfma_f32_16x16x32_bf16 v[176:179], v[252:255], v[48:51], v[176:179]
v_mfma_f32_16x16x32_bf16 v[180:183], v[252:255], v[52:55], v[180:183]
ds_read_b64_tr_b16 v[220:221], v31 offset:32768
v_mfma_f32_16x16x32_bf16 v[184:187], v[252:255], v[56:59], v[184:187]
v_mfma_f32_16x16x32_bf16 v[188:191], v[252:255], v[60:63], v[188:191]
ds_read_b64_tr_b16 v[222:223], v31 offset:33792
s_waitcnt lgkmcnt(8)
v_mfma_f32_16x16x32_bf16 v[64:67], v[192:195], v[32:35], v[64:67]
v_mfma_f32_16x16x32_bf16 v[68:71], v[192:195], v[36:39], v[68:71]
ds_read_b128 v[48:51], v22 offset:0
v_mfma_f32_16x16x32_bf16 v[72:75], v[192:195], v[40:43], v[72:75]
ds_read_b128 v[52:55], v22 offset:2048
v_mfma_f32_16x16x32_bf16 v[76:79], v[192:195], v[44:47], v[76:79]
ds_read_b128 v[56:59], v22 offset:4096
v_mfma_f32_16x16x32_bf16 v[80:83], v[196:199], v[32:35], v[80:83]
v_mfma_f32_16x16x32_bf16 v[84:87], v[196:199], v[36:39], v[84:87]
ds_read_b128 v[60:63], v22 offset:6144
v_mfma_f32_16x16x32_bf16 v[88:91], v[196:199], v[40:43], v[88:91]
ds_read_b64_tr_b16 v[224:225], v24 offset:40960
v_mfma_f32_16x16x32_bf16 v[92:95], v[196:199], v[44:47], v[92:95]
ds_read_b64_tr_b16 v[226:227], v24 offset:41984
v_mfma_f32_16x16x32_bf16 v[96:99], v[200:203], v[32:35], v[96:99]
v_mfma_f32_16x16x32_bf16 v[100:103], v[200:203], v[36:39], v[100:103]
ds_read_b64_tr_b16 v[228:229], v25 offset:40960
v_mfma_f32_16x16x32_bf16 v[104:107], v[200:203], v[40:43], v[104:107]
ds_read_b64_tr_b16 v[230:231], v25 offset:41984
v_mfma_f32_16x16x32_bf16 v[108:111], v[200:203], v[44:47], v[108:111]
ds_read_b64_tr_b16 v[232:233], v26 offset:40960
v_mfma_f32_16x16x32_bf16 v[112:115], v[204:207], v[32:35], v[112:115]
v_mfma_f32_16x16x32_bf16 v[116:119], v[204:207], v[36:39], v[116:119]
ds_read_b64_tr_b16 v[234:235], v26 offset:41984
v_mfma_f32_16x16x32_bf16 v[120:123], v[204:207], v[40:43], v[120:123]
ds_read_b64_tr_b16 v[236:237], v27 offset:40960
v_mfma_f32_16x16x32_bf16 v[124:127], v[204:207], v[44:47], v[124:127]
ds_read_b64_tr_b16 v[238:239], v27 offset:41984
s_waitcnt lgkmcnt(12)
v_mfma_f32_16x16x32_bf16 v[128:131], v[208:211], v[32:35], v[128:131]
v_mfma_f32_16x16x32_bf16 v[132:135], v[208:211], v[36:39], v[132:135]
ds_read_b64_tr_b16 v[240:241], v28 offset:40960
v_mfma_f32_16x16x32_bf16 v[136:139], v[208:211], v[40:43], v[136:139]
v_mfma_f32_16x16x32_bf16 v[140:143], v[208:211], v[44:47], v[140:143]
ds_read_b64_tr_b16 v[242:243], v28 offset:41984
v_mfma_f32_16x16x32_bf16 v[144:147], v[212:215], v[32:35], v[144:147]
v_mfma_f32_16x16x32_bf16 v[148:151], v[212:215], v[36:39], v[148:151]
ds_read_b64_tr_b16 v[244:245], v29 offset:40960
v_mfma_f32_16x16x32_bf16 v[152:155], v[212:215], v[40:43], v[152:155]
v_mfma_f32_16x16x32_bf16 v[156:159], v[212:215], v[44:47], v[156:159]
ds_read_b64_tr_b16 v[246:247], v29 offset:41984
v_mfma_f32_16x16x32_bf16 v[160:163], v[216:219], v[32:35], v[160:163]
v_mfma_f32_16x16x32_bf16 v[164:167], v[216:219], v[36:39], v[164:167]
ds_read_b64_tr_b16 v[248:249], v30 offset:40960
v_mfma_f32_16x16x32_bf16 v[168:171], v[216:219], v[40:43], v[168:171]
v_mfma_f32_16x16x32_bf16 v[172:175], v[216:219], v[44:47], v[172:175]
ds_read_b64_tr_b16 v[250:251], v30 offset:41984
v_mfma_f32_16x16x32_bf16 v[176:179], v[220:223], v[32:35], v[176:179]
v_mfma_f32_16x16x32_bf16 v[180:183], v[220:223], v[36:39], v[180:183]
ds_read_b64_tr_b16 v[252:253], v31 offset:40960
v_mfma_f32_16x16x32_bf16 v[184:187], v[220:223], v[40:43], v[184:187]
v_mfma_f32_16x16x32_bf16 v[188:191], v[220:223], v[44:47], v[188:191]
ds_read_b64_tr_b16 v[254:255], v31 offset:41984
s_waitcnt lgkmcnt(8)
v_mfma_f32_16x16x32_bf16 v[64:67], v[224:227], v[48:51], v[64:67]
v_mfma_f32_16x16x32_bf16 v[68:71], v[224:227], v[52:55], v[68:71]
v_mfma_f32_16x16x32_bf16 v[72:75], v[224:227], v[56:59], v[72:75]
v_mfma_f32_16x16x32_bf16 v[76:79], v[224:227], v[60:63], v[76:79]
s_waitcnt lgkmcnt(0)
s_barrier
v_mfma_f32_16x16x32_bf16 v[80:83], v[228:231], v[48:51], v[80:83]
ds_read_b128 v[32:35], v14 offset:16384
v_mfma_f32_16x16x32_bf16 v[84:87], v[228:231], v[52:55], v[84:87]
ds_read_b128 v[36:39], v14 offset:18432
v_mfma_f32_16x16x32_bf16 v[88:91], v[228:231], v[56:59], v[88:91]
ds_read_b128 v[40:43], v14 offset:20480
v_mfma_f32_16x16x32_bf16 v[92:95], v[228:231], v[60:63], v[92:95]
ds_read_b128 v[44:47], v14 offset:22528
v_mfma_f32_16x16x32_bf16 v[96:99], v[232:235], v[48:51], v[96:99]
ds_read_b64_tr_b16 v[192:193], v24 offset:0
v_mfma_f32_16x16x32_bf16 v[100:103], v[232:235], v[52:55], v[100:103]
ds_read_b64_tr_b16 v[194:195], v24 offset:1024
v_mfma_f32_16x16x32_bf16 v[104:107], v[232:235], v[56:59], v[104:107]
ds_read_b64_tr_b16 v[196:197], v25 offset:0
v_mfma_f32_16x16x32_bf16 v[108:111], v[232:235], v[60:63], v[108:111]
ds_read_b64_tr_b16 v[198:199], v25 offset:1024
v_mfma_f32_16x16x32_bf16 v[112:115], v[236:239], v[48:51], v[112:115]
ds_read_b64_tr_b16 v[200:201], v26 offset:0
v_mfma_f32_16x16x32_bf16 v[116:119], v[236:239], v[52:55], v[116:119]
ds_read_b64_tr_b16 v[202:203], v26 offset:1024
v_mfma_f32_16x16x32_bf16 v[120:123], v[236:239], v[56:59], v[120:123]
ds_read_b64_tr_b16 v[204:205], v27 offset:0
v_mfma_f32_16x16x32_bf16 v[124:127], v[236:239], v[60:63], v[124:127]
ds_read_b64_tr_b16 v[206:207], v27 offset:1024
v_mfma_f32_16x16x32_bf16 v[128:131], v[240:243], v[48:51], v[128:131]
v_mfma_f32_16x16x32_bf16 v[132:135], v[240:243], v[52:55], v[132:135]
ds_read_b64_tr_b16 v[208:209], v28 offset:0
v_mfma_f32_16x16x32_bf16 v[136:139], v[240:243], v[56:59], v[136:139]
v_mfma_f32_16x16x32_bf16 v[140:143], v[240:243], v[60:63], v[140:143]
ds_read_b64_tr_b16 v[210:211], v28 offset:1024
v_mfma_f32_16x16x32_bf16 v[144:147], v[244:247], v[48:51], v[144:147]
v_mfma_f32_16x16x32_bf16 v[148:151], v[244:247], v[52:55], v[148:151]
ds_read_b64_tr_b16 v[212:213], v29 offset:0
v_mfma_f32_16x16x32_bf16 v[152:155], v[244:247], v[56:59], v[152:155]
v_mfma_f32_16x16x32_bf16 v[156:159], v[244:247], v[60:63], v[156:159]
ds_read_b64_tr_b16 v[214:215], v29 offset:1024
v_mfma_f32_16x16x32_bf16 v[160:163], v[248:251], v[48:51], v[160:163]
v_mfma_f32_16x16x32_bf16 v[164:167], v[248:251], v[52:55], v[164:167]
ds_read_b64_tr_b16 v[216:217], v30 offset:0
v_mfma_f32_16x16x32_bf16 v[168:171], v[248:251], v[56:59], v[168:171]
v_mfma_f32_16x16x32_bf16 v[172:175], v[248:251], v[60:63], v[172:175]
ds_read_b64_tr_b16 v[218:219], v30 offset:1024
v_mfma_f32_16x16x32_bf16 v[176:179], v[252:255], v[48:51], v[176:179]
v_mfma_f32_16x16x32_bf16 v[180:183], v[252:255], v[52:55], v[180:183]
ds_read_b64_tr_b16 v[220:221], v31 offset:0
v_mfma_f32_16x16x32_bf16 v[184:187], v[252:255], v[56:59], v[184:187]
v_mfma_f32_16x16x32_bf16 v[188:191], v[252:255], v[60:63], v[188:191]
ds_read_b64_tr_b16 v[222:223], v31 offset:1024
s_waitcnt lgkmcnt(8)
v_mfma_f32_16x16x32_bf16 v[64:67], v[192:195], v[32:35], v[64:67]
v_mfma_f32_16x16x32_bf16 v[68:71], v[192:195], v[36:39], v[68:71]
ds_read_b128 v[48:51], v15 offset:16384
v_mfma_f32_16x16x32_bf16 v[72:75], v[192:195], v[40:43], v[72:75]
ds_read_b128 v[52:55], v15 offset:18432
v_mfma_f32_16x16x32_bf16 v[76:79], v[192:195], v[44:47], v[76:79]
ds_read_b128 v[56:59], v15 offset:20480
v_mfma_f32_16x16x32_bf16 v[80:83], v[196:199], v[32:35], v[80:83]
v_mfma_f32_16x16x32_bf16 v[84:87], v[196:199], v[36:39], v[84:87]
ds_read_b128 v[60:63], v15 offset:22528
v_mfma_f32_16x16x32_bf16 v[88:91], v[196:199], v[40:43], v[88:91]
ds_read_b64_tr_b16 v[224:225], v24 offset:8192
v_mfma_f32_16x16x32_bf16 v[92:95], v[196:199], v[44:47], v[92:95]
ds_read_b64_tr_b16 v[226:227], v24 offset:9216
v_mfma_f32_16x16x32_bf16 v[96:99], v[200:203], v[32:35], v[96:99]
v_mfma_f32_16x16x32_bf16 v[100:103], v[200:203], v[36:39], v[100:103]
ds_read_b64_tr_b16 v[228:229], v25 offset:8192
v_mfma_f32_16x16x32_bf16 v[104:107], v[200:203], v[40:43], v[104:107]
ds_read_b64_tr_b16 v[230:231], v25 offset:9216
v_mfma_f32_16x16x32_bf16 v[108:111], v[200:203], v[44:47], v[108:111]
ds_read_b64_tr_b16 v[232:233], v26 offset:8192
v_mfma_f32_16x16x32_bf16 v[112:115], v[204:207], v[32:35], v[112:115]
v_mfma_f32_16x16x32_bf16 v[116:119], v[204:207], v[36:39], v[116:119]
ds_read_b64_tr_b16 v[234:235], v26 offset:9216
v_mfma_f32_16x16x32_bf16 v[120:123], v[204:207], v[40:43], v[120:123]
ds_read_b64_tr_b16 v[236:237], v27 offset:8192
v_mfma_f32_16x16x32_bf16 v[124:127], v[204:207], v[44:47], v[124:127]
ds_read_b64_tr_b16 v[238:239], v27 offset:9216
s_waitcnt lgkmcnt(12)
v_mfma_f32_16x16x32_bf16 v[128:131], v[208:211], v[32:35], v[128:131]
v_mfma_f32_16x16x32_bf16 v[132:135], v[208:211], v[36:39], v[132:135]
ds_read_b64_tr_b16 v[240:241], v28 offset:8192
v_mfma_f32_16x16x32_bf16 v[136:139], v[208:211], v[40:43], v[136:139]
v_mfma_f32_16x16x32_bf16 v[140:143], v[208:211], v[44:47], v[140:143]
ds_read_b64_tr_b16 v[242:243], v28 offset:9216
v_mfma_f32_16x16x32_bf16 v[144:147], v[212:215], v[32:35], v[144:147]
v_mfma_f32_16x16x32_bf16 v[148:151], v[212:215], v[36:39], v[148:151]
ds_read_b64_tr_b16 v[244:245], v29 offset:8192
v_mfma_f32_16x16x32_bf16 v[152:155], v[212:215], v[40:43], v[152:155]
v_mfma_f32_16x16x32_bf16 v[156:159], v[212:215], v[44:47], v[156:159]
ds_read_b64_tr_b16 v[246:247], v29 offset:9216
v_mfma_f32_16x16x32_bf16 v[160:163], v[216:219], v[32:35], v[160:163]
v_mfma_f32_16x16x32_bf16 v[164:167], v[216:219], v[36:39], v[164:167]
ds_read_b64_tr_b16 v[248:249], v30 offset:8192
v_mfma_f32_16x16x32_bf16 v[168:171], v[216:219], v[40:43], v[168:171]
v_mfma_f32_16x16x32_bf16 v[172:175], v[216:219], v[44:47], v[172:175]
ds_read_b64_tr_b16 v[250:251], v30 offset:9216
v_mfma_f32_16x16x32_bf16 v[176:179], v[220:223], v[32:35], v[176:179]
v_mfma_f32_16x16x32_bf16 v[180:183], v[220:223], v[36:39], v[180:183]
ds_read_b64_tr_b16 v[252:253], v31 offset:8192
v_mfma_f32_16x16x32_bf16 v[184:187], v[220:223], v[40:43], v[184:187]
v_mfma_f32_16x16x32_bf16 v[188:191], v[220:223], v[44:47], v[188:191]
ds_read_b64_tr_b16 v[254:255], v31 offset:9216
s_waitcnt lgkmcnt(8)
v_mfma_f32_16x16x32_bf16 v[64:67], v[224:227], v[48:51], v[64:67]
v_mfma_f32_16x16x32_bf16 v[68:71], v[224:227], v[52:55], v[68:71]
v_mfma_f32_16x16x32_bf16 v[72:75], v[224:227], v[56:59], v[72:75]
v_mfma_f32_16x16x32_bf16 v[76:79], v[224:227], v[60:63], v[76:79]
s_waitcnt lgkmcnt(0)
s_barrier
v_mfma_f32_16x16x32_bf16 v[80:83], v[228:231], v[48:51], v[80:83]
ds_read_b128 v[32:35], v14 offset:0
v_mfma_f32_16x16x32_bf16 v[84:87], v[228:231], v[52:55], v[84:87]
ds_read_b128 v[36:39], v14 offset:2048
v_mfma_f32_16x16x32_bf16 v[88:91], v[228:231], v[56:59], v[88:91]
ds_read_b128 v[40:43], v14 offset:4096
v_mfma_f32_16x16x32_bf16 v[92:95], v[228:231], v[60:63], v[92:95]
ds_read_b128 v[44:47], v14 offset:6144
v_mfma_f32_16x16x32_bf16 v[96:99], v[232:235], v[48:51], v[96:99]
ds_read_b64_tr_b16 v[192:193], v24 offset:16384
v_mfma_f32_16x16x32_bf16 v[100:103], v[232:235], v[52:55], v[100:103]
ds_read_b64_tr_b16 v[194:195], v24 offset:17408
v_mfma_f32_16x16x32_bf16 v[104:107], v[232:235], v[56:59], v[104:107]
ds_read_b64_tr_b16 v[196:197], v25 offset:16384
v_mfma_f32_16x16x32_bf16 v[108:111], v[232:235], v[60:63], v[108:111]
ds_read_b64_tr_b16 v[198:199], v25 offset:17408
v_mfma_f32_16x16x32_bf16 v[112:115], v[236:239], v[48:51], v[112:115]
ds_read_b64_tr_b16 v[200:201], v26 offset:16384
v_mfma_f32_16x16x32_bf16 v[116:119], v[236:239], v[52:55], v[116:119]
ds_read_b64_tr_b16 v[202:203], v26 offset:17408
v_mfma_f32_16x16x32_bf16 v[120:123], v[236:239], v[56:59], v[120:123]
ds_read_b64_tr_b16 v[204:205], v27 offset:16384
v_mfma_f32_16x16x32_bf16 v[124:127], v[236:239], v[60:63], v[124:127]
ds_read_b64_tr_b16 v[206:207], v27 offset:17408
v_mfma_f32_16x16x32_bf16 v[128:131], v[240:243], v[48:51], v[128:131]
v_mfma_f32_16x16x32_bf16 v[132:135], v[240:243], v[52:55], v[132:135]
ds_read_b64_tr_b16 v[208:209], v28 offset:16384
v_mfma_f32_16x16x32_bf16 v[136:139], v[240:243], v[56:59], v[136:139]
v_mfma_f32_16x16x32_bf16 v[140:143], v[240:243], v[60:63], v[140:143]
ds_read_b64_tr_b16 v[210:211], v28 offset:17408
v_mfma_f32_16x16x32_bf16 v[144:147], v[244:247], v[48:51], v[144:147]
v_mfma_f32_16x16x32_bf16 v[148:151], v[244:247], v[52:55], v[148:151]
ds_read_b64_tr_b16 v[212:213], v29 offset:16384
v_mfma_f32_16x16x32_bf16 v[152:155], v[244:247], v[56:59], v[152:155]
v_mfma_f32_16x16x32_bf16 v[156:159], v[244:247], v[60:63], v[156:159]
ds_read_b64_tr_b16 v[214:215], v29 offset:17408
v_mfma_f32_16x16x32_bf16 v[160:163], v[248:251], v[48:51], v[160:163]
v_mfma_f32_16x16x32_bf16 v[164:167], v[248:251], v[52:55], v[164:167]
ds_read_b64_tr_b16 v[216:217], v30 offset:16384
v_mfma_f32_16x16x32_bf16 v[168:171], v[248:251], v[56:59], v[168:171]
v_mfma_f32_16x16x32_bf16 v[172:175], v[248:251], v[60:63], v[172:175]
ds_read_b64_tr_b16 v[218:219], v30 offset:17408
v_mfma_f32_16x16x32_bf16 v[176:179], v[252:255], v[48:51], v[176:179]
v_mfma_f32_16x16x32_bf16 v[180:183], v[252:255], v[52:55], v[180:183]
ds_read_b64_tr_b16 v[220:221], v31 offset:16384
v_mfma_f32_16x16x32_bf16 v[184:187], v[252:255], v[56:59], v[184:187]
v_mfma_f32_16x16x32_bf16 v[188:191], v[252:255], v[60:63], v[188:191]
ds_read_b64_tr_b16 v[222:223], v31 offset:17408
s_waitcnt lgkmcnt(8)
v_mfma_f32_16x16x32_bf16 v[64:67], v[192:195], v[32:35], v[64:67]
v_mfma_f32_16x16x32_bf16 v[68:71], v[192:195], v[36:39], v[68:71]
ds_read_b128 v[48:51], v15 offset:0
v_mfma_f32_16x16x32_bf16 v[72:75], v[192:195], v[40:43], v[72:75]
ds_read_b128 v[52:55], v15 offset:2048
v_mfma_f32_16x16x32_bf16 v[76:79], v[192:195], v[44:47], v[76:79]
ds_read_b128 v[56:59], v15 offset:4096
v_mfma_f32_16x16x32_bf16 v[80:83], v[196:199], v[32:35], v[80:83]
v_mfma_f32_16x16x32_bf16 v[84:87], v[196:199], v[36:39], v[84:87]
ds_read_b128 v[60:63], v15 offset:6144
v_mfma_f32_16x16x32_bf16 v[88:91], v[196:199], v[40:43], v[88:91]
ds_read_b64_tr_b16 v[224:225], v24 offset:24576
v_mfma_f32_16x16x32_bf16 v[92:95], v[196:199], v[44:47], v[92:95]
ds_read_b64_tr_b16 v[226:227], v24 offset:25600
v_mfma_f32_16x16x32_bf16 v[96:99], v[200:203], v[32:35], v[96:99]
v_mfma_f32_16x16x32_bf16 v[100:103], v[200:203], v[36:39], v[100:103]
ds_read_b64_tr_b16 v[228:229], v25 offset:24576
v_mfma_f32_16x16x32_bf16 v[104:107], v[200:203], v[40:43], v[104:107]
ds_read_b64_tr_b16 v[230:231], v25 offset:25600
v_mfma_f32_16x16x32_bf16 v[108:111], v[200:203], v[44:47], v[108:111]
ds_read_b64_tr_b16 v[232:233], v26 offset:24576
v_mfma_f32_16x16x32_bf16 v[112:115], v[204:207], v[32:35], v[112:115]
v_mfma_f32_16x16x32_bf16 v[116:119], v[204:207], v[36:39], v[116:119]
ds_read_b64_tr_b16 v[234:235], v26 offset:25600
v_mfma_f32_16x16x32_bf16 v[120:123], v[204:207], v[40:43], v[120:123]
ds_read_b64_tr_b16 v[236:237], v27 offset:24576
v_mfma_f32_16x16x32_bf16 v[124:127], v[204:207], v[44:47], v[124:127]
ds_read_b64_tr_b16 v[238:239], v27 offset:25600
s_waitcnt lgkmcnt(12)
v_mfma_f32_16x16x32_bf16 v[128:131], v[208:211], v[32:35], v[128:131]
v_mfma_f32_16x16x32_bf16 v[132:135], v[208:211], v[36:39], v[132:135]
ds_read_b64_tr_b16 v[240:241], v28 offset:24576
v_mfma_f32_16x16x32_bf16 v[136:139], v[208:211], v[40:43], v[136:139]
v_mfma_f32_16x16x32_bf16 v[140:143], v[208:211], v[44:47], v[140:143]
ds_read_b64_tr_b16 v[242:243], v28 offset:25600
v_mfma_f32_16x16x32_bf16 v[144:147], v[212:215], v[32:35], v[144:147]
v_mfma_f32_16x16x32_bf16 v[148:151], v[212:215], v[36:39], v[148:151]
ds_read_b64_tr_b16 v[244:245], v29 offset:24576
v_mfma_f32_16x16x32_bf16 v[152:155], v[212:215], v[40:43], v[152:155]
v_mfma_f32_16x16x32_bf16 v[156:159], v[212:215], v[44:47], v[156:159]
ds_read_b64_tr_b16 v[246:247], v29 offset:25600
v_mfma_f32_16x16x32_bf16 v[160:163], v[216:219], v[32:35], v[160:163]
v_mfma_f32_16x16x32_bf16 v[164:167], v[216:219], v[36:39], v[164:167]
ds_read_b64_tr_b16 v[248:249], v30 offset:24576
v_mfma_f32_16x16x32_bf16 v[168:171], v[216:219], v[40:43], v[168:171]
v_mfma_f32_16x16x32_bf16 v[172:175], v[216:219], v[44:47], v[172:175]
ds_read_b64_tr_b16 v[250:251], v30 offset:25600
v_mfma_f32_16x16x32_bf16 v[176:179], v[220:223], v[32:35], v[176:179]
v_mfma_f32_16x16x32_bf16 v[180:183], v[220:223], v[36:39], v[180:183]
ds_read_b64_tr_b16 v[252:253], v31 offset:24576
v_mfma_f32_16x16x32_bf16 v[184:187], v[220:223], v[40:43], v[184:187]
v_mfma_f32_16x16x32_bf16 v[188:191], v[220:223], v[44:47], v[188:191]
ds_read_b64_tr_b16 v[254:255], v31 offset:25600
s_waitcnt lgkmcnt(8)
v_mfma_f32_16x16x32_bf16 v[64:67], v[224:227], v[48:51], v[64:67]
v_mfma_f32_16x16x32_bf16 v[68:71], v[224:227], v[52:55], v[68:71]
v_mfma_f32_16x16x32_bf16 v[72:75], v[224:227], v[56:59], v[72:75]
v_mfma_f32_16x16x32_bf16 v[76:79], v[224:227], v[60:63], v[76:79]
s_waitcnt lgkmcnt(0)
s_barrier
v_mfma_f32_16x16x32_bf16 v[80:83], v[228:231], v[48:51], v[80:83]
ds_read_b128 v[32:35], v21 offset:0
v_mfma_f32_16x16x32_bf16 v[84:87], v[228:231], v[52:55], v[84:87]
ds_read_b128 v[36:39], v21 offset:2048
v_mfma_f32_16x16x32_bf16 v[88:91], v[228:231], v[56:59], v[88:91]
ds_read_b128 v[40:43], v21 offset:4096
v_mfma_f32_16x16x32_bf16 v[92:95], v[228:231], v[60:63], v[92:95]
ds_read_b128 v[44:47], v21 offset:6144
v_mfma_f32_16x16x32_bf16 v[96:99], v[232:235], v[48:51], v[96:99]
ds_read_b64_tr_b16 v[192:193], v24 offset:32768
v_mfma_f32_16x16x32_bf16 v[100:103], v[232:235], v[52:55], v[100:103]
ds_read_b64_tr_b16 v[194:195], v24 offset:33792
v_mfma_f32_16x16x32_bf16 v[104:107], v[232:235], v[56:59], v[104:107]
ds_read_b64_tr_b16 v[196:197], v25 offset:32768
v_mfma_f32_16x16x32_bf16 v[108:111], v[232:235], v[60:63], v[108:111]
ds_read_b64_tr_b16 v[198:199], v25 offset:33792
v_mfma_f32_16x16x32_bf16 v[112:115], v[236:239], v[48:51], v[112:115]
ds_read_b64_tr_b16 v[200:201], v26 offset:32768
v_mfma_f32_16x16x32_bf16 v[116:119], v[236:239], v[52:55], v[116:119]
ds_read_b64_tr_b16 v[202:203], v26 offset:33792
v_mfma_f32_16x16x32_bf16 v[120:123], v[236:239], v[56:59], v[120:123]
ds_read_b64_tr_b16 v[204:205], v27 offset:32768
v_mfma_f32_16x16x32_bf16 v[124:127], v[236:239], v[60:63], v[124:127]
ds_read_b64_tr_b16 v[206:207], v27 offset:33792
v_mfma_f32_16x16x32_bf16 v[128:131], v[240:243], v[48:51], v[128:131]
v_mfma_f32_16x16x32_bf16 v[132:135], v[240:243], v[52:55], v[132:135]
ds_read_b64_tr_b16 v[208:209], v24 offset:40960
v_mfma_f32_16x16x32_bf16 v[136:139], v[240:243], v[56:59], v[136:139]
v_mfma_f32_16x16x32_bf16 v[140:143], v[240:243], v[60:63], v[140:143]
ds_read_b64_tr_b16 v[210:211], v24 offset:41984
v_mfma_f32_16x16x32_bf16 v[144:147], v[244:247], v[48:51], v[144:147]
v_mfma_f32_16x16x32_bf16 v[148:151], v[244:247], v[52:55], v[148:151]
ds_read_b64_tr_b16 v[212:213], v25 offset:40960
v_mfma_f32_16x16x32_bf16 v[152:155], v[244:247], v[56:59], v[152:155]
v_mfma_f32_16x16x32_bf16 v[156:159], v[244:247], v[60:63], v[156:159]
ds_read_b64_tr_b16 v[214:215], v25 offset:41984
v_mfma_f32_16x16x32_bf16 v[160:163], v[248:251], v[48:51], v[160:163]
v_mfma_f32_16x16x32_bf16 v[164:167], v[248:251], v[52:55], v[164:167]
ds_read_b64_tr_b16 v[216:217], v26 offset:40960
v_mfma_f32_16x16x32_bf16 v[168:171], v[248:251], v[56:59], v[168:171]
v_mfma_f32_16x16x32_bf16 v[172:175], v[248:251], v[60:63], v[172:175]
ds_read_b64_tr_b16 v[218:219], v26 offset:41984
v_mfma_f32_16x16x32_bf16 v[176:179], v[252:255], v[48:51], v[176:179]
v_mfma_f32_16x16x32_bf16 v[180:183], v[252:255], v[52:55], v[180:183]
ds_read_b64_tr_b16 v[220:221], v27 offset:40960
v_mfma_f32_16x16x32_bf16 v[184:187], v[252:255], v[56:59], v[184:187]
v_mfma_f32_16x16x32_bf16 v[188:191], v[252:255], v[60:63], v[188:191]
ds_read_b64_tr_b16 v[222:223], v27 offset:41984
s_waitcnt lgkmcnt(8)
v_mfma_f32_16x16x32_bf16 v[64:67], v[192:195], v[32:35], v[64:67]
v_mfma_f32_16x16x32_bf16 v[68:71], v[192:195], v[36:39], v[68:71]
ds_read_b128 v[48:51], v22 offset:0
v_mfma_f32_16x16x32_bf16 v[72:75], v[192:195], v[40:43], v[72:75]
ds_read_b128 v[52:55], v22 offset:2048
v_mfma_f32_16x16x32_bf16 v[76:79], v[192:195], v[44:47], v[76:79]
ds_read_b128 v[56:59], v22 offset:4096
v_mfma_f32_16x16x32_bf16 v[80:83], v[196:199], v[32:35], v[80:83]
v_mfma_f32_16x16x32_bf16 v[84:87], v[196:199], v[36:39], v[84:87]
ds_read_b128 v[60:63], v22 offset:6144
v_mfma_f32_16x16x32_bf16 v[88:91], v[196:199], v[40:43], v[88:91]
ds_read_b64_tr_b16 v[224:225], v28 offset:32768
v_mfma_f32_16x16x32_bf16 v[92:95], v[196:199], v[44:47], v[92:95]
ds_read_b64_tr_b16 v[226:227], v28 offset:33792
v_mfma_f32_16x16x32_bf16 v[96:99], v[200:203], v[32:35], v[96:99]
v_mfma_f32_16x16x32_bf16 v[100:103], v[200:203], v[36:39], v[100:103]
ds_read_b64_tr_b16 v[228:229], v29 offset:32768
v_mfma_f32_16x16x32_bf16 v[104:107], v[200:203], v[40:43], v[104:107]
ds_read_b64_tr_b16 v[230:231], v29 offset:33792
v_mfma_f32_16x16x32_bf16 v[108:111], v[200:203], v[44:47], v[108:111]
ds_read_b64_tr_b16 v[232:233], v30 offset:32768
v_mfma_f32_16x16x32_bf16 v[112:115], v[204:207], v[32:35], v[112:115]
v_mfma_f32_16x16x32_bf16 v[116:119], v[204:207], v[36:39], v[116:119]
ds_read_b64_tr_b16 v[234:235], v30 offset:33792
v_mfma_f32_16x16x32_bf16 v[120:123], v[204:207], v[40:43], v[120:123]
ds_read_b64_tr_b16 v[236:237], v31 offset:32768
v_mfma_f32_16x16x32_bf16 v[124:127], v[204:207], v[44:47], v[124:127]
ds_read_b64_tr_b16 v[238:239], v31 offset:33792
s_waitcnt lgkmcnt(8)
v_mfma_f32_16x16x32_bf16 v[64:67], v[208:211], v[48:51], v[64:67]
v_mfma_f32_16x16x32_bf16 v[68:71], v[208:211], v[52:55], v[68:71]
ds_read_b64_tr_b16 v[240:241], v28 offset:40960
v_mfma_f32_16x16x32_bf16 v[72:75], v[208:211], v[56:59], v[72:75]
v_mfma_f32_16x16x32_bf16 v[76:79], v[208:211], v[60:63], v[76:79]
ds_read_b64_tr_b16 v[242:243], v28 offset:41984
v_mfma_f32_16x16x32_bf16 v[80:83], v[212:215], v[48:51], v[80:83]
v_mfma_f32_16x16x32_bf16 v[84:87], v[212:215], v[52:55], v[84:87]
ds_read_b64_tr_b16 v[244:245], v29 offset:40960
v_mfma_f32_16x16x32_bf16 v[88:91], v[212:215], v[56:59], v[88:91]
v_mfma_f32_16x16x32_bf16 v[92:95], v[212:215], v[60:63], v[92:95]
ds_read_b64_tr_b16 v[246:247], v29 offset:41984
v_mfma_f32_16x16x32_bf16 v[96:99], v[216:219], v[48:51], v[96:99]
v_mfma_f32_16x16x32_bf16 v[100:103], v[216:219], v[52:55], v[100:103]
ds_read_b64_tr_b16 v[248:249], v30 offset:40960
v_mfma_f32_16x16x32_bf16 v[104:107], v[216:219], v[56:59], v[104:107]
v_mfma_f32_16x16x32_bf16 v[108:111], v[216:219], v[60:63], v[108:111]
ds_read_b64_tr_b16 v[250:251], v30 offset:41984
v_mfma_f32_16x16x32_bf16 v[112:115], v[220:223], v[48:51], v[112:115]
v_mfma_f32_16x16x32_bf16 v[116:119], v[220:223], v[52:55], v[116:119]
ds_read_b64_tr_b16 v[252:253], v31 offset:40960
v_mfma_f32_16x16x32_bf16 v[120:123], v[220:223], v[56:59], v[120:123]
v_mfma_f32_16x16x32_bf16 v[124:127], v[220:223], v[60:63], v[124:127]
ds_read_b64_tr_b16 v[254:255], v31 offset:41984
s_waitcnt lgkmcnt(8)
v_mfma_f32_16x16x32_bf16 v[128:131], v[224:227], v[32:35], v[128:131]
v_mfma_f32_16x16x32_bf16 v[132:135], v[224:227], v[36:39], v[132:135]
v_mfma_f32_16x16x32_bf16 v[136:139], v[224:227], v[40:43], v[136:139]
v_mfma_f32_16x16x32_bf16 v[140:143], v[224:227], v[44:47], v[140:143]
s_waitcnt lgkmcnt(0)
s_barrier
v_mfma_f32_16x16x32_bf16 v[144:147], v[228:231], v[32:35], v[144:147]
v_mul_f32 v64, s98, v64
v_mul_f32 v65, s98, v65
v_mul_f32 v66, s98, v66
v_mul_f32 v67, s98, v67
v_mfma_f32_16x16x32_bf16 v[148:151], v[228:231], v[36:39], v[148:151]
v_cvt_pk_bf16_f32 v64, v64, v65
v_cvt_pk_bf16_f32 v65, v66, v67
v_mul_f32 v80, s98, v80
v_mul_f32 v81, s98, v81
v_mul_f32 v82, s98, v82
v_mfma_f32_16x16x32_bf16 v[152:155], v[228:231], v[40:43], v[152:155]
v_mul_f32 v83, s98, v83
v_cvt_pk_bf16_f32 v80, v80, v81
v_cvt_pk_bf16_f32 v81, v82, v83
v_mul_f32 v68, s98, v68
v_mul_f32 v69, s98, v69
v_mfma_f32_16x16x32_bf16 v[156:159], v[228:231], v[44:47], v[156:159]
v_mul_f32 v70, s98, v70
v_mul_f32 v71, s98, v71
v_cvt_pk_bf16_f32 v68, v68, v69
v_cvt_pk_bf16_f32 v69, v70, v71
v_mfma_f32_16x16x32_bf16 v[128:131], v[240:243], v[48:51], v[128:131]
v_mul_f32 v84, s98, v84
v_mul_f32 v85, s98, v85
v_mul_f32 v86, s98, v86
v_mul_f32 v87, s98, v87
v_cvt_pk_bf16_f32 v84, v84, v85
v_mfma_f32_16x16x32_bf16 v[132:135], v[240:243], v[52:55], v[132:135]
v_cvt_pk_bf16_f32 v85, v86, v87
ds_write_b64 v16, v[64:65] offset:0
ds_write_b64 v16, v[80:81] offset:512
v_mul_f32 v72, s98, v72
v_mul_f32 v73, s98, v73
v_mfma_f32_16x16x32_bf16 v[136:139], v[240:243], v[56:59], v[136:139]
v_mul_f32 v74, s98, v74
v_mul_f32 v75, s98, v75
v_cvt_pk_bf16_f32 v72, v72, v73
v_cvt_pk_bf16_f32 v73, v74, v75
v_mfma_f32_16x16x32_bf16 v[140:143], v[240:243], v[60:63], v[140:143]
v_mul_f32 v88, s98, v88
v_mul_f32 v89, s98, v89
v_mul_f32 v90, s98, v90
v_mul_f32 v91, s98, v91
v_cvt_pk_bf16_f32 v88, v88, v89
v_mfma_f32_16x16x32_bf16 v[144:147], v[244:247], v[48:51], v[144:147]
v_cvt_pk_bf16_f32 v89, v90, v91
ds_write_b64 v16, v[68:69] offset:1024
ds_write_b64 v16, v[84:85] offset:1536
v_mul_f32 v76, s98, v76
v_mul_f32 v77, s98, v77
v_mfma_f32_16x16x32_bf16 v[148:151], v[244:247], v[52:55], v[148:151]
v_mul_f32 v78, s98, v78
v_mul_f32 v79, s98, v79
v_cvt_pk_bf16_f32 v76, v76, v77
v_cvt_pk_bf16_f32 v77, v78, v79
v_mfma_f32_16x16x32_bf16 v[152:155], v[244:247], v[56:59], v[152:155]
v_mul_f32 v92, s98, v92
v_mul_f32 v93, s98, v93
v_mul_f32 v94, s98, v94
v_mul_f32 v95, s98, v95
v_cvt_pk_bf16_f32 v92, v92, v93
v_mfma_f32_16x16x32_bf16 v[156:159], v[244:247], v[60:63], v[156:159]
v_cvt_pk_bf16_f32 v93, v94, v95
ds_write_b64 v17, v[72:73] offset:0
ds_write_b64 v17, v[88:89] offset:512
v_mul_f32 v96, s98, v96
v_mul_f32 v97, s98, v97
v_mfma_f32_16x16x32_bf16 v[160:163], v[232:235], v[32:35], v[160:163]
v_mul_f32 v98, s98, v98
v_mul_f32 v99, s98, v99
v_cvt_pk_bf16_f32 v96, v96, v97
v_cvt_pk_bf16_f32 v97, v98, v99
v_mul_f32 v112, s98, v112
v_mul_f32 v113, s98, v113
v_mul_f32 v114, s98, v114
v_mfma_f32_16x16x32_bf16 v[164:167], v[232:235], v[36:39], v[164:167]
v_mul_f32 v115, s98, v115
v_cvt_pk_bf16_f32 v112, v112, v113
v_cvt_pk_bf16_f32 v113, v114, v115
ds_write_b64 v17, v[76:77] offset:1024
ds_write_b64 v17, v[92:93] offset:1536
v_mul_f32 v100, s98, v100
v_mul_f32 v101, s98, v101
v_mfma_f32_16x16x32_bf16 v[168:171], v[232:235], v[40:43], v[168:171]
v_mul_f32 v102, s98, v102
v_mul_f32 v103, s98, v103
v_cvt_pk_bf16_f32 v100, v100, v101
v_cvt_pk_bf16_f32 v101, v102, v103
v_mul_f32 v116, s98, v116
v_mul_f32 v117, s98, v117
v_mul_f32 v118, s98, v118
v_mfma_f32_16x16x32_bf16 v[172:175], v[232:235], v[44:47], v[172:175]
v_mul_f32 v119, s98, v119
v_cvt_pk_bf16_f32 v116, v116, v117
v_cvt_pk_bf16_f32 v117, v118, v119
ds_write_b64 v16, v[96:97] offset:2048
ds_write_b64 v16, v[112:113] offset:2560
v_mul_f32 v104, s98, v104
v_mul_f32 v105, s98, v105
v_mfma_f32_16x16x32_bf16 v[176:179], v[236:239], v[32:35], v[176:179]
v_mul_f32 v106, s98, v106
v_mul_f32 v107, s98, v107
v_cvt_pk_bf16_f32 v104, v104, v105
v_cvt_pk_bf16_f32 v105, v106, v107
v_mul_f32 v120, s98, v120
v_mul_f32 v121, s98, v121
v_mul_f32 v122, s98, v122
v_mfma_f32_16x16x32_bf16 v[180:183], v[236:239], v[36:39], v[180:183]
v_mul_f32 v123, s98, v123
v_cvt_pk_bf16_f32 v120, v120, v121
v_cvt_pk_bf16_f32 v121, v122, v123
ds_write_b64 v16, v[100:101] offset:3072
ds_write_b64 v16, v[116:117] offset:3584
v_mul_f32 v108, s98, v108
v_mul_f32 v109, s98, v109
v_mfma_f32_16x16x32_bf16 v[184:187], v[236:239], v[40:43], v[184:187]
v_mul_f32 v110, s98, v110
v_mul_f32 v111, s98, v111
v_cvt_pk_bf16_f32 v108, v108, v109
v_cvt_pk_bf16_f32 v109, v110, v111
v_mul_f32 v124, s98, v124
v_mul_f32 v125, s98, v125
v_mul_f32 v126, s98, v126
v_mfma_f32_16x16x32_bf16 v[188:191], v[236:239], v[44:47], v[188:191]
v_mul_f32 v127, s98, v127
v_cvt_pk_bf16_f32 v124, v124, v125
v_cvt_pk_bf16_f32 v125, v126, v127
ds_write_b64 v17, v[104:105] offset:2048
ds_write_b64 v17, v[120:121] offset:2560
ds_write_b64 v17, v[108:109] offset:3072
ds_write_b64 v17, v[124:125] offset:3584
v_mfma_f32_16x16x32_bf16 v[160:163], v[248:251], v[48:51], v[160:163]
v_mul_f32 v128, s98, v128
v_mul_f32 v129, s98, v129
v_mul_f32 v130, s98, v130
v_mul_f32 v131, s98, v131
v_cvt_pk_bf16_f32 v128, v128, v129
v_cvt_pk_bf16_f32 v129, v130, v131
v_mul_f32 v144, s98, v144
v_mfma_f32_16x16x32_bf16 v[164:167], v[248:251], v[52:55], v[164:167]
v_mul_f32 v145, s98, v145
v_mul_f32 v146, s98, v146
v_mul_f32 v147, s98, v147
v_cvt_pk_bf16_f32 v144, v144, v145
v_cvt_pk_bf16_f32 v145, v146, v147
v_mul_f32 v132, s98, v132
v_mul_f32 v133, s98, v133
v_mfma_f32_16x16x32_bf16 v[168:171], v[248:251], v[56:59], v[168:171]
v_mul_f32 v134, s98, v134
v_mul_f32 v135, s98, v135
v_cvt_pk_bf16_f32 v132, v132, v133
v_cvt_pk_bf16_f32 v133, v134, v135
v_mul_f32 v148, s98, v148
v_mul_f32 v149, s98, v149
v_mul_f32 v150, s98, v150
v_mfma_f32_16x16x32_bf16 v[172:175], v[248:251], v[60:63], v[172:175]
v_mul_f32 v151, s98, v151
v_cvt_pk_bf16_f32 v148, v148, v149
v_cvt_pk_bf16_f32 v149, v150, v151
ds_write_b64 v16, v[128:129] offset:4096
ds_write_b64 v16, v[144:145] offset:4608
v_mul_f32 v136, s98, v136
v_mul_f32 v137, s98, v137
v_mfma_f32_16x16x32_bf16 v[176:179], v[252:255], v[48:51], v[176:179]
v_mul_f32 v138, s98, v138
v_mul_f32 v139, s98, v139
v_cvt_pk_bf16_f32 v136, v136, v137
v_cvt_pk_bf16_f32 v137, v138, v139
v_mul_f32 v152, s98, v152
v_mul_f32 v153, s98, v153
v_mul_f32 v154, s98, v154
v_mfma_f32_16x16x32_bf16 v[180:183], v[252:255], v[52:55], v[180:183]
v_mul_f32 v155, s98, v155
v_cvt_pk_bf16_f32 v152, v152, v153
v_cvt_pk_bf16_f32 v153, v154, v155
ds_write_b64 v16, v[132:133] offset:5120
ds_write_b64 v16, v[148:149] offset:5632
v_mul_f32 v140, s98, v140
v_mul_f32 v141, s98, v141
v_mfma_f32_16x16x32_bf16 v[184:187], v[252:255], v[56:59], v[184:187]
v_mul_f32 v142, s98, v142
v_mul_f32 v143, s98, v143
v_cvt_pk_bf16_f32 v140, v140, v141
v_cvt_pk_bf16_f32 v141, v142, v143
v_mul_f32 v156, s98, v156
v_mul_f32 v157, s98, v157
v_mul_f32 v158, s98, v158
v_mfma_f32_16x16x32_bf16 v[188:191], v[252:255], v[60:63], v[188:191]
v_mul_f32 v159, s98, v159
v_cvt_pk_bf16_f32 v156, v156, v157
v_cvt_pk_bf16_f32 v157, v158, v159
ds_write_b64 v17, v[136:137] offset:4096
ds_write_b64 v17, v[152:153] offset:4608
ds_write_b64 v17, v[140:141] offset:5120
ds_write_b64 v17, v[156:157] offset:5632
v_mul_f32 v160, s98, v160
v_mul_f32 v161, s98, v161
v_mul_f32 v162, s98, v162
v_mul_f32 v163, s98, v163
v_cvt_pk_bf16_f32 v160, v160, v161
v_cvt_pk_bf16_f32 v161, v162, v163
v_mul_f32 v176, s98, v176
v_mul_f32 v177, s98, v177
v_mul_f32 v178, s98, v178
v_mul_f32 v179, s98, v179
v_cvt_pk_bf16_f32 v176, v176, v177
v_cvt_pk_bf16_f32 v177, v178, v179
v_mul_f32 v164, s98, v164
v_mul_f32 v165, s98, v165
v_mul_f32 v166, s98, v166
v_mul_f32 v167, s98, v167
v_cvt_pk_bf16_f32 v164, v164, v165
v_cvt_pk_bf16_f32 v165, v166, v167
v_mul_f32 v180, s98, v180
v_mul_f32 v181, s98, v181
v_mul_f32 v182, s98, v182
v_mul_f32 v183, s98, v183
v_cvt_pk_bf16_f32 v180, v180, v181
v_cvt_pk_bf16_f32 v181, v182, v183
ds_write_b64 v16, v[160:161] offset:6144
ds_write_b64 v16, v[176:177] offset:6656
v_mul_f32 v168, s98, v168
v_mul_f32 v169, s98, v169
v_mul_f32 v170, s98, v170
v_mul_f32 v171, s98, v171
v_cvt_pk_bf16_f32 v168, v168, v169
v_cvt_pk_bf16_f32 v169, v170, v171
v_mul_f32 v184, s98, v184
v_mul_f32 v185, s98, v185
v_mul_f32 v186, s98, v186
v_mul_f32 v187, s98, v187
v_cvt_pk_bf16_f32 v184, v184, v185
v_cvt_pk_bf16_f32 v185, v186, v187
ds_write_b64 v16, v[164:165] offset:7168
ds_write_b64 v16, v[180:181] offset:7680
v_mul_f32 v172, s98, v172
v_mul_f32 v173, s98, v173
v_mul_f32 v174, s98, v174
v_mul_f32 v175, s98, v175
v_cvt_pk_bf16_f32 v172, v172, v173
v_cvt_pk_bf16_f32 v173, v174, v175
v_mul_f32 v188, s98, v188
v_mul_f32 v189, s98, v189
v_mul_f32 v190, s98, v190
v_mul_f32 v191, s98, v191
v_cvt_pk_bf16_f32 v188, v188, v189
v_cvt_pk_bf16_f32 v189, v190, v191
ds_write_b64 v17, v[168:169] offset:6144
ds_write_b64 v17, v[184:185] offset:6656
ds_write_b64 v17, v[172:173] offset:7168
ds_write_b64 v17, v[188:189] offset:7680
s_waitcnt lgkmcnt(0)
s_barrier
s_and_b32 s36, s4, 1
s_lshl_b32 s36, s36, 13
s_lshr_b32 s37, s4, 1
s_mul_i32 s37, s37, 81920
s_add_u32 s36, s36, s37
s_add_u32 s36, s36, 49152
v_add_u32 v16, s36, v20
ds_read_b128 v[32:35], v16 offset:0
ds_read_b128 v[36:39], v16 offset:1024
ds_read_b128 v[40:43], v16 offset:2048
ds_read_b128 v[44:47], v16 offset:3072
ds_read_b128 v[48:51], v16 offset:4096
ds_read_b128 v[52:55], v16 offset:5120
ds_read_b128 v[56:59], v16 offset:6144
ds_read_b128 v[60:63], v16 offset:7168
ds_read_b128 v[176:179], v2 offset:0
ds_read_b128 v[180:183], v2 offset:4096
ds_read_b128 v[184:187], v3 offset:0
ds_read_b128 v[188:191], v3 offset:4096
ds_read_b128 v[192:195], v4 offset:0
ds_read_b128 v[196:199], v4 offset:4096
ds_read_b128 v[200:203], v5 offset:0
ds_read_b128 v[204:207], v5 offset:4096
ds_read_b128 v[208:211], v2 offset:8192
ds_read_b128 v[212:215], v2 offset:12288
ds_read_b128 v[216:219], v3 offset:8192
ds_read_b128 v[220:223], v3 offset:12288
ds_read_b128 v[224:227], v4 offset:8192
ds_read_b128 v[228:231], v4 offset:12288
ds_read_b128 v[232:235], v5 offset:8192
ds_read_b128 v[236:239], v5 offset:12288
v_mov_b32 v64, 0
v_mov_b32 v65, 0
v_mov_b32 v66, 0
v_mov_b32 v67, 0
v_mov_b32 v68, 0
v_mov_b32 v69, 0
v_mov_b32 v70, 0
v_mov_b32 v71, 0
v_mov_b32 v72, 0
v_mov_b32 v73, 0
v_mov_b32 v74, 0
v_mov_b32 v75, 0
v_mov_b32 v76, 0
v_mov_b32 v77, 0
v_mov_b32 v78, 0
v_mov_b32 v79, 0
v_mov_b32 v80, 0
v_mov_b32 v81, 0
v_mov_b32 v82, 0
v_mov_b32 v83, 0
v_mov_b32 v84, 0
v_mov_b32 v85, 0
v_mov_b32 v86, 0
v_mov_b32 v87, 0
v_mov_b32 v88, 0
v_mov_b32 v89, 0
v_mov_b32 v90, 0
v_mov_b32 v91, 0
v_mov_b32 v92, 0
v_mov_b32 v93, 0
s_waitcnt lgkmcnt(15)
v_mfma_f32_16x16x32_bf16 v[128:131], v[176:179], v[32:35], 0
v_mov_b32 v94, 0
v_mov_b32 v95, 0
v_mfma_f32_16x16x32_bf16 v[132:135], v[176:179], v[36:39], 0
v_mov_b32 v96, 0
v_mov_b32 v97, 0
s_waitcnt lgkmcnt(14)
v_mfma_f32_16x16x32_bf16 v[136:139], v[180:183], v[32:35], 0
v_mov_b32 v98, 0
v_mov_b32 v99, 0
v_mfma_f32_16x16x32_bf16 v[140:143], v[180:183], v[36:39], 0
v_mov_b32 v100, 0
v_mov_b32 v101, 0
v_mov_b32 v102, 0
s_waitcnt lgkmcnt(13)
v_mfma_f32_16x16x32_bf16 v[128:131], v[184:187], v[40:43], v[128:131]
v_mov_b32 v103, 0
v_mov_b32 v104, 0
v_mfma_f32_16x16x32_bf16 v[132:135], v[184:187], v[44:47], v[132:135]
v_mov_b32 v105, 0
v_mov_b32 v106, 0
s_waitcnt lgkmcnt(12)
v_mfma_f32_16x16x32_bf16 v[136:139], v[188:191], v[40:43], v[136:139]
v_mov_b32 v107, 0
v_mov_b32 v108, 0
v_mfma_f32_16x16x32_bf16 v[140:143], v[188:191], v[44:47], v[140:143]
v_mov_b32 v109, 0
v_mov_b32 v110, 0
v_mov_b32 v111, 0
s_waitcnt lgkmcnt(11)
v_mfma_f32_16x16x32_bf16 v[128:131], v[192:195], v[48:51], v[128:131]
v_mov_b32 v112, 0
v_mov_b32 v113, 0
v_mfma_f32_16x16x32_bf16 v[132:135], v[192:195], v[52:55], v[132:135]
v_mov_b32 v114, 0
v_mov_b32 v115, 0
s_waitcnt lgkmcnt(10)
v_mfma_f32_16x16x32_bf16 v[136:139], v[196:199], v[48:51], v[136:139]
v_mov_b32 v116, 0
v_mov_b32 v117, 0
v_mfma_f32_16x16x32_bf16 v[140:143], v[196:199], v[52:55], v[140:143]
v_mov_b32 v118, 0
v_mov_b32 v119, 0
v_mov_b32 v120, 0
s_waitcnt lgkmcnt(9)
v_mfma_f32_16x16x32_bf16 v[128:131], v[200:203], v[56:59], v[128:131]
v_mov_b32 v121, 0
v_mov_b32 v122, 0
v_mfma_f32_16x16x32_bf16 v[132:135], v[200:203], v[60:63], v[132:135]
v_mov_b32 v123, 0
v_mov_b32 v124, 0
s_waitcnt lgkmcnt(8)
v_mfma_f32_16x16x32_bf16 v[136:139], v[204:207], v[56:59], v[136:139]
v_mov_b32 v125, 0
v_mov_b32 v126, 0
v_mfma_f32_16x16x32_bf16 v[140:143], v[204:207], v[60:63], v[140:143]
v_mov_b32 v127, 0
v_mov_b32 v14, 0
v_mov_b32 v15, 0
s_xor_b32 s37, s4, s34
s_and_b32 s36, s37, 1
s_lshl_b32 s36, s36, 13
s_lshr_b32 s37, s37, 1
s_mul_i32 s37, s37, 81920
s_add_u32 s36, s36, s37
s_add_u32 s36, s36, 65536
v_add_u32 v29, s36, v20
v_max3_f32 v16, v128, v129, v130
v_max3_f32 v16, v16, v131, v136
v_max3_f32 v16, v16, v137, v138
v_max_f32 v16, v16, v139
v_mov_b32 v18, v16
s_nop 1
v_permlane32_swap_b32 v16, v18
v_max_f32 v16, v16, v18
v_mov_b32 v18, v16
s_nop 1
v_permlane16_swap_b32 v16, v18
v_max_f32 v16, v16, v18
v_ceil_f32 v16, v16
v_add_f32 v16, 0x40e00000, v16
v_max3_f32 v17, v132, v133, v134
v_max3_f32 v17, v17, v135, v140
v_max3_f32 v17, v17, v141, v142
v_max_f32 v17, v17, v143
v_mov_b32 v18, v17
s_nop 1
v_permlane32_swap_b32 v17, v18
v_max_f32 v17, v17, v18
v_mov_b32 v18, v17
s_nop 1
v_permlane16_swap_b32 v17, v18
v_max_f32 v17, v17, v18
v_ceil_f32 v17, v17
v_add_f32 v17, 0x40e00000, v17
v_sub_f32 v240, 0, v16
v_sub_f32 v241, 0, v16
v_sub_f32 v242, 0, v16
v_sub_f32 v243, 0, v16
v_sub_f32 v244, 0, v17
v_sub_f32 v245, 0, v17
v_sub_f32 v246, 0, v17
v_sub_f32 v247, 0, v17
v_sub_f32 v128, v128, v16
v_sub_f32 v129, v129, v16
v_sub_f32 v130, v130, v16
v_sub_f32 v131, v131, v16
v_sub_f32 v132, v132, v17
v_sub_f32 v133, v133, v17
v_sub_f32 v134, v134, v17
v_sub_f32 v135, v135, v17
v_sub_f32 v136, v136, v16
v_sub_f32 v137, v137, v16
v_sub_f32 v138, v138, v16
v_sub_f32 v139, v139, v16
v_sub_f32 v140, v140, v17
v_sub_f32 v141, v141, v17
v_sub_f32 v142, v142, v17
v_sub_f32 v143, v143, v17
s_waitcnt lgkmcnt(7)
v_mfma_f32_16x16x32_bf16 v[144:147], v[208:211], v[32:35], v[240:243]
v_exp_f32 v16, v128
v_exp_f32 v17, v129
v_mfma_f32_16x16x32_bf16 v[148:151], v[208:211], v[36:39], v[244:247]
v_exp_f32 v18, v130
v_exp_f32 v19, v131
s_waitcnt lgkmcnt(6)
v_mfma_f32_16x16x32_bf16 v[152:155], v[212:215], v[32:35], v[240:243]
v_cvt_pk_bf16_f32 v160, v16, v17
v_exp_f32 v16, v132
v_mfma_f32_16x16x32_bf16 v[156:159], v[212:215], v[36:39], v[244:247]
v_exp_f32 v17, v133
v_cvt_pk_bf16_f32 v161, v18, v19
s_waitcnt lgkmcnt(5)
v_mfma_f32_16x16x32_bf16 v[144:147], v[216:219], v[40:43], v[144:147]
v_dot2_f32_bf16 v24, v160, s70, v14
v_exp_f32 v18, v134
v_mfma_f32_16x16x32_bf16 v[148:151], v[216:219], v[44:47], v[148:151]
v_exp_f32 v19, v135
v_cvt_pk_bf16_f32 v164, v16, v17
s_waitcnt lgkmcnt(4)
v_mfma_f32_16x16x32_bf16 v[152:155], v[220:223], v[40:43], v[152:155]
v_dot2_f32_bf16 v24, v161, s70, v24
v_cvt_pk_bf16_f32 v165, v18, v19
v_mfma_f32_16x16x32_bf16 v[156:159], v[220:223], v[44:47], v[156:159]
v_dot2_f32_bf16 v25, v164, s70, v15
v_dot2_f32_bf16 v25, v165, s70, v25
s_waitcnt lgkmcnt(3)
v_mfma_f32_16x16x32_bf16 v[144:147], v[224:227], v[48:51], v[144:147]
v_exp_f32 v16, v136
v_exp_f32 v17, v137
v_mfma_f32_16x16x32_bf16 v[148:151], v[224:227], v[52:55], v[148:151]
v_exp_f32 v18, v138
v_exp_f32 v19, v139
s_waitcnt lgkmcnt(2)
v_mfma_f32_16x16x32_bf16 v[152:155], v[228:231], v[48:51], v[152:155]
v_cvt_pk_bf16_f32 v162, v16, v17
v_exp_f32 v16, v140
v_mfma_f32_16x16x32_bf16 v[156:159], v[228:231], v[52:55], v[156:159]
v_exp_f32 v17, v141
v_cvt_pk_bf16_f32 v163, v18, v19
s_waitcnt lgkmcnt(1)
v_mfma_f32_16x16x32_bf16 v[144:147], v[232:235], v[56:59], v[144:147]
v_dot2_f32_bf16 v24, v162, s70, v24
v_exp_f32 v18, v142
v_mfma_f32_16x16x32_bf16 v[148:151], v[232:235], v[60:63], v[148:151]
v_exp_f32 v19, v143
v_cvt_pk_bf16_f32 v166, v16, v17
s_waitcnt lgkmcnt(0)
v_mfma_f32_16x16x32_bf16 v[152:155], v[236:239], v[56:59], v[152:155]
v_dot2_f32_bf16 v24, v163, s70, v24
v_cvt_pk_bf16_f32 v167, v18, v19
v_mfma_f32_16x16x32_bf16 v[156:159], v[236:239], v[60:63], v[156:159]
v_dot2_f32_bf16 v25, v166, s70, v25
v_dot2_f32_bf16 v25, v167, s70, v25
s_waitcnt vmcnt(0) lgkmcnt(0)
s_barrier
ds_read_b128 v[176:179], v2 offset:16384
ds_read_b128 v[180:183], v2 offset:20480
ds_read_b128 v[184:187], v3 offset:16384
ds_read_b128 v[188:191], v3 offset:20480
ds_read_b128 v[192:195], v4 offset:16384
ds_read_b128 v[196:199], v4 offset:20480
ds_read_b128 v[200:203], v5 offset:16384
ds_read_b128 v[204:207], v5 offset:20480
s_bfe_u32 s38, s2, 0x20003
s_xor_b32 s39, s4, s34
s_add_u32 s36, s38, 1
s_and_b32 s36, s36, 3
s_lshl_b32 s36, s36, 1
s_lshl_b32 s37, s34, 3
s_add_u32 s36, s36, s37
s_lshl_b32 s37, s32, 5
s_add_u32 s37, s37, s36
s_lshl_b32 s37, s37, 2
s_add_u32 s37, s37, s39
s_lshl_b32 s84, s37, 13
s_add_u32 s36, s38, 2
s_and_b32 s36, s36, 3
s_lshl_b32 s36, s36, 1
s_lshl_b32 s37, s34, 3
s_add_u32 s36, s36, s37
s_lshl_b32 s37, s32, 5
s_add_u32 s37, s37, s36
s_lshl_b32 s37, s37, 2
s_add_u32 s37, s37, s39
s_lshl_b32 s85, s37, 13
s_add_u32 s36, s38, 3
s_and_b32 s36, s36, 3
s_lshl_b32 s36, s36, 1
s_lshl_b32 s37, s34, 3
s_add_u32 s36, s36, s37
s_lshl_b32 s37, s32, 5
s_add_u32 s37, s37, s36
s_lshl_b32 s37, s37, 2
s_add_u32 s37, s37, s39
s_lshl_b32 s86, s37, 13
v_lshrrev_b32 v16, 2, v1
v_add_u32 v16, s38, v16
v_add_u32 v16, 1, v16
v_and_b32 v16, 3, v16
v_lshlrev_b32 v16, 10, v16
s_and_b32 s36, s2, 0xe7
s_lshl_b32 s36, s36, 7
s_add_u32 s36, s36, 33554432
v_and_b32 v28, 3, v1
v_lshl_add_u32 v28, v28, 2, v16
v_add_u32 v28, s36, v28
s_cmp_lg_u32 s4, 0
s_cbranch_scc1 LA_nocnt
s_getreg_b32 s36, hwreg(HW_REG_XCC_ID, 0, 4)
s_lshl_b32 s37, s7, 4
s_or_b32 s37, s37, s36
v_mov_b32 v26, s37
v_mov_b32 v27, 0
s_lshl_b32 s36, s2, 7
s_add_u32 s36, s36, 33554432
s_mov_b64 exec, 1
buffer_store_dword v26, v27, s[24:27], s36 offen offset:32 sc1
s_mov_b64 exec, -1
LA_nocnt:
s_mov_b32 s46, 0
LA_loop:
s_waitcnt lgkmcnt(0)
v_mfma_f32_16x16x32_bf16 v[128:131], v[176:179], v[32:35], v[240:243]
ds_read_b64_tr_b16 v[208:209], v6 offset:0
ds_read_b64_tr_b16 v[210:211], v6 offset:4096
v_mfma_f32_16x16x32_bf16 v[132:135], v[176:179], v[36:39], v[244:247]
ds_read_b64_tr_b16 v[212:213], v7 offset:0
ds_read_b64_tr_b16 v[214:215], v7 offset:4096
v_exp_f32 v16, v144
v_mfma_f32_16x16x32_bf16 v[136:139], v[180:183], v[32:35], v[240:243]
ds_read_b64_tr_b16 v[216:217], v8 offset:0
ds_read_b64_tr_b16 v[218:219], v8 offset:4096
v_mfma_f32_16x16x32_bf16 v[140:143], v[180:183], v[36:39], v[244:247]
ds_read_b64_tr_b16 v[220:221], v9 offset:0
ds_read_b64_tr_b16 v[222:223], v9 offset:4096
v_mfma_f32_16x16x32_bf16 v[128:131], v[184:187], v[40:43], v[128:131]
ds_read_b64_tr_b16 v[224:225], v10 offset:0
ds_read_b64_tr_b16 v[226:227], v10 offset:4096
v_mfma_f32_16x16x32_bf16 v[132:135], v[184:187], v[44:47], v[132:135]
ds_read_b64_tr_b16 v[228:229], v11 offset:0
ds_read_b64_tr_b16 v[230:231], v11 offset:4096
v_exp_f32 v17, v145
v_mfma_f32_16x16x32_bf16 v[136:139], v[188:191], v[40:43], v[136:139]
ds_read_b64_tr_b16 v[232:233], v12 offset:0
ds_read_b64_tr_b16 v[234:235], v12 offset:4096
v_mfma_f32_16x16x32_bf16 v[140:143], v[188:191], v[44:47], v[140:143]
ds_read_b64_tr_b16 v[236:237], v13 offset:0
ds_read_b64_tr_b16 v[238:239], v13 offset:4096
v_mfma_f32_16x16x32_bf16 v[128:131], v[192:195], v[48:51], v[128:131]
v_exp_f32 v18, v146
v_mfma_f32_16x16x32_bf16 v[132:135], v[192:195], v[52:55], v[132:135]
v_exp_f32 v19, v147
v_cvt_pk_bf16_f32 v168, v16, v17
v_mfma_f32_16x16x32_bf16 v[136:139], v[196:199], v[48:51], v[136:139]
v_exp_f32 v16, v148
v_mfma_f32_16x16x32_bf16 v[140:143], v[196:199], v[52:55], v[140:143]
v_exp_f32 v17, v149
v_cvt_pk_bf16_f32 v169, v18, v19
v_mfma_f32_16x16x32_bf16 v[128:131], v[200:203], v[56:59], v[128:131]
v_dot2_f32_bf16 v14, v168, s70, v24
v_exp_f32 v18, v150
v_mfma_f32_16x16x32_bf16 v[132:135], v[200:203], v[60:63], v[132:135]
v_exp_f32 v19, v151
v_mfma_f32_16x16x32_bf16 v[136:139], v[204:207], v[56:59], v[136:139]
v_cvt_pk_bf16_f32 v172, v16, v17
v_dot2_f32_bf16 v14, v169, s70, v14
v_cvt_pk_bf16_f32 v173, v18, v19
v_mfma_f32_16x16x32_bf16 v[140:143], v[204:207], v[60:63], v[140:143]
v_dot2_f32_bf16 v15, v172, s70, v25
v_dot2_f32_bf16 v15, v173, s70, v15
s_waitcnt lgkmcnt(0)
v_mfma_f32_16x16x32_bf16 v[64:67], v[208:211], v[160:163], v[64:67]
ds_read_b128 v[176:179], v2 offset:24576
v_exp_f32 v16, v152
v_mfma_f32_16x16x32_bf16 v[68:71], v[208:211], v[164:167], v[68:71]
ds_read_b128 v[180:183], v2 offset:28672
v_mfma_f32_16x16x32_bf16 v[72:75], v[212:215], v[160:163], v[72:75]
ds_read_b128 v[184:187], v3 offset:24576
v_exp_f32 v17, v153
v_mfma_f32_16x16x32_bf16 v[76:79], v[212:215], v[164:167], v[76:79]
ds_read_b128 v[188:191], v3 offset:28672
v_mfma_f32_16x16x32_bf16 v[80:83], v[216:219], v[160:163], v[80:83]
ds_read_b128 v[192:195], v4 offset:24576
v_exp_f32 v18, v154
v_mfma_f32_16x16x32_bf16 v[84:87], v[216:219], v[164:167], v[84:87]
ds_read_b128 v[196:199], v4 offset:28672
v_mfma_f32_16x16x32_bf16 v[88:91], v[220:223], v[160:163], v[88:91]
ds_read_b128 v[200:203], v5 offset:24576
v_exp_f32 v19, v155
v_mfma_f32_16x16x32_bf16 v[92:95], v[220:223], v[164:167], v[92:95]
ds_read_b128 v[204:207], v5 offset:28672
v_cvt_pk_bf16_f32 v170, v16, v17
v_mfma_f32_16x16x32_bf16 v[96:99], v[224:227], v[160:163], v[96:99]
v_exp_f32 v16, v156
v_mfma_f32_16x16x32_bf16 v[100:103], v[224:227], v[164:167], v[100:103]
v_exp_f32 v17, v157
v_mfma_f32_16x16x32_bf16 v[104:107], v[228:231], v[160:163], v[104:107]
v_cvt_pk_bf16_f32 v171, v18, v19
v_dot2_f32_bf16 v14, v170, s70, v14
v_mfma_f32_16x16x32_bf16 v[108:111], v[228:231], v[164:167], v[108:111]
v_exp_f32 v18, v158
v_mfma_f32_16x16x32_bf16 v[112:115], v[232:235], v[160:163], v[112:115]
v_exp_f32 v19, v159
v_cvt_pk_bf16_f32 v174, v16, v17
v_mfma_f32_16x16x32_bf16 v[116:119], v[232:235], v[164:167], v[116:119]
v_dot2_f32_bf16 v14, v171, s70, v14
v_cvt_pk_bf16_f32 v175, v18, v19
v_mfma_f32_16x16x32_bf16 v[120:123], v[236:239], v[160:163], v[120:123]
v_dot2_f32_bf16 v15, v174, s70, v15
v_dot2_f32_bf16 v15, v175, s70, v15
v_mfma_f32_16x16x32_bf16 v[124:127], v[236:239], v[164:167], v[124:127]
s_nop 1
v_add_f32 v16, v14, v15
v_cmp_nge_f32 vcc, 0x41800000, v16
s_cbranch_vccnz LA_rare1_0
LA_back1_0:
s_waitcnt lgkmcnt(0)
v_mfma_f32_16x16x32_bf16 v[144:147], v[176:179], v[32:35], v[240:243]
ds_read_b64_tr_b16 v[208:209], v6 offset:8192
ds_read_b64_tr_b16 v[210:211], v6 offset:12288
v_mfma_f32_16x16x32_bf16 v[148:151], v[176:179], v[36:39], v[244:247]
ds_read_b64_tr_b16 v[212:213], v7 offset:8192
ds_read_b64_tr_b16 v[214:215], v7 offset:12288
v_exp_f32 v16, v128
v_mfma_f32_16x16x32_bf16 v[152:155], v[180:183], v[32:35], v[240:243]
ds_read_b64_tr_b16 v[216:217], v8 offset:8192
ds_read_b64_tr_b16 v[218:219], v8 offset:12288
v_mfma_f32_16x16x32_bf16 v[156:159], v[180:183], v[36:39], v[244:247]
ds_read_b64_tr_b16 v[220:221], v9 offset:8192
ds_read_b64_tr_b16 v[222:223], v9 offset:12288
v_mfma_f32_16x16x32_bf16 v[144:147], v[184:187], v[40:43], v[144:147]
ds_read_b64_tr_b16 v[224:225], v10 offset:8192
ds_read_b64_tr_b16 v[226:227], v10 offset:12288
v_mfma_f32_16x16x32_bf16 v[148:151], v[184:187], v[44:47], v[148:151]
ds_read_b64_tr_b16 v[228:229], v11 offset:8192
ds_read_b64_tr_b16 v[230:231], v11 offset:12288
v_exp_f32 v17, v129
v_mfma_f32_16x16x32_bf16 v[152:155], v[188:191], v[40:43], v[152:155]
ds_read_b64_tr_b16 v[232:233], v12 offset:8192
ds_read_b64_tr_b16 v[234:235], v12 offset:12288
v_mfma_f32_16x16x32_bf16 v[156:159], v[188:191], v[44:47], v[156:159]
ds_read_b64_tr_b16 v[236:237], v13 offset:8192
ds_read_b64_tr_b16 v[238:239], v13 offset:12288
v_mfma_f32_16x16x32_bf16 v[144:147], v[192:195], v[48:51], v[144:147]
v_exp_f32 v18, v130
v_mfma_f32_16x16x32_bf16 v[148:151], v[192:195], v[52:55], v[148:151]
v_exp_f32 v19, v131
v_cvt_pk_bf16_f32 v160, v16, v17
v_mfma_f32_16x16x32_bf16 v[152:155], v[196:199], v[48:51], v[152:155]
v_exp_f32 v16, v132
v_mfma_f32_16x16x32_bf16 v[156:159], v[196:199], v[52:55], v[156:159]
v_exp_f32 v17, v133
v_cvt_pk_bf16_f32 v161, v18, v19
v_mfma_f32_16x16x32_bf16 v[144:147], v[200:203], v[56:59], v[144:147]
v_dot2_f32_bf16 v24, v160, s70, v14
v_exp_f32 v18, v134
v_mfma_f32_16x16x32_bf16 v[148:151], v[200:203], v[60:63], v[148:151]
v_exp_f32 v19, v135
v_mfma_f32_16x16x32_bf16 v[152:155], v[204:207], v[56:59], v[152:155]
v_cvt_pk_bf16_f32 v164, v16, v17
v_dot2_f32_bf16 v24, v161, s70, v24
v_cvt_pk_bf16_f32 v165, v18, v19
v_mfma_f32_16x16x32_bf16 v[156:159], v[204:207], v[60:63], v[156:159]
v_dot2_f32_bf16 v25, v164, s70, v15
v_dot2_f32_bf16 v25, v165, s70, v25
s_cmp_eq_u32 s46, 10
s_waitcnt lgkmcnt(0)
s_cbranch_scc1 LA_last
v_mfma_f32_16x16x32_bf16 v[64:67], v[208:211], v[168:171], v[64:67]
v_exp_f32 v16, v136
v_mfma_f32_16x16x32_bf16 v[68:71], v[208:211], v[172:175], v[68:71]
v_exp_f32 v17, v137
v_mfma_f32_16x16x32_bf16 v[72:75], v[212:215], v[168:171], v[72:75]
v_exp_f32 v18, v138
v_mfma_f32_16x16x32_bf16 v[76:79], v[212:215], v[172:175], v[76:79]
v_exp_f32 v19, v139
v_cvt_pk_bf16_f32 v162, v16, v17
s_barrier
v_mfma_f32_16x16x32_bf16 v[80:83], v[216:219], v[168:171], v[80:83]
ds_read_b128 v[176:179], v2 offset:32768
v_exp_f32 v16, v140
v_mfma_f32_16x16x32_bf16 v[84:87], v[216:219], v[172:175], v[84:87]
ds_read_b128 v[180:183], v2 offset:36864
v_mfma_f32_16x16x32_bf16 v[88:91], v[220:223], v[168:171], v[88:91]
ds_read_b128 v[184:187], v3 offset:32768
v_exp_f32 v17, v141
v_mfma_f32_16x16x32_bf16 v[92:95], v[220:223], v[172:175], v[92:95]
ds_read_b128 v[188:191], v3 offset:36864
v_mfma_f32_16x16x32_bf16 v[96:99], v[224:227], v[168:171], v[96:99]
ds_read_b128 v[192:195], v4 offset:32768
v_cvt_pk_bf16_f32 v163, v18, v19
v_mfma_f32_16x16x32_bf16 v[100:103], v[224:227], v[172:175], v[100:103]
ds_read_b128 v[196:199], v4 offset:36864
v_dot2_f32_bf16 v24, v162, s70, v24
v_mfma_f32_16x16x32_bf16 v[104:107], v[228:231], v[168:171], v[104:107]
ds_read_b128 v[200:203], v5 offset:32768
v_exp_f32 v18, v142
v_mfma_f32_16x16x32_bf16 v[108:111], v[228:231], v[172:175], v[108:111]
ds_read_b128 v[204:207], v5 offset:36864
v_mfma_f32_16x16x32_bf16 v[112:115], v[232:235], v[168:171], v[112:115]
v_exp_f32 v19, v143
v_cvt_pk_bf16_f32 v166, v16, v17
v_mfma_f32_16x16x32_bf16 v[116:119], v[232:235], v[172:175], v[116:119]
v_dot2_f32_bf16 v24, v163, s70, v24
v_cvt_pk_bf16_f32 v167, v18, v19
v_mfma_f32_16x16x32_bf16 v[120:123], v[236:239], v[168:171], v[120:123]
v_dot2_f32_bf16 v25, v166, s70, v25
v_dot2_f32_bf16 v25, v167, s70, v25
v_mfma_f32_16x16x32_bf16 v[124:127], v[236:239], v[172:175], v[124:127]
s_nop 1
v_add_f32 v16, v24, v25
v_cmp_nge_f32 vcc, 0x41800000, v16
s_cbranch_vccnz LA_rare0_0
LA_back0_0:
s_waitcnt lgkmcnt(0)
v_mfma_f32_16x16x32_bf16 v[128:131], v[176:179], v[32:35], v[240:243]
ds_read_b64_tr_b16 v[208:209], v6 offset:16384
ds_read_b64_tr_b16 v[210:211], v6 offset:20480
v_mfma_f32_16x16x32_bf16 v[132:135], v[176:179], v[36:39], v[244:247]
ds_read_b64_tr_b16 v[212:213], v7 offset:16384
ds_read_b64_tr_b16 v[214:215], v7 offset:20480
v_exp_f32 v16, v144
v_mfma_f32_16x16x32_bf16 v[136:139], v[180:183], v[32:35], v[240:243]
ds_read_b64_tr_b16 v[216:217], v8 offset:16384
ds_read_b64_tr_b16 v[218:219], v8 offset:20480
v_mfma_f32_16x16x32_bf16 v[140:143], v[180:183], v[36:39], v[244:247]
ds_read_b64_tr_b16 v[220:221], v9 offset:16384
ds_read_b64_tr_b16 v[222:223], v9 offset:20480
v_mfma_f32_16x16x32_bf16 v[128:131], v[184:187], v[40:43], v[128:131]
ds_read_b64_tr_b16 v[224:225], v10 offset:16384
ds_read_b64_tr_b16 v[226:227], v10 offset:20480
v_mfma_f32_16x16x32_bf16 v[132:135], v[184:187], v[44:47], v[132:135]
ds_read_b64_tr_b16 v[228:229], v11 offset:16384
ds_read_b64_tr_b16 v[230:231], v11 offset:20480
v_exp_f32 v17, v145
v_mfma_f32_16x16x32_bf16 v[136:139], v[188:191], v[40:43], v[136:139]
ds_read_b64_tr_b16 v[232:233], v12 offset:16384
ds_read_b64_tr_b16 v[234:235], v12 offset:20480
v_mfma_f32_16x16x32_bf16 v[140:143], v[188:191], v[44:47], v[140:143]
ds_read_b64_tr_b16 v[236:237], v13 offset:16384
ds_read_b64_tr_b16 v[238:239], v13 offset:20480
v_mfma_f32_16x16x32_bf16 v[128:131], v[192:195], v[48:51], v[128:131]
v_exp_f32 v18, v146
v_mfma_f32_16x16x32_bf16 v[132:135], v[192:195], v[52:55], v[132:135]
v_exp_f32 v19, v147
v_cvt_pk_bf16_f32 v168, v16, v17
v_mfma_f32_16x16x32_bf16 v[136:139], v[196:199], v[48:51], v[136:139]
v_exp_f32 v16, v148
v_mfma_f32_16x16x32_bf16 v[140:143], v[196:199], v[52:55], v[140:143]
v_exp_f32 v17, v149
v_cvt_pk_bf16_f32 v169, v18, v19
v_mfma_f32_16x16x32_bf16 v[128:131], v[200:203], v[56:59], v[128:131]
v_dot2_f32_bf16 v14, v168, s70, v24
v_exp_f32 v18, v150
v_mfma_f32_16x16x32_bf16 v[132:135], v[200:203], v[60:63], v[132:135]
v_exp_f32 v19, v151
v_mfma_f32_16x16x32_bf16 v[136:139], v[204:207], v[56:59], v[136:139]
v_cvt_pk_bf16_f32 v172, v16, v17
v_dot2_f32_bf16 v14, v169, s70, v14
v_cvt_pk_bf16_f32 v173, v18, v19
v_mfma_f32_16x16x32_bf16 v[140:143], v[204:207], v[60:63], v[140:143]
v_dot2_f32_bf16 v15, v172, s70, v25
v_dot2_f32_bf16 v15, v173, s70, v15
s_waitcnt lgkmcnt(0)
v_mfma_f32_16x16x32_bf16 v[64:67], v[208:211], v[160:163], v[64:67]
ds_read_b128 v[176:179], v2 offset:40960
v_exp_f32 v16, v152
v_mfma_f32_16x16x32_bf16 v[68:71], v[208:211], v[164:167], v[68:71]
ds_read_b128 v[180:183], v2 offset:45056
v_mfma_f32_16x16x32_bf16 v[72:75], v[212:215], v[160:163], v[72:75]
ds_read_b128 v[184:187], v3 offset:40960
v_exp_f32 v17, v153
v_mfma_f32_16x16x32_bf16 v[76:79], v[212:215], v[164:167], v[76:79]
ds_read_b128 v[188:191], v3 offset:45056
v_mfma_f32_16x16x32_bf16 v[80:83], v[216:219], v[160:163], v[80:83]
ds_read_b128 v[192:195], v4 offset:40960
v_exp_f32 v18, v154
v_mfma_f32_16x16x32_bf16 v[84:87], v[216:219], v[164:167], v[84:87]
ds_read_b128 v[196:199], v4 offset:45056
v_mfma_f32_16x16x32_bf16 v[88:91], v[220:223], v[160:163], v[88:91]
ds_read_b128 v[200:203], v5 offset:40960
v_exp_f32 v19, v155
v_mfma_f32_16x16x32_bf16 v[92:95], v[220:223], v[164:167], v[92:95]
ds_read_b128 v[204:207], v5 offset:45056
v_cvt_pk_bf16_f32 v170, v16, v17
v_mfma_f32_16x16x32_bf16 v[96:99], v[224:227], v[160:163], v[96:99]
v_exp_f32 v16, v156
v_mfma_f32_16x16x32_bf16 v[100:103], v[224:227], v[164:167], v[100:103]
v_exp_f32 v17, v157
v_mfma_f32_16x16x32_bf16 v[104:107], v[228:231], v[160:163], v[104:107]
v_cvt_pk_bf16_f32 v171, v18, v19
v_dot2_f32_bf16 v14, v170, s70, v14
v_mfma_f32_16x16x32_bf16 v[108:111], v[228:231], v[164:167], v[108:111]
v_exp_f32 v18, v158
v_mfma_f32_16x16x32_bf16 v[112:115], v[232:235], v[160:163], v[112:115]
v_exp_f32 v19, v159
v_cvt_pk_bf16_f32 v174, v16, v17
v_mfma_f32_16x16x32_bf16 v[116:119], v[232:235], v[164:167], v[116:119]
v_dot2_f32_bf16 v14, v171, s70, v14
v_cvt_pk_bf16_f32 v175, v18, v19
v_mfma_f32_16x16x32_bf16 v[120:123], v[236:239], v[160:163], v[120:123]
v_dot2_f32_bf16 v15, v174, s70, v15
v_dot2_f32_bf16 v15, v175, s70, v15
v_mfma_f32_16x16x32_bf16 v[124:127], v[236:239], v[164:167], v[124:127]
s_nop 1
v_add_f32 v16, v14, v15
v_cmp_nge_f32 vcc, 0x41800000, v16
s_cbranch_vccnz LA_rare1_1
LA_back1_1:
s_waitcnt lgkmcnt(0)
v_mfma_f32_16x16x32_bf16 v[144:147], v[176:179], v[32:35], v[240:243]
ds_read_b64_tr_b16 v[208:209], v6 offset:24576
ds_read_b64_tr_b16 v[210:211], v6 offset:28672
v_mfma_f32_16x16x32_bf16 v[148:151], v[176:179], v[36:39], v[244:247]
ds_read_b64_tr_b16 v[212:213], v7 offset:24576
ds_read_b64_tr_b16 v[214:215], v7 offset:28672
v_exp_f32 v16, v128
v_mfma_f32_16x16x32_bf16 v[152:155], v[180:183], v[32:35], v[240:243]
ds_read_b64_tr_b16 v[216:217], v8 offset:24576
ds_read_b64_tr_b16 v[218:219], v8 offset:28672
v_mfma_f32_16x16x32_bf16 v[156:159], v[180:183], v[36:39], v[244:247]
ds_read_b64_tr_b16 v[220:221], v9 offset:24576
ds_read_b64_tr_b16 v[222:223], v9 offset:28672
v_mfma_f32_16x16x32_bf16 v[144:147], v[184:187], v[40:43], v[144:147]
ds_read_b64_tr_b16 v[224:225], v10 offset:24576
ds_read_b64_tr_b16 v[226:227], v10 offset:28672
v_mfma_f32_16x16x32_bf16 v[148:151], v[184:187], v[44:47], v[148:151]
ds_read_b64_tr_b16 v[228:229], v11 offset:24576
ds_read_b64_tr_b16 v[230:231], v11 offset:28672
v_exp_f32 v17, v129
v_mfma_f32_16x16x32_bf16 v[152:155], v[188:191], v[40:43], v[152:155]
ds_read_b64_tr_b16 v[232:233], v12 offset:24576
ds_read_b64_tr_b16 v[234:235], v12 offset:28672
v_mfma_f32_16x16x32_bf16 v[156:159], v[188:191], v[44:47], v[156:159]
ds_read_b64_tr_b16 v[236:237], v13 offset:24576
ds_read_b64_tr_b16 v[238:239], v13 offset:28672
v_mfma_f32_16x16x32_bf16 v[144:147], v[192:195], v[48:51], v[144:147]
v_exp_f32 v18, v130
v_mfma_f32_16x16x32_bf16 v[148:151], v[192:195], v[52:55], v[148:151]
v_exp_f32 v19, v131
v_cvt_pk_bf16_f32 v160, v16, v17
v_mfma_f32_16x16x32_bf16 v[152:155], v[196:199], v[48:51], v[152:155]
v_exp_f32 v16, v132
v_mfma_f32_16x16x32_bf16 v[156:159], v[196:199], v[52:55], v[156:159]
v_exp_f32 v17, v133
v_cvt_pk_bf16_f32 v161, v18, v19
v_mfma_f32_16x16x32_bf16 v[144:147], v[200:203], v[56:59], v[144:147]
v_dot2_f32_bf16 v24, v160, s70, v14
v_exp_f32 v18, v134
v_mfma_f32_16x16x32_bf16 v[148:151], v[200:203], v[60:63], v[148:151]
v_exp_f32 v19, v135
v_mfma_f32_16x16x32_bf16 v[152:155], v[204:207], v[56:59], v[152:155]
v_cvt_pk_bf16_f32 v164, v16, v17
v_dot2_f32_bf16 v24, v161, s70, v24
v_cvt_pk_bf16_f32 v165, v18, v19
v_mfma_f32_16x16x32_bf16 v[156:159], v[204:207], v[60:63], v[156:159]
v_dot2_f32_bf16 v25, v164, s70, v15
v_dot2_f32_bf16 v25, v165, s70, v25
s_waitcnt lgkmcnt(0)
v_mfma_f32_16x16x32_bf16 v[64:67], v[208:211], v[168:171], v[64:67]
v_exp_f32 v16, v136
v_mfma_f32_16x16x32_bf16 v[68:71], v[208:211], v[172:175], v[68:71]
v_exp_f32 v17, v137
v_mfma_f32_16x16x32_bf16 v[72:75], v[212:215], v[168:171], v[72:75]
v_exp_f32 v18, v138
v_mfma_f32_16x16x32_bf16 v[76:79], v[212:215], v[172:175], v[76:79]
v_exp_f32 v19, v139
v_cvt_pk_bf16_f32 v162, v16, v17
s_barrier
v_mfma_f32_16x16x32_bf16 v[80:83], v[216:219], v[168:171], v[80:83]
ds_read_b128 v[176:179], v2 offset:0
v_exp_f32 v16, v140
v_mfma_f32_16x16x32_bf16 v[84:87], v[216:219], v[172:175], v[84:87]
ds_read_b128 v[180:183], v2 offset:4096
v_mfma_f32_16x16x32_bf16 v[88:91], v[220:223], v[168:171], v[88:91]
ds_read_b128 v[184:187], v3 offset:0
v_exp_f32 v17, v141
v_mfma_f32_16x16x32_bf16 v[92:95], v[220:223], v[172:175], v[92:95]
ds_read_b128 v[188:191], v3 offset:4096
v_mfma_f32_16x16x32_bf16 v[96:99], v[224:227], v[168:171], v[96:99]
ds_read_b128 v[192:195], v4 offset:0
v_cvt_pk_bf16_f32 v163, v18, v19
v_mfma_f32_16x16x32_bf16 v[100:103], v[224:227], v[172:175], v[100:103]
ds_read_b128 v[196:199], v4 offset:4096
v_dot2_f32_bf16 v24, v162, s70, v24
v_mfma_f32_16x16x32_bf16 v[104:107], v[228:231], v[168:171], v[104:107]
ds_read_b128 v[200:203], v5 offset:0
v_exp_f32 v18, v142
v_mfma_f32_16x16x32_bf16 v[108:111], v[228:231], v[172:175], v[108:111]
ds_read_b128 v[204:207], v5 offset:4096
v_mfma_f32_16x16x32_bf16 v[112:115], v[232:235], v[168:171], v[112:115]
v_exp_f32 v19, v143
v_cvt_pk_bf16_f32 v166, v16, v17
v_mfma_f32_16x16x32_bf16 v[116:119], v[232:235], v[172:175], v[116:119]
v_dot2_f32_bf16 v24, v163, s70, v24
v_cvt_pk_bf16_f32 v167, v18, v19
v_mfma_f32_16x16x32_bf16 v[120:123], v[236:239], v[168:171], v[120:123]
v_dot2_f32_bf16 v25, v166, s70, v25
v_dot2_f32_bf16 v25, v167, s70, v25
v_mfma_f32_16x16x32_bf16 v[124:127], v[236:239], v[172:175], v[124:127]
s_nop 1
v_add_f32 v16, v24, v25
v_cmp_nge_f32 vcc, 0x41800000, v16
s_cbranch_vccnz LA_rare0_1
LA_back0_1:
s_waitcnt lgkmcnt(0)
v_mfma_f32_16x16x32_bf16 v[128:131], v[176:179], v[32:35], v[240:243]
ds_read_b64_tr_b16 v[208:209], v6 offset:32768
ds_read_b64_tr_b16 v[210:211], v6 offset:36864
v_mfma_f32_16x16x32_bf16 v[132:135], v[176:179], v[36:39], v[244:247]
ds_read_b64_tr_b16 v[212:213], v7 offset:32768
ds_read_b64_tr_b16 v[214:215], v7 offset:36864
v_exp_f32 v16, v144
v_mfma_f32_16x16x32_bf16 v[136:139], v[180:183], v[32:35], v[240:243]
ds_read_b64_tr_b16 v[216:217], v8 offset:32768
ds_read_b64_tr_b16 v[218:219], v8 offset:36864
v_mfma_f32_16x16x32_bf16 v[140:143], v[180:183], v[36:39], v[244:247]
ds_read_b64_tr_b16 v[220:221], v9 offset:32768
ds_read_b64_tr_b16 v[222:223], v9 offset:36864
v_mfma_f32_16x16x32_bf16 v[128:131], v[184:187], v[40:43], v[128:131]
ds_read_b64_tr_b16 v[224:225], v10 offset:32768
ds_read_b64_tr_b16 v[226:227], v10 offset:36864
v_mfma_f32_16x16x32_bf16 v[132:135], v[184:187], v[44:47], v[132:135]
ds_read_b64_tr_b16 v[228:229], v11 offset:32768
ds_read_b64_tr_b16 v[230:231], v11 offset:36864
v_exp_f32 v17, v145
v_mfma_f32_16x16x32_bf16 v[136:139], v[188:191], v[40:43], v[136:139]
ds_read_b64_tr_b16 v[232:233], v12 offset:32768
ds_read_b64_tr_b16 v[234:235], v12 offset:36864
v_mfma_f32_16x16x32_bf16 v[140:143], v[188:191], v[44:47], v[140:143]
ds_read_b64_tr_b16 v[236:237], v13 offset:32768
ds_read_b64_tr_b16 v[238:239], v13 offset:36864
v_mfma_f32_16x16x32_bf16 v[128:131], v[192:195], v[48:51], v[128:131]
v_exp_f32 v18, v146
v_mfma_f32_16x16x32_bf16 v[132:135], v[192:195], v[52:55], v[132:135]
v_exp_f32 v19, v147
v_cvt_pk_bf16_f32 v168, v16, v17
v_mfma_f32_16x16x32_bf16 v[136:139], v[196:199], v[48:51], v[136:139]
v_exp_f32 v16, v148
v_mfma_f32_16x16x32_bf16 v[140:143], v[196:199], v[52:55], v[140:143]
v_exp_f32 v17, v149
v_cvt_pk_bf16_f32 v169, v18, v19
v_mfma_f32_16x16x32_bf16 v[128:131], v[200:203], v[56:59], v[128:131]
v_dot2_f32_bf16 v14, v168, s70, v24
v_exp_f32 v18, v150
v_mfma_f32_16x16x32_bf16 v[132:135], v[200:203], v[60:63], v[132:135]
v_exp_f32 v19, v151
v_mfma_f32_16x16x32_bf16 v[136:139], v[204:207], v[56:59], v[136:139]
v_cvt_pk_bf16_f32 v172, v16, v17
v_dot2_f32_bf16 v14, v169, s70, v14
v_cvt_pk_bf16_f32 v173, v18, v19
v_mfma_f32_16x16x32_bf16 v[140:143], v[204:207], v[60:63], v[140:143]
v_dot2_f32_bf16 v15, v172, s70, v25
v_dot2_f32_bf16 v15, v173, s70, v15
s_waitcnt lgkmcnt(0)
v_mfma_f32_16x16x32_bf16 v[64:67], v[208:211], v[160:163], v[64:67]
ds_read_b128 v[176:179], v2 offset:8192
v_exp_f32 v16, v152
v_mfma_f32_16x16x32_bf16 v[68:71], v[208:211], v[164:167], v[68:71]
ds_read_b128 v[180:183], v2 offset:12288
v_mfma_f32_16x16x32_bf16 v[72:75], v[212:215], v[160:163], v[72:75]
ds_read_b128 v[184:187], v3 offset:8192
v_exp_f32 v17, v153
v_mfma_f32_16x16x32_bf16 v[76:79], v[212:215], v[164:167], v[76:79]
ds_read_b128 v[188:191], v3 offset:12288
v_mfma_f32_16x16x32_bf16 v[80:83], v[216:219], v[160:163], v[80:83]
ds_read_b128 v[192:195], v4 offset:8192
v_exp_f32 v18, v154
v_mfma_f32_16x16x32_bf16 v[84:87], v[216:219], v[164:167], v[84:87]
ds_read_b128 v[196:199], v4 offset:12288
v_mfma_f32_16x16x32_bf16 v[88:91], v[220:223], v[160:163], v[88:91]
ds_read_b128 v[200:203], v5 offset:8192
v_exp_f32 v19, v155
v_mfma_f32_16x16x32_bf16 v[92:95], v[220:223], v[164:167], v[92:95]
ds_read_b128 v[204:207], v5 offset:12288
v_cvt_pk_bf16_f32 v170, v16, v17
v_mfma_f32_16x16x32_bf16 v[96:99], v[224:227], v[160:163], v[96:99]
v_exp_f32 v16, v156
v_mfma_f32_16x16x32_bf16 v[100:103], v[224:227], v[164:167], v[100:103]
v_exp_f32 v17, v157
v_mfma_f32_16x16x32_bf16 v[104:107], v[228:231], v[160:163], v[104:107]
v_cvt_pk_bf16_f32 v171, v18, v19
v_dot2_f32_bf16 v14, v170, s70, v14
v_mfma_f32_16x16x32_bf16 v[108:111], v[228:231], v[164:167], v[108:111]
v_exp_f32 v18, v158
v_mfma_f32_16x16x32_bf16 v[112:115], v[232:235], v[160:163], v[112:115]
v_exp_f32 v19, v159
v_cvt_pk_bf16_f32 v174, v16, v17
v_mfma_f32_16x16x32_bf16 v[116:119], v[232:235], v[164:167], v[116:119]
v_dot2_f32_bf16 v14, v171, s70, v14
v_cvt_pk_bf16_f32 v175, v18, v19
v_mfma_f32_16x16x32_bf16 v[120:123], v[236:239], v[160:163], v[120:123]
v_dot2_f32_bf16 v15, v174, s70, v15
v_dot2_f32_bf16 v15, v175, s70, v15
v_mfma_f32_16x16x32_bf16 v[124:127], v[236:239], v[164:167], v[124:127]
s_nop 1
v_add_f32 v16, v14, v15
v_cmp_nge_f32 vcc, 0x41800000, v16
s_cbranch_vccnz LA_rare1_2
LA_back1_2:
s_waitcnt lgkmcnt(0)
v_mfma_f32_16x16x32_bf16 v[144:147], v[176:179], v[32:35], v[240:243]
ds_read_b64_tr_b16 v[208:209], v6 offset:40960
ds_read_b64_tr_b16 v[210:211], v6 offset:45056
v_mfma_f32_16x16x32_bf16 v[148:151], v[176:179], v[36:39], v[244:247]
ds_read_b64_tr_b16 v[212:213], v7 offset:40960
ds_read_b64_tr_b16 v[214:215], v7 offset:45056
v_exp_f32 v16, v128
v_mfma_f32_16x16x32_bf16 v[152:155], v[180:183], v[32:35], v[240:243]
ds_read_b64_tr_b16 v[216:217], v8 offset:40960
ds_read_b64_tr_b16 v[218:219], v8 offset:45056
v_mfma_f32_16x16x32_bf16 v[156:159], v[180:183], v[36:39], v[244:247]
ds_read_b64_tr_b16 v[220:221], v9 offset:40960
ds_read_b64_tr_b16 v[222:223], v9 offset:45056
v_mfma_f32_16x16x32_bf16 v[144:147], v[184:187], v[40:43], v[144:147]
ds_read_b64_tr_b16 v[224:225], v10 offset:40960
ds_read_b64_tr_b16 v[226:227], v10 offset:45056
v_mfma_f32_16x16x32_bf16 v[148:151], v[184:187], v[44:47], v[148:151]
ds_read_b64_tr_b16 v[228:229], v11 offset:40960
ds_read_b64_tr_b16 v[230:231], v11 offset:45056
v_exp_f32 v17, v129
v_mfma_f32_16x16x32_bf16 v[152:155], v[188:191], v[40:43], v[152:155]
ds_read_b64_tr_b16 v[232:233], v12 offset:40960
ds_read_b64_tr_b16 v[234:235], v12 offset:45056
v_mfma_f32_16x16x32_bf16 v[156:159], v[188:191], v[44:47], v[156:159]
ds_read_b64_tr_b16 v[236:237], v13 offset:40960
ds_read_b64_tr_b16 v[238:239], v13 offset:45056
v_mfma_f32_16x16x32_bf16 v[144:147], v[192:195], v[48:51], v[144:147]
v_exp_f32 v18, v130
v_mfma_f32_16x16x32_bf16 v[148:151], v[192:195], v[52:55], v[148:151]
v_exp_f32 v19, v131
v_cvt_pk_bf16_f32 v160, v16, v17
v_mfma_f32_16x16x32_bf16 v[152:155], v[196:199], v[48:51], v[152:155]
v_exp_f32 v16, v132
v_mfma_f32_16x16x32_bf16 v[156:159], v[196:199], v[52:55], v[156:159]
v_exp_f32 v17, v133
v_cvt_pk_bf16_f32 v161, v18, v19
v_mfma_f32_16x16x32_bf16 v[144:147], v[200:203], v[56:59], v[144:147]
v_dot2_f32_bf16 v24, v160, s70, v14
v_exp_f32 v18, v134
v_mfma_f32_16x16x32_bf16 v[148:151], v[200:203], v[60:63], v[148:151]
v_exp_f32 v19, v135
v_mfma_f32_16x16x32_bf16 v[152:155], v[204:207], v[56:59], v[152:155]
v_cvt_pk_bf16_f32 v164, v16, v17
v_dot2_f32_bf16 v24, v161, s70, v24
v_cvt_pk_bf16_f32 v165, v18, v19
v_mfma_f32_16x16x32_bf16 v[156:159], v[204:207], v[60:63], v[156:159]
v_dot2_f32_bf16 v25, v164, s70, v15
v_dot2_f32_bf16 v25, v165, s70, v25
s_waitcnt lgkmcnt(0)
v_mfma_f32_16x16x32_bf16 v[64:67], v[208:211], v[168:171], v[64:67]
v_exp_f32 v16, v136
v_mfma_f32_16x16x32_bf16 v[68:71], v[208:211], v[172:175], v[68:71]
v_exp_f32 v17, v137
v_mfma_f32_16x16x32_bf16 v[72:75], v[212:215], v[168:171], v[72:75]
v_exp_f32 v18, v138
v_mfma_f32_16x16x32_bf16 v[76:79], v[212:215], v[172:175], v[76:79]
v_exp_f32 v19, v139
v_cvt_pk_bf16_f32 v162, v16, v17
s_barrier
v_mfma_f32_16x16x32_bf16 v[80:83], v[216:219], v[168:171], v[80:83]
ds_read_b128 v[176:179], v2 offset:16384
v_exp_f32 v16, v140
v_mfma_f32_16x16x32_bf16 v[84:87], v[216:219], v[172:175], v[84:87]
ds_read_b128 v[180:183], v2 offset:20480
v_mfma_f32_16x16x32_bf16 v[88:91], v[220:223], v[168:171], v[88:91]
ds_read_b128 v[184:187], v3 offset:16384
v_exp_f32 v17, v141
v_mfma_f32_16x16x32_bf16 v[92:95], v[220:223], v[172:175], v[92:95]
ds_read_b128 v[188:191], v3 offset:20480
v_cvt_pk_bf16_f32 v163, v18, v19
v_mfma_f32_16x16x32_bf16 v[96:99], v[224:227], v[168:171], v[96:99]
ds_read_b128 v[192:195], v4 offset:16384
v_dot2_f32_bf16 v24, v162, s70, v24
v_mfma_f32_16x16x32_bf16 v[100:103], v[224:227], v[172:175], v[100:103]
ds_read_b128 v[196:199], v4 offset:20480
v_exp_f32 v18, v142
v_mfma_f32_16x16x32_bf16 v[104:107], v[228:231], v[168:171], v[104:107]
ds_read_b128 v[200:203], v5 offset:16384
v_mfma_f32_16x16x32_bf16 v[108:111], v[228:231], v[172:175], v[108:111]
ds_read_b128 v[204:207], v5 offset:20480
v_exp_f32 v19, v143
v_mfma_f32_16x16x32_bf16 v[112:115], v[232:235], v[168:171], v[112:115]
v_cvt_pk_bf16_f32 v166, v16, v17
v_dot2_f32_bf16 v24, v163, s70, v24
v_mfma_f32_16x16x32_bf16 v[116:119], v[232:235], v[172:175], v[116:119]
v_cvt_pk_bf16_f32 v167, v18, v19
v_dot2_f32_bf16 v25, v166, s70, v25
v_mfma_f32_16x16x32_bf16 v[120:123], v[236:239], v[168:171], v[120:123]
v_dot2_f32_bf16 v25, v167, s70, v25
s_add_u32 s46, s46, 1
v_mfma_f32_16x16x32_bf16 v[124:127], v[236:239], v[172:175], v[124:127]
s_nop 0
v_add_f32 v16, v24, v25
v_cmp_nge_f32 vcc, 0x41800000, v16
s_cbranch_vccnz LA_rare0_2
LA_back0_2:
s_cmp_lg_u32 s46, 5
s_cbranch_scc1 LA_loop
ds_read_b128 v[32:35], v29 offset:0
ds_read_b128 v[36:39], v29 offset:1024
ds_read_b128 v[40:43], v29 offset:2048
ds_read_b128 v[44:47], v29 offset:3072
ds_read_b128 v[48:51], v29 offset:4096
ds_read_b128 v[52:55], v29 offset:5120
ds_read_b128 v[56:59], v29 offset:6144
ds_read_b128 v[60:63], v29 offset:7168
s_waitcnt lgkmcnt(0)
v_mfma_f32_16x16x32_bf16 v[128:131], v[176:179], v[32:35], 0
ds_read_b64_tr_b16 v[208:209], v6 offset:0
ds_read_b64_tr_b16 v[210:211], v6 offset:4096
v_mfma_f32_16x16x32_bf16 v[132:135], v[176:179], v[36:39], 0
ds_read_b64_tr_b16 v[212:213], v7 offset:0
ds_read_b64_tr_b16 v[214:215], v7 offset:4096
v_exp_f32 v16, v144
v_mfma_f32_16x16x32_bf16 v[136:139], v[180:183], v[32:35], 0
ds_read_b64_tr_b16 v[216:217], v8 offset:0
ds_read_b64_tr_b16 v[218:219], v8 offset:4096
v_mfma_f32_16x16x32_bf16 v[140:143], v[180:183], v[36:39], 0
ds_read_b64_tr_b16 v[220:221], v9 offset:0
ds_read_b64_tr_b16 v[222:223], v9 offset:4096
v_mfma_f32_16x16x32_bf16 v[128:131], v[184:187], v[40:43], v[128:131]
ds_read_b64_tr_b16 v[224:225], v10 offset:0
ds_read_b64_tr_b16 v[226:227], v10 offset:4096
v_mfma_f32_16x16x32_bf16 v[132:135], v[184:187], v[44:47], v[132:135]
ds_read_b64_tr_b16 v[228:229], v11 offset:0
ds_read_b64_tr_b16 v[230:231], v11 offset:4096
v_exp_f32 v17, v145
v_mfma_f32_16x16x32_bf16 v[136:139], v[188:191], v[40:43], v[136:139]
ds_read_b64_tr_b16 v[232:233], v12 offset:0
ds_read_b64_tr_b16 v[234:235], v12 offset:4096
v_mfma_f32_16x16x32_bf16 v[140:143], v[188:191], v[44:47], v[140:143]
ds_read_b64_tr_b16 v[236:237], v13 offset:0
ds_read_b64_tr_b16 v[238:239], v13 offset:4096
v_mfma_f32_16x16x32_bf16 v[128:131], v[192:195], v[48:51], v[128:131]
v_exp_f32 v18, v146
v_mfma_f32_16x16x32_bf16 v[132:135], v[192:195], v[52:55], v[132:135]
v_exp_f32 v19, v147
v_cvt_pk_bf16_f32 v168, v16, v17
v_mfma_f32_16x16x32_bf16 v[136:139], v[196:199], v[48:51], v[136:139]
v_exp_f32 v16, v148
v_mfma_f32_16x16x32_bf16 v[140:143], v[196:199], v[52:55], v[140:143]
v_exp_f32 v17, v149
v_cvt_pk_bf16_f32 v169, v18, v19
v_mfma_f32_16x16x32_bf16 v[128:131], v[200:203], v[56:59], v[128:131]
v_dot2_f32_bf16 v14, v168, s70, v24
v_exp_f32 v18, v150
v_mfma_f32_16x16x32_bf16 v[132:135], v[200:203], v[60:63], v[132:135]
v_exp_f32 v19, v151
v_mfma_f32_16x16x32_bf16 v[136:139], v[204:207], v[56:59], v[136:139]
v_cvt_pk_bf16_f32 v172, v16, v17
v_dot2_f32_bf16 v14, v169, s70, v14
v_cvt_pk_bf16_f32 v173, v18, v19
v_mfma_f32_16x16x32_bf16 v[140:143], v[204:207], v[60:63], v[140:143]
v_dot2_f32_bf16 v15, v172, s70, v25
v_dot2_f32_bf16 v15, v173, s70, v15
s_waitcnt lgkmcnt(0)
v_mfma_f32_16x16x32_bf16 v[64:67], v[208:211], v[160:163], v[64:67]
ds_read_b128 v[176:179], v2 offset:24576
v_exp_f32 v16, v152
v_exp_f32 v17, v153
v_mfma_f32_16x16x32_bf16 v[68:71], v[208:211], v[164:167], v[68:71]
ds_read_b128 v[180:183], v2 offset:28672
v_exp_f32 v18, v154
v_mfma_f32_16x16x32_bf16 v[72:75], v[212:215], v[160:163], v[72:75]
ds_read_b128 v[184:187], v3 offset:24576
v_exp_f32 v19, v155
v_cvt_pk_bf16_f32 v170, v16, v17
v_exp_f32 v16, v156
v_mfma_f32_16x16x32_bf16 v[76:79], v[212:215], v[164:167], v[76:79]
ds_read_b128 v[188:191], v3 offset:28672
v_exp_f32 v17, v157
v_cvt_pk_bf16_f32 v171, v18, v19
v_mfma_f32_16x16x32_bf16 v[80:83], v[216:219], v[160:163], v[80:83]
ds_read_b128 v[192:195], v4 offset:24576
v_dot2_f32_bf16 v14, v170, s70, v14
v_exp_f32 v18, v158
v_mfma_f32_16x16x32_bf16 v[84:87], v[216:219], v[164:167], v[84:87]
ds_read_b128 v[196:199], v4 offset:28672
v_exp_f32 v19, v159
v_cvt_pk_bf16_f32 v174, v16, v17
v_mfma_f32_16x16x32_bf16 v[88:91], v[220:223], v[160:163], v[88:91]
ds_read_b128 v[200:203], v5 offset:24576
v_dot2_f32_bf16 v14, v171, s70, v14
v_cvt_pk_bf16_f32 v175, v18, v19
v_dot2_f32_bf16 v15, v174, s70, v15
v_dot2_f32_bf16 v15, v175, s70, v15
v_mfma_f32_16x16x32_bf16 v[92:95], v[220:223], v[164:167], v[92:95]
ds_read_b128 v[204:207], v5 offset:28672
v_max3_f32 v248, v128, v129, v130
v_max3_f32 v248, v248, v131, v136
v_max3_f32 v248, v248, v137, v138
v_mfma_f32_16x16x32_bf16 v[96:99], v[224:227], v[160:163], v[96:99]
v_max_f32 v248, v248, v139
v_mov_b32 v250, v248
s_nop 1
v_permlane32_swap_b32 v248, v250
v_mfma_f32_16x16x32_bf16 v[100:103], v[224:227], v[164:167], v[100:103]
v_max_f32 v248, v248, v250
v_mov_b32 v250, v248
s_nop 1
v_permlane16_swap_b32 v248, v250
v_max_f32 v248, v248, v250
v_mfma_f32_16x16x32_bf16 v[104:107], v[228:231], v[160:163], v[104:107]
v_ceil_f32 v248, v248
v_add_f32 v248, 0x40e00000, v248
v_max3_f32 v249, v132, v133, v134
v_max3_f32 v249, v249, v135, v140
v_mfma_f32_16x16x32_bf16 v[108:111], v[228:231], v[164:167], v[108:111]
v_max3_f32 v249, v249, v141, v142
v_max_f32 v249, v249, v143
v_mov_b32 v250, v249
s_nop 1
v_permlane32_swap_b32 v249, v250
v_mfma_f32_16x16x32_bf16 v[112:115], v[232:235], v[160:163], v[112:115]
v_max_f32 v249, v249, v250
v_mov_b32 v250, v249
s_nop 1
v_permlane16_swap_b32 v249, v250
v_mfma_f32_16x16x32_bf16 v[116:119], v[232:235], v[164:167], v[116:119]
v_max_f32 v249, v249, v250
v_ceil_f32 v249, v249
v_add_f32 v249, 0x40e00000, v249
v_sub_f32 v240, 0, v248
v_mfma_f32_16x16x32_bf16 v[120:123], v[236:239], v[160:163], v[120:123]
v_sub_f32 v241, 0, v248
v_sub_f32 v242, 0, v248
v_sub_f32 v243, 0, v248
v_sub_f32 v244, 0, v249
v_sub_f32 v245, 0, v249
v_mfma_f32_16x16x32_bf16 v[124:127], v[236:239], v[164:167], v[124:127]
v_sub_f32 v246, 0, v249
v_sub_f32 v247, 0, v249
v_add_f32 v16, v14, v15
v_cmp_nge_f32 vcc, 0x41800000, v16
s_cbranch_vccnz LA_rare3
LA_back3:
s_waitcnt lgkmcnt(0)
v_mfma_f32_16x16x32_bf16 v[144:147], v[176:179], v[32:35], v[240:243]
ds_read_b64_tr_b16 v[208:209], v6 offset:8192
ds_read_b64_tr_b16 v[210:211], v6 offset:12288
v_mov_b32 v252, v14
v_mov_b32 v250, v252
s_nop 1
v_mfma_f32_16x16x32_bf16 v[148:151], v[176:179], v[36:39], v[244:247]
ds_read_b64_tr_b16 v[212:213], v7 offset:8192
ds_read_b64_tr_b16 v[214:215], v7 offset:12288
v_permlane32_swap_b32 v252, v250
v_add_f32 v252, v252, v250
v_mov_b32 v250, v252
v_mfma_f32_16x16x32_bf16 v[152:155], v[180:183], v[32:35], v[240:243]
ds_read_b64_tr_b16 v[216:217], v8 offset:8192
ds_read_b64_tr_b16 v[218:219], v8 offset:12288
s_nop 1
v_permlane16_swap_b32 v252, v250
v_add_f32 v252, v252, v250
v_mfma_f32_16x16x32_bf16 v[156:159], v[180:183], v[36:39], v[244:247]
ds_read_b64_tr_b16 v[220:221], v9 offset:8192
ds_read_b64_tr_b16 v[222:223], v9 offset:12288
v_rcp_f32 v252, v252
v_mov_b32 v14, 0
v_mov_b32 v253, v15
v_mfma_f32_16x16x32_bf16 v[144:147], v[184:187], v[40:43], v[144:147]
ds_read_b64_tr_b16 v[224:225], v10 offset:8192
ds_read_b64_tr_b16 v[226:227], v10 offset:12288
v_mov_b32 v250, v253
s_nop 1
v_mfma_f32_16x16x32_bf16 v[148:151], v[184:187], v[44:47], v[148:151]
ds_read_b64_tr_b16 v[228:229], v11 offset:8192
ds_read_b64_tr_b16 v[230:231], v11 offset:12288
v_permlane32_swap_b32 v253, v250
v_add_f32 v253, v253, v250
v_mov_b32 v250, v253
v_mfma_f32_16x16x32_bf16 v[152:155], v[188:191], v[40:43], v[152:155]
ds_read_b64_tr_b16 v[232:233], v12 offset:8192
ds_read_b64_tr_b16 v[234:235], v12 offset:12288
s_nop 1
v_permlane16_swap_b32 v253, v250
v_add_f32 v253, v253, v250
v_mfma_f32_16x16x32_bf16 v[156:159], v[188:191], v[44:47], v[156:159]
ds_read_b64_tr_b16 v[236:237], v13 offset:8192
ds_read_b64_tr_b16 v[238:239], v13 offset:12288
v_rcp_f32 v253, v253
v_mov_b32 v15, 0
v_sub_f32 v128, v128, v248
v_mfma_f32_16x16x32_bf16 v[144:147], v[192:195], v[48:51], v[144:147]
v_sub_f32 v129, v129, v248
v_sub_f32 v130, v130, v248
v_sub_f32 v131, v131, v248
v_sub_f32 v132, v132, v249
v_sub_f32 v133, v133, v249
v_mfma_f32_16x16x32_bf16 v[148:151], v[192:195], v[52:55], v[148:151]
v_sub_f32 v134, v134, v249
v_sub_f32 v135, v135, v249
v_sub_f32 v136, v136, v248
v_sub_f32 v137, v137, v248
v_sub_f32 v138, v138, v248
v_mfma_f32_16x16x32_bf16 v[152:155], v[196:199], v[48:51], v[152:155]
v_sub_f32 v139, v139, v248
v_sub_f32 v140, v140, v249
v_sub_f32 v141, v141, v249
v_sub_f32 v142, v142, v249
v_sub_f32 v143, v143, v249
v_mfma_f32_16x16x32_bf16 v[156:159], v[196:199], v[52:55], v[156:159]
v_exp_f32 v16, v128
v_exp_f32 v17, v129
v_mfma_f32_16x16x32_bf16 v[144:147], v[200:203], v[56:59], v[144:147]
v_exp_f32 v18, v130
v_exp_f32 v19, v131
v_cvt_pk_bf16_f32 v160, v16, v17
v_mfma_f32_16x16x32_bf16 v[148:151], v[200:203], v[60:63], v[148:151]
v_exp_f32 v16, v132
v_exp_f32 v17, v133
v_cvt_pk_bf16_f32 v161, v18, v19
v_mfma_f32_16x16x32_bf16 v[152:155], v[204:207], v[56:59], v[152:155]
v_dot2_f32_bf16 v24, v160, s70, v14
v_exp_f32 v18, v134
v_exp_f32 v19, v135
v_mfma_f32_16x16x32_bf16 v[156:159], v[204:207], v[60:63], v[156:159]
v_cvt_pk_bf16_f32 v164, v16, v17
v_dot2_f32_bf16 v24, v161, s70, v24
v_cvt_pk_bf16_f32 v165, v18, v19
v_dot2_f32_bf16 v25, v164, s70, v15
v_dot2_f32_bf16 v25, v165, s70, v25
s_waitcnt lgkmcnt(0)
v_mfma_f32_16x16x32_bf16 v[64:67], v[208:211], v[168:171], v[64:67]
v_exp_f32 v16, v136
v_mfma_f32_16x16x32_bf16 v[68:71], v[208:211], v[172:175], v[68:71]
v_exp_f32 v17, v137
v_mfma_f32_16x16x32_bf16 v[72:75], v[212:215], v[168:171], v[72:75]
v_exp_f32 v18, v138
v_mfma_f32_16x16x32_bf16 v[76:79], v[212:215], v[172:175], v[76:79]
v_exp_f32 v19, v139
v_cvt_pk_bf16_f32 v162, v16, v17
s_barrier
v_mfma_f32_16x16x32_bf16 v[80:83], v[216:219], v[168:171], v[80:83]
ds_read_b128 v[176:179], v2 offset:32768
v_mfma_f32_16x16x32_bf16 v[84:87], v[216:219], v[172:175], v[84:87]
ds_read_b128 v[180:183], v2 offset:36864
v_exp_f32 v16, v140
v_mfma_f32_16x16x32_bf16 v[88:91], v[220:223], v[168:171], v[88:91]
ds_read_b128 v[184:187], v3 offset:32768
v_mfma_f32_16x16x32_bf16 v[92:95], v[220:223], v[172:175], v[92:95]
ds_read_b128 v[188:191], v3 offset:36864
v_exp_f32 v17, v141
v_mfma_f32_16x16x32_bf16 v[96:99], v[224:227], v[168:171], v[96:99]
ds_read_b128 v[192:195], v4 offset:32768
v_cvt_pk_bf16_f32 v163, v18, v19
v_mfma_f32_16x16x32_bf16 v[100:103], v[224:227], v[172:175], v[100:103]
ds_read_b128 v[196:199], v4 offset:36864
v_dot2_f32_bf16 v24, v162, s70, v24
v_mfma_f32_16x16x32_bf16 v[104:107], v[228:231], v[168:171], v[104:107]
ds_read_b128 v[200:203], v5 offset:32768
v_mfma_f32_16x16x32_bf16 v[108:111], v[228:231], v[172:175], v[108:111]
ds_read_b128 v[204:207], v5 offset:36864
v_exp_f32 v18, v142
v_mfma_f32_16x16x32_bf16 v[112:115], v[232:235], v[168:171], v[112:115]
v_exp_f32 v19, v143
v_mfma_f32_16x16x32_bf16 v[116:119], v[232:235], v[172:175], v[116:119]
v_cvt_pk_bf16_f32 v166, v16, v17
v_mfma_f32_16x16x32_bf16 v[120:123], v[236:239], v[168:171], v[120:123]
v_dot2_f32_bf16 v24, v163, s70, v24
v_cvt_pk_bf16_f32 v167, v18, v19
v_mfma_f32_16x16x32_bf16 v[124:127], v[236:239], v[172:175], v[124:127]
v_dot2_f32_bf16 v25, v166, s70, v25
v_dot2_f32_bf16 v25, v167, s70, v25
s_waitcnt lgkmcnt(0)
v_mfma_f32_16x16x32_bf16 v[128:131], v[176:179], v[32:35], v[240:243]
ds_read_b64_tr_b16 v[208:209], v6 offset:16384
ds_read_b64_tr_b16 v[210:211], v6 offset:20480
v_exp_f32 v16, v144
v_exp_f32 v17, v145
v_exp_f32 v18, v146
v_exp_f32 v19, v147
v_mfma_f32_16x16x32_bf16 v[132:135], v[176:179], v[36:39], v[244:247]
ds_read_b64_tr_b16 v[212:213], v7 offset:16384
ds_read_b64_tr_b16 v[214:215], v7 offset:20480
v_cvt_pk_bf16_f32 v168, v16, v17
v_exp_f32 v16, v148
v_exp_f32 v17, v149
v_cvt_pk_bf16_f32 v169, v18, v19
v_mfma_f32_16x16x32_bf16 v[136:139], v[180:183], v[32:35], v[240:243]
ds_read_b64_tr_b16 v[216:217], v8 offset:16384
ds_read_b64_tr_b16 v[218:219], v8 offset:20480
v_dot2_f32_bf16 v14, v168, s70, v24
v_exp_f32 v18, v150
v_exp_f32 v19, v151
v_cvt_pk_bf16_f32 v172, v16, v17
v_dot2_f32_bf16 v14, v169, s70, v14
v_mfma_f32_16x16x32_bf16 v[140:143], v[180:183], v[36:39], v[244:247]
ds_read_b64_tr_b16 v[220:221], v9 offset:16384
ds_read_b64_tr_b16 v[222:223], v9 offset:20480
v_cvt_pk_bf16_f32 v173, v18, v19
v_dot2_f32_bf16 v15, v172, s70, v25
v_dot2_f32_bf16 v15, v173, s70, v15
v_mul_f32 v64, v64, v252
v_mul_f32 v65, v65, v252
v_mul_f32 v66, v66, v252
v_mul_f32 v67, v67, v252
v_mfma_f32_16x16x32_bf16 v[128:131], v[184:187], v[40:43], v[128:131]
ds_read_b64_tr_b16 v[224:225], v10 offset:16384
ds_read_b64_tr_b16 v[226:227], v10 offset:20480
v_mul_f32 v72, v72, v252
v_mul_f32 v73, v73, v252
v_mul_f32 v74, v74, v252
v_mul_f32 v75, v75, v252
v_cvt_pk_bf16_f32 v64, v64, v65
v_cvt_pk_bf16_f32 v65, v66, v67
v_cvt_pk_bf16_f32 v66, v72, v73
v_mfma_f32_16x16x32_bf16 v[132:135], v[184:187], v[44:47], v[132:135]
ds_read_b64_tr_b16 v[228:229], v11 offset:16384
ds_read_b64_tr_b16 v[230:231], v11 offset:20480
v_cvt_pk_bf16_f32 v67, v74, v75
ds_write_b128 v29, v[64:67] offset:0
v_mul_f32 v68, v68, v253
v_mul_f32 v69, v69, v253
v_mul_f32 v70, v70, v253
v_mul_f32 v71, v71, v253
v_mul_f32 v76, v76, v253
v_mfma_f32_16x16x32_bf16 v[136:139], v[188:191], v[40:43], v[136:139]
ds_read_b64_tr_b16 v[232:233], v12 offset:16384
ds_read_b64_tr_b16 v[234:235], v12 offset:20480
v_mul_f32 v77, v77, v253
v_mul_f32 v78, v78, v253
v_mul_f32 v79, v79, v253
v_cvt_pk_bf16_f32 v68, v68, v69
v_cvt_pk_bf16_f32 v69, v70, v71
v_cvt_pk_bf16_f32 v70, v76, v77
v_cvt_pk_bf16_f32 v71, v78, v79
v_mfma_f32_16x16x32_bf16 v[140:143], v[188:191], v[44:47], v[140:143]
ds_read_b64_tr_b16 v[236:237], v13 offset:16384
ds_read_b64_tr_b16 v[238:239], v13 offset:20480
ds_write_b128 v29, v[68:71] offset:1024
v_mul_f32 v80, v80, v252
v_mul_f32 v81, v81, v252
v_mul_f32 v82, v82, v252
v_mul_f32 v83, v83, v252
v_mul_f32 v88, v88, v252
v_mul_f32 v89, v89, v252
v_mfma_f32_16x16x32_bf16 v[128:131], v[192:195], v[48:51], v[128:131]
v_mul_f32 v90, v90, v252
v_mul_f32 v91, v91, v252
v_cvt_pk_bf16_f32 v80, v80, v81
v_cvt_pk_bf16_f32 v81, v82, v83
v_cvt_pk_bf16_f32 v82, v88, v89
v_cvt_pk_bf16_f32 v83, v90, v91
ds_write_b128 v29, v[80:83] offset:2048
v_mul_f32 v84, v84, v253
v_mul_f32 v85, v85, v253
v_mfma_f32_16x16x32_bf16 v[132:135], v[192:195], v[52:55], v[132:135]
v_mul_f32 v86, v86, v253
v_mul_f32 v87, v87, v253
v_mul_f32 v92, v92, v253
v_mul_f32 v93, v93, v253
v_mul_f32 v94, v94, v253
v_mul_f32 v95, v95, v253
v_cvt_pk_bf16_f32 v84, v84, v85
v_cvt_pk_bf16_f32 v85, v86, v87
v_cvt_pk_bf16_f32 v86, v92, v93
v_mfma_f32_16x16x32_bf16 v[136:139], v[196:199], v[48:51], v[136:139]
v_cvt_pk_bf16_f32 v87, v94, v95
ds_write_b128 v29, v[84:87] offset:3072
v_mul_f32 v96, v96, v252
v_mul_f32 v97, v97, v252
v_mul_f32 v98, v98, v252
v_mul_f32 v99, v99, v252
v_mul_f32 v104, v104, v252
v_mul_f32 v105, v105, v252
v_mul_f32 v106, v106, v252
v_mfma_f32_16x16x32_bf16 v[140:143], v[196:199], v[52:55], v[140:143]
v_mul_f32 v107, v107, v252
v_cvt_pk_bf16_f32 v96, v96, v97
v_cvt_pk_bf16_f32 v97, v98, v99
v_cvt_pk_bf16_f32 v98, v104, v105
v_cvt_pk_bf16_f32 v99, v106, v107
ds_write_b128 v29, v[96:99] offset:4096
v_mul_f32 v100, v100, v253
v_mul_f32 v101, v101, v253
v_mul_f32 v102, v102, v253
v_mfma_f32_16x16x32_bf16 v[128:131], v[200:203], v[56:59], v[128:131]
v_mul_f32 v103, v103, v253
v_mul_f32 v108, v108, v253
v_mul_f32 v109, v109, v253
v_mul_f32 v110, v110, v253
v_mul_f32 v111, v111, v253
v_cvt_pk_bf16_f32 v100, v100, v101
v_cvt_pk_bf16_f32 v101, v102, v103
v_cvt_pk_bf16_f32 v102, v108, v109
v_cvt_pk_bf16_f32 v103, v110, v111
v_mfma_f32_16x16x32_bf16 v[132:135], v[200:203], v[60:63], v[132:135]
ds_write_b128 v29, v[100:103] offset:5120
v_mul_f32 v112, v112, v252
v_mul_f32 v113, v113, v252
v_mul_f32 v114, v114, v252
v_mul_f32 v115, v115, v252
v_mul_f32 v120, v120, v252
v_mul_f32 v121, v121, v252
v_mul_f32 v122, v122, v252
v_mul_f32 v123, v123, v252
v_mfma_f32_16x16x32_bf16 v[136:139], v[204:207], v[56:59], v[136:139]
v_cvt_pk_bf16_f32 v112, v112, v113
v_cvt_pk_bf16_f32 v113, v114, v115
v_cvt_pk_bf16_f32 v114, v120, v121
v_cvt_pk_bf16_f32 v115, v122, v123
ds_write_b128 v29, v[112:115] offset:6144
v_mul_f32 v116, v116, v253
v_mul_f32 v117, v117, v253
v_mul_f32 v118, v118, v253
v_mul_f32 v119, v119, v253
v_mfma_f32_16x16x32_bf16 v[140:143], v[204:207], v[60:63], v[140:143]
v_mul_f32 v124, v124, v253
v_mul_f32 v125, v125, v253
v_mul_f32 v126, v126, v253
v_mul_f32 v127, v127, v253
v_cvt_pk_bf16_f32 v116, v116, v117
v_cvt_pk_bf16_f32 v117, v118, v119
v_cvt_pk_bf16_f32 v118, v124, v125
v_cvt_pk_bf16_f32 v119, v126, v127
ds_write_b128 v29, v[116:119] offset:7168
s_xor_b32 s37, s4, s34
s_and_b32 s36, s37, 1
s_lshl_b32 s36, s36, 13
s_lshr_b32 s37, s37, 1
s_mul_i32 s37, s37, 4294901760
s_add_u32 s36, s36, s37
s_add_u32 s36, s36, 81920
v_add_u32 v29, s36, v20
s_mov_b64 exec, 0x111
buffer_load_dword v27, v28, s[24:27], 0 offen offset:32 sc1
s_mov_b64 exec, -1
s_waitcnt lgkmcnt(0)
v_mfma_f32_16x16x32_bf16 v[64:67], v[208:211], v[160:163], 0
ds_read_b128 v[176:179], v2 offset:40960
v_exp_f32 v16, v152
v_mfma_f32_16x16x32_bf16 v[68:71], v[208:211], v[164:167], 0
ds_read_b128 v[180:183], v2 offset:45056
v_mfma_f32_16x16x32_bf16 v[72:75], v[212:215], v[160:163], 0
ds_read_b128 v[184:187], v3 offset:40960
v_exp_f32 v17, v153
v_mfma_f32_16x16x32_bf16 v[76:79], v[212:215], v[164:167], 0
ds_read_b128 v[188:191], v3 offset:45056
v_mfma_f32_16x16x32_bf16 v[80:83], v[216:219], v[160:163], 0
ds_read_b128 v[192:195], v4 offset:40960
v_exp_f32 v18, v154
v_mfma_f32_16x16x32_bf16 v[84:87], v[216:219], v[164:167], 0
ds_read_b128 v[196:199], v4 offset:45056
v_mfma_f32_16x16x32_bf16 v[88:91], v[220:223], v[160:163], 0
ds_read_b128 v[200:203], v5 offset:40960
v_exp_f32 v19, v155
v_mfma_f32_16x16x32_bf16 v[92:95], v[220:223], v[164:167], 0
ds_read_b128 v[204:207], v5 offset:45056
v_cvt_pk_bf16_f32 v170, v16, v17
v_mfma_f32_16x16x32_bf16 v[96:99], v[224:227], v[160:163], 0
v_exp_f32 v16, v156
v_mfma_f32_16x16x32_bf16 v[100:103], v[224:227], v[164:167], 0
v_exp_f32 v17, v157
v_mfma_f32_16x16x32_bf16 v[104:107], v[228:231], v[160:163], 0
v_cvt_pk_bf16_f32 v171, v18, v19
v_dot2_f32_bf16 v14, v170, s70, v14
v_mfma_f32_16x16x32_bf16 v[108:111], v[228:231], v[164:167], 0
v_exp_f32 v18, v158
v_mfma_f32_16x16x32_bf16 v[112:115], v[232:235], v[160:163], 0
v_exp_f32 v19, v159
v_cvt_pk_bf16_f32 v174, v16, v17
v_mfma_f32_16x16x32_bf16 v[116:119], v[232:235], v[164:167], 0
v_dot2_f32_bf16 v14, v171, s70, v14
v_cvt_pk_bf16_f32 v175, v18, v19
v_mfma_f32_16x16x32_bf16 v[120:123], v[236:239], v[160:163], 0
v_dot2_f32_bf16 v15, v174, s70, v15
v_dot2_f32_bf16 v15, v175, s70, v15
v_mfma_f32_16x16x32_bf16 v[124:127], v[236:239], v[164:167], 0
s_nop 1
v_add_f32 v16, v14, v15
v_cmp_nge_f32 vcc, 0x41800000, v16
s_cbranch_vccnz LA_rare1_1
s_branch LA_back1_1
s_waitcnt lgkmcnt(0)
LA_last:
s_waitcnt vmcnt(0)
v_mfma_f32_16x16x32_bf16 v[64:67], v[208:211], v[168:171], v[64:67]
v_exp_f32 v16, v136
v_mfma_f32_16x16x32_bf16 v[68:71], v[208:211], v[172:175], v[68:71]
v_exp_f32 v17, v137
v_mfma_f32_16x16x32_bf16 v[72:75], v[212:215], v[168:171], v[72:75]
v_mfma_f32_16x16x32_bf16 v[76:79], v[212:215], v[172:175], v[76:79]
v_exp_f32 v18, v138
v_mfma_f32_16x16x32_bf16 v[80:83], v[216:219], v[168:171], v[80:83]
v_exp_f32 v19, v139
v_mfma_f32_16x16x32_bf16 v[84:87], v[216:219], v[172:175], v[84:87]
v_cvt_pk_bf16_f32 v162, v16, v17
v_mfma_f32_16x16x32_bf16 v[88:91], v[220:223], v[168:171], v[88:91]
v_exp_f32 v16, v140
v_mfma_f32_16x16x32_bf16 v[92:95], v[220:223], v[172:175], v[92:95]
v_exp_f32 v17, v141
v_mfma_f32_16x16x32_bf16 v[96:99], v[224:227], v[168:171], v[96:99]
v_cvt_pk_bf16_f32 v163, v18, v19
v_dot2_f32_bf16 v24, v162, s70, v24
v_mfma_f32_16x16x32_bf16 v[100:103], v[224:227], v[172:175], v[100:103]
v_exp_f32 v18, v142
v_mfma_f32_16x16x32_bf16 v[104:107], v[228:231], v[168:171], v[104:107]
v_mfma_f32_16x16x32_bf16 v[108:111], v[228:231], v[172:175], v[108:111]
v_exp_f32 v19, v143
v_cvt_pk_bf16_f32 v166, v16, v17
v_mfma_f32_16x16x32_bf16 v[112:115], v[232:235], v[168:171], v[112:115]
v_dot2_f32_bf16 v24, v163, s70, v24
v_mfma_f32_16x16x32_bf16 v[116:119], v[232:235], v[172:175], v[116:119]
v_cvt_pk_bf16_f32 v167, v18, v19
v_dot2_f32_bf16 v25, v166, s70, v25
v_mfma_f32_16x16x32_bf16 v[120:123], v[236:239], v[168:171], v[120:123]
v_dot2_f32_bf16 v25, v167, s70, v25
v_mfma_f32_16x16x32_bf16 v[124:127], v[236:239], v[172:175], v[124:127]
s_nop 1
v_add_f32 v16, v24, v25
v_cmp_nge_f32 vcc, 0x41800000, v16
s_cbranch_vccnz LA_rare4
LA_back4:
v_exp_f32 v16, v144
v_exp_f32 v17, v145
v_exp_f32 v18, v146
v_exp_f32 v19, v147
v_cvt_pk_bf16_f32 v168, v16, v17
v_exp_f32 v16, v148
v_exp_f32 v17, v149
v_cvt_pk_bf16_f32 v169, v18, v19
v_dot2_f32_bf16 v14, v168, s70, v24
v_exp_f32 v18, v150
v_exp_f32 v19, v151
v_cvt_pk_bf16_f32 v172, v16, v17
v_dot2_f32_bf16 v14, v169, s70, v14
v_cvt_pk_bf16_f32 v173, v18, v19
v_dot2_f32_bf16 v15, v172, s70, v25
v_dot2_f32_bf16 v15, v173, s70, v15
v_exp_f32 v16, v152
v_exp_f32 v17, v153
v_exp_f32 v18, v154
v_exp_f32 v19, v155
v_cvt_pk_bf16_f32 v170, v16, v17
v_exp_f32 v16, v156
v_exp_f32 v17, v157
v_cvt_pk_bf16_f32 v171, v18, v19
v_dot2_f32_bf16 v14, v170, s70, v14
v_exp_f32 v18, v158
v_exp_f32 v19, v159
v_cvt_pk_bf16_f32 v174, v16, v17
v_dot2_f32_bf16 v14, v171, s70, v14
v_cvt_pk_bf16_f32 v175, v18, v19
v_dot2_f32_bf16 v15, v174, s70, v15
v_dot2_f32_bf16 v15, v175, s70, v15
s_nop 2
v_add_f32 v16, v14, v15
v_cmp_nge_f32 vcc, 0x41800000, v16
s_cbranch_vccnz LA_rare2
LA_back2:
v_mov_b32 v16, v14
s_nop 1
v_permlane32_swap_b32 v14, v16
v_add_f32 v14, v14, v16
v_mov_b32 v16, v14
s_nop 1
v_permlane16_swap_b32 v14, v16
v_add_f32 v14, v14, v16
v_rcp_f32 v14, v14
v_mov_b32 v16, v15
s_nop 1
v_permlane32_swap_b32 v15, v16
v_add_f32 v15, v15, v16
v_mov_b32 v16, v15
s_nop 1
v_permlane16_swap_b32 v15, v16
v_add_f32 v15, v15, v16
v_rcp_f32 v15, v15
s_getreg_b32 s36, hwreg(HW_REG_XCC_ID, 0, 4)
s_lshl_b32 s37, s7, 4
s_or_b32 s37, s37, s36
s_mov_b64 exec, 0x111
v_cmp_ne_u32 vcc, s37, v27
s_mov_b64 exec, -1
s_cmp_eq_u64 vcc, 0
s_cselect_b32 s35, 1, 0
s_lshl_b32 s36, s32, 5
s_add_u32 s36, s36, s33
s_add_u32 s36, s36, 1
s_lshl_b32 s36, s36, 2
s_add_u32 s36, s36, s4
s_lshl_b32 s80, s36, 13
s_add_u32 s81, s80, 4096
s_barrier
ds_read_b64_tr_b16 v[208:209], v6 offset:16384
ds_read_b64_tr_b16 v[210:211], v6 offset:20480
ds_read_b64_tr_b16 v[176:177], v6 offset:24576
ds_read_b64_tr_b16 v[178:179], v6 offset:28672
ds_read_b64_tr_b16 v[212:213], v7 offset:16384
ds_read_b64_tr_b16 v[214:215], v7 offset:20480
ds_read_b64_tr_b16 v[180:181], v7 offset:24576
ds_read_b64_tr_b16 v[182:183], v7 offset:28672
ds_read_b64_tr_b16 v[216:217], v8 offset:16384
ds_read_b64_tr_b16 v[218:219], v8 offset:20480
ds_read_b64_tr_b16 v[184:185], v8 offset:24576
ds_read_b64_tr_b16 v[186:187], v8 offset:28672
s_waitcnt lgkmcnt(10)
v_mfma_f32_16x16x32_bf16 v[64:67], v[208:211], v[160:163], v[64:67]
ds_read_b64_tr_b16 v[220:221], v9 offset:16384
ds_read_b64_tr_b16 v[222:223], v9 offset:20480
v_mfma_f32_16x16x32_bf16 v[68:71], v[208:211], v[164:167], v[68:71]
ds_read_b64_tr_b16 v[188:189], v9 offset:24576
ds_read_b64_tr_b16 v[190:191], v9 offset:28672
s_waitcnt lgkmcnt(12)
v_mfma_f32_16x16x32_bf16 v[64:67], v[176:179], v[168:171], v[64:67]
ds_read_b64_tr_b16 v[224:225], v10 offset:16384
ds_read_b64_tr_b16 v[226:227], v10 offset:20480
v_mfma_f32_16x16x32_bf16 v[68:71], v[176:179], v[172:175], v[68:71]
ds_read_b64_tr_b16 v[192:193], v10 offset:24576
ds_read_b64_tr_b16 v[194:195], v10 offset:28672
s_waitcnt lgkmcnt(14)
v_mfma_f32_16x16x32_bf16 v[72:75], v[212:215], v[160:163], v[72:75]
ds_read_b64_tr_b16 v[228:229], v11 offset:16384
ds_read_b64_tr_b16 v[230:231], v11 offset:20480
v_mfma_f32_16x16x32_bf16 v[76:79], v[212:215], v[164:167], v[76:79]
ds_read_b64_tr_b16 v[196:197], v11 offset:24576
ds_read_b64_tr_b16 v[198:199], v11 offset:28672
s_waitcnt lgkmcnt(15)
v_mfma_f32_16x16x32_bf16 v[72:75], v[180:183], v[168:171], v[72:75]
ds_read_b64_tr_b16 v[232:233], v12 offset:16384
ds_read_b64_tr_b16 v[234:235], v12 offset:20480
v_mfma_f32_16x16x32_bf16 v[76:79], v[180:183], v[172:175], v[76:79]
ds_read_b64_tr_b16 v[200:201], v12 offset:24576
ds_read_b64_tr_b16 v[202:203], v12 offset:28672
s_waitcnt lgkmcnt(15)
v_mfma_f32_16x16x32_bf16 v[80:83], v[216:219], v[160:163], v[80:83]
ds_read_b64_tr_b16 v[236:237], v13 offset:16384
ds_read_b64_tr_b16 v[238:239], v13 offset:20480
v_mfma_f32_16x16x32_bf16 v[84:87], v[216:219], v[164:167], v[84:87]
ds_read_b64_tr_b16 v[204:205], v13 offset:24576
ds_read_b64_tr_b16 v[206:207], v13 offset:28672
s_waitcnt lgkmcnt(15)
v_mfma_f32_16x16x32_bf16 v[80:83], v[184:187], v[168:171], v[80:83]
v_mul_f32 v64, v64, v14
v_mul_f32 v65, v65, v14
v_mul_f32 v66, v66, v14
v_mfma_f32_16x16x32_bf16 v[84:87], v[184:187], v[172:175], v[84:87]
v_mul_f32 v67, v67, v14
v_mul_f32 v72, v72, v14
v_mul_f32 v73, v73, v14
s_waitcnt lgkmcnt(15)
v_mfma_f32_16x16x32_bf16 v[88:91], v[220:223], v[160:163], v[88:91]
v_mul_f32 v74, v74, v14
v_mul_f32 v75, v75, v14
v_cvt_pk_bf16_f32 v64, v64, v65
v_mfma_f32_16x16x32_bf16 v[92:95], v[220:223], v[164:167], v[92:95]
v_cvt_pk_bf16_f32 v65, v66, v67
v_cvt_pk_bf16_f32 v66, v72, v73
v_cvt_pk_bf16_f32 v67, v74, v75
ds_write_b128 v29, v[64:67] offset:0
s_waitcnt lgkmcnt(15)
v_mfma_f32_16x16x32_bf16 v[88:91], v[188:191], v[168:171], v[88:91]
v_mul_f32 v68, v68, v15
v_mul_f32 v69, v69, v15
v_mul_f32 v70, v70, v15
v_mfma_f32_16x16x32_bf16 v[92:95], v[188:191], v[172:175], v[92:95]
v_mul_f32 v71, v71, v15
v_mul_f32 v76, v76, v15
v_mul_f32 v77, v77, v15
s_waitcnt lgkmcnt(15)
v_mfma_f32_16x16x32_bf16 v[96:99], v[224:227], v[160:163], v[96:99]
v_mul_f32 v78, v78, v15
v_mul_f32 v79, v79, v15
v_cvt_pk_bf16_f32 v68, v68, v69
v_mfma_f32_16x16x32_bf16 v[100:103], v[224:227], v[164:167], v[100:103]
v_cvt_pk_bf16_f32 v69, v70, v71
v_cvt_pk_bf16_f32 v70, v76, v77
v_cvt_pk_bf16_f32 v71, v78, v79
ds_write_b128 v29, v[68:71] offset:1024
s_waitcnt lgkmcnt(14)
v_mfma_f32_16x16x32_bf16 v[96:99], v[192:195], v[168:171], v[96:99]
v_mul_f32 v80, v80, v14
v_mul_f32 v81, v81, v14
v_mul_f32 v82, v82, v14
v_mfma_f32_16x16x32_bf16 v[100:103], v[192:195], v[172:175], v[100:103]
v_mul_f32 v83, v83, v14
v_mul_f32 v88, v88, v14
v_mul_f32 v89, v89, v14
s_waitcnt lgkmcnt(12)
v_mfma_f32_16x16x32_bf16 v[104:107], v[228:231], v[160:163], v[104:107]
v_mul_f32 v90, v90, v14
v_mul_f32 v91, v91, v14
v_cvt_pk_bf16_f32 v80, v80, v81
v_mfma_f32_16x16x32_bf16 v[108:111], v[228:231], v[164:167], v[108:111]
v_cvt_pk_bf16_f32 v81, v82, v83
v_cvt_pk_bf16_f32 v82, v88, v89
v_cvt_pk_bf16_f32 v83, v90, v91
ds_write_b128 v29, v[80:83] offset:2048
s_waitcnt lgkmcnt(11)
v_mfma_f32_16x16x32_bf16 v[104:107], v[196:199], v[168:171], v[104:107]
v_mul_f32 v84, v84, v15
v_mul_f32 v85, v85, v15
v_mul_f32 v86, v86, v15
v_mfma_f32_16x16x32_bf16 v[108:111], v[196:199], v[172:175], v[108:111]
v_mul_f32 v87, v87, v15
v_mul_f32 v92, v92, v15
v_mul_f32 v93, v93, v15
s_waitcnt lgkmcnt(9)
v_mfma_f32_16x16x32_bf16 v[112:115], v[232:235], v[160:163], v[112:115]
v_mul_f32 v94, v94, v15
v_mul_f32 v95, v95, v15
v_cvt_pk_bf16_f32 v84, v84, v85
v_mfma_f32_16x16x32_bf16 v[116:119], v[232:235], v[164:167], v[116:119]
v_cvt_pk_bf16_f32 v85, v86, v87
v_cvt_pk_bf16_f32 v86, v92, v93
v_cvt_pk_bf16_f32 v87, v94, v95
ds_write_b128 v29, v[84:87] offset:3072
s_waitcnt lgkmcnt(8)
v_mfma_f32_16x16x32_bf16 v[112:115], v[200:203], v[168:171], v[112:115]
v_mul_f32 v96, v96, v14
v_mul_f32 v97, v97, v14
v_mfma_f32_16x16x32_bf16 v[116:119], v[200:203], v[172:175], v[116:119]
v_mul_f32 v98, v98, v14
v_mul_f32 v99, v99, v14
s_waitcnt lgkmcnt(6)
v_mfma_f32_16x16x32_bf16 v[120:123], v[236:239], v[160:163], v[120:123]
v_mul_f32 v104, v104, v14
v_mul_f32 v105, v105, v14
v_mfma_f32_16x16x32_bf16 v[124:127], v[236:239], v[164:167], v[124:127]
v_mul_f32 v106, v106, v14
v_mul_f32 v107, v107, v14
s_waitcnt lgkmcnt(4)
v_mfma_f32_16x16x32_bf16 v[120:123], v[204:207], v[168:171], v[120:123]
v_cvt_pk_bf16_f32 v96, v96, v97
v_cvt_pk_bf16_f32 v97, v98, v99
v_mfma_f32_16x16x32_bf16 v[124:127], v[204:207], v[172:175], v[124:127]
v_cvt_pk_bf16_f32 v98, v104, v105
v_cvt_pk_bf16_f32 v99, v106, v107
ds_write_b128 v29, v[96:99] offset:4096
v_mul_f32 v100, v100, v15
v_mul_f32 v101, v101, v15
v_mul_f32 v102, v102, v15
v_mul_f32 v103, v103, v15
v_mul_f32 v108, v108, v15
v_mul_f32 v109, v109, v15
v_mul_f32 v110, v110, v15
v_mul_f32 v111, v111, v15
v_cvt_pk_bf16_f32 v100, v100, v101
v_cvt_pk_bf16_f32 v101, v102, v103
v_cvt_pk_bf16_f32 v102, v108, v109
v_cvt_pk_bf16_f32 v103, v110, v111
ds_write_b128 v29, v[100:103] offset:5120
v_mul_f32 v112, v112, v14
v_mul_f32 v113, v113, v14
v_mul_f32 v114, v114, v14
v_mul_f32 v115, v115, v14
v_mul_f32 v120, v120, v14
v_mul_f32 v121, v121, v14
v_mul_f32 v122, v122, v14
v_mul_f32 v123, v123, v14
v_cvt_pk_bf16_f32 v112, v112, v113
v_cvt_pk_bf16_f32 v113, v114, v115
v_cvt_pk_bf16_f32 v114, v120, v121
v_cvt_pk_bf16_f32 v115, v122, v123
ds_write_b128 v29, v[112:115] offset:6144
v_mul_f32 v116, v116, v15
v_mul_f32 v117, v117, v15
v_mul_f32 v118, v118, v15
v_mul_f32 v119, v119, v15
v_mul_f32 v124, v124, v15
v_mul_f32 v125, v125, v15
v_mul_f32 v126, v126, v15
v_mul_f32 v127, v127, v15
v_cvt_pk_bf16_f32 v116, v116, v117
v_cvt_pk_bf16_f32 v117, v118, v119
v_cvt_pk_bf16_f32 v118, v124, v125
v_cvt_pk_bf16_f32 v119, v126, v127
ds_write_b128 v29, v[116:119] offset:7168
s_waitcnt lgkmcnt(0)
s_barrier
s_lshl_b32 s36, s32, 5
s_add_u32 s36, s36, s33
s_add_u32 s36, s36, 1
s_lshl_b32 s36, s36, 2
s_add_u32 s36, s36, s4
s_lshl_b32 s36, s36, 13
s_add_u32 s37, s36, 4096
LA_pub_s:
buffer_store_dwordx4 v[64:67], v20, s[24:27], s36 offen offset:0 sc1
buffer_store_dwordx4 v[68:71], v20, s[24:27], s36 offen offset:1024 sc1
buffer_store_dwordx4 v[80:83], v20, s[24:27], s36 offen offset:2048 sc1
buffer_store_dwordx4 v[84:87], v20, s[24:27], s36 offen offset:3072 sc1
buffer_store_dwordx4 v[96:99], v20, s[24:27], s37 offen offset:0 sc1
buffer_store_dwordx4 v[100:103], v20, s[24:27], s37 offen offset:1024 sc1
buffer_store_dwordx4 v[112:115], v20, s[24:27], s37 offen offset:2048 sc1
buffer_store_dwordx4 v[116:119], v20, s[24:27], s37 offen offset:3072 sc1
LA_pub_e:
s_barrier
s_and_b32 s36, s4, 1
s_lshl_b32 s36, s36, 13
s_lshr_b32 s37, s4, 1
s_mul_i32 s37, s37, 4294901760
s_add_u32 s36, s36, s37
s_add_u32 m0, s36, 81920
s_add_u32 s37, s85, 0
buffer_load_dwordx4 v20, s[24:27], s37 offen offset:0 sc1 lds
buffer_load_dwordx4 v20, s[24:27], s37 offen offset:1024 sc1 lds
buffer_load_dwordx4 v20, s[24:27], s37 offen offset:2048 sc1 lds
buffer_load_dwordx4 v20, s[24:27], s37 offen offset:3072 sc1 lds
s_add_u32 m0, m0, 4096
s_add_u32 s37, s37, 4096
buffer_load_dwordx4 v20, s[24:27], s37 offen offset:0 sc1 lds
buffer_load_dwordx4 v20, s[24:27], s37 offen offset:1024 sc1 lds
buffer_load_dwordx4 v20, s[24:27], s37 offen offset:2048 sc1 lds
buffer_load_dwordx4 v20, s[24:27], s37 offen offset:3072 sc1 lds
s_and_b32 s36, s4, 1
s_lshl_b32 s36, s36, 13
s_lshr_b32 s37, s4, 1
s_mul_i32 s37, s37, 49152
s_add_u32 s36, s36, s37
s_add_u32 m0, s36, 49152
s_add_u32 s37, s86, 0
buffer_load_dwordx4 v20, s[24:27], s37 offen offset:0 sc1 lds
buffer_load_dwordx4 v20, s[24:27], s37 offen offset:1024 sc1 lds
buffer_load_dwordx4 v20, s[24:27], s37 offen offset:2048 sc1 lds
buffer_load_dwordx4 v20, s[24:27], s37 offen offset:3072 sc1 lds
s_add_u32 m0, m0, 4096
s_add_u32 s37, s37, 4096
buffer_load_dwordx4 v20, s[24:27], s37 offen offset:0 sc1 lds
buffer_load_dwordx4 v20, s[24:27], s37 offen offset:1024 sc1 lds
buffer_load_dwordx4 v20, s[24:27], s37 offen offset:2048 sc1 lds
buffer_load_dwordx4 v20, s[24:27], s37 offen offset:3072 sc1 lds
s_waitcnt vmcnt(16)
s_lshl_b32 s38, s2, 7
s_lshl_b32 s39, s4, 2
s_add_u32 s38, s38, s39
s_add_u32 s38, s38, 33554448
v_mov_b32 v16, s7
v_mov_b32 v17, 0
s_mov_b64 exec, 1
s_cmp_eq_u32 s35, 0
s_cbranch_scc1 LA_fl_s
buffer_store_dword v16, v17, s[24:27], s38 offen
s_branch LA_fl_e
LA_fl_s:
buffer_store_dword v16, v17, s[24:27], s38 offen sc1
LA_fl_e:
s_mov_b64 exec, -1
s_waitcnt vmcnt(1)
s_barrier
LA_q1:
s_mov_b64 exec, 0xfff
buffer_load_dword v26, v28, s[24:27], 0 offen offset:16 sc1
s_waitcnt vmcnt(0)
v_cmp_ne_u32 vcc, s7, v26
s_mov_b64 exec, -1
s_cbranch_vccnz LA_q1
s_and_b32 s36, s4, 1
s_lshl_b32 s36, s36, 13
s_lshr_b32 s37, s4, 1
s_mul_i32 s37, s37, 81920
s_add_u32 s36, s36, s37
s_add_u32 m0, s36, 65536
s_add_u32 s37, s84, 32768
buffer_load_dwordx4 v20, s[24:27], s37 offen offset:0 sc1 lds
buffer_load_dwordx4 v20, s[24:27], s37 offen offset:1024 sc1 lds
buffer_load_dwordx4 v20, s[24:27], s37 offen offset:2048 sc1 lds
buffer_load_dwordx4 v20, s[24:27], s37 offen offset:3072 sc1 lds
s_add_u32 m0, m0, 4096
s_add_u32 s37, s37, 4096
buffer_load_dwordx4 v20, s[24:27], s37 offen offset:0 sc1 lds
buffer_load_dwordx4 v20, s[24:27], s37 offen offset:1024 sc1 lds
buffer_load_dwordx4 v20, s[24:27], s37 offen offset:2048 sc1 lds
buffer_load_dwordx4 v20, s[24:27], s37 offen offset:3072 sc1 lds
s_and_b32 s36, s4, 1
s_lshl_b32 s36, s36, 13
s_lshr_b32 s37, s4, 1
s_mul_i32 s37, s37, 98304
s_add_u32 s36, s36, s37
s_add_u32 m0, s36, 32768
s_add_u32 s37, s85, 32768
buffer_load_dwordx4 v20, s[24:27], s37 offen offset:0 sc1 lds
buffer_load_dwordx4 v20, s[24:27], s37 offen offset:1024 sc1 lds
buffer_load_dwordx4 v20, s[24:27], s37 offen offset:2048 sc1 lds
buffer_load_dwordx4 v20, s[24:27], s37 offen offset:3072 sc1 lds
s_add_u32 m0, m0, 4096
s_add_u32 s37, s37, 4096
buffer_load_dwordx4 v20, s[24:27], s37 offen offset:0 sc1 lds
buffer_load_dwordx4 v20, s[24:27], s37 offen offset:1024 sc1 lds
buffer_load_dwordx4 v20, s[24:27], s37 offen offset:2048 sc1 lds
buffer_load_dwordx4 v20, s[24:27], s37 offen offset:3072 sc1 lds
s_waitcnt vmcnt(0)
s_barrier
s_and_b32 s36, s4, 1
s_lshl_b32 s36, s36, 13
s_lshr_b32 s37, s4, 1
s_mul_i32 s37, s37, 4294901760
s_add_u32 s36, s36, s37
s_add_u32 m0, s36, 81920
s_add_u32 s37, s86, 32768
buffer_load_dwordx4 v20, s[24:27], s37 offen offset:0 sc1 lds
buffer_load_dwordx4 v20, s[24:27], s37 offen offset:1024 sc1 lds
buffer_load_dwordx4 v20, s[24:27], s37 offen offset:2048 sc1 lds
buffer_load_dwordx4 v20, s[24:27], s37 offen offset:3072 sc1 lds
s_add_u32 m0, m0, 4096
s_add_u32 s37, s37, 4096
buffer_load_dwordx4 v20, s[24:27], s37 offen offset:0 sc1 lds
buffer_load_dwordx4 v20, s[24:27], s37 offen offset:1024 sc1 lds
buffer_load_dwordx4 v20, s[24:27], s37 offen offset:2048 sc1 lds
buffer_load_dwordx4 v20, s[24:27], s37 offen offset:3072 sc1 lds
s_waitcnt vmcnt(0)
s_barrier
s_or_b32 s36, s2, s4
s_cmp_lg_u32 s36, 0
s_cbranch_scc1 LA_fin
v_lshlrev_b32 v2, 7, v1
s_and_b32 s38, s7, 0xfffffff
LA_p3:
s_mov_b32 s36, 33554432
buffer_load_dword v8, v2, s[24:27], s36 offen offset:32 sc1
s_mov_b32 s36, 33562624
buffer_load_dword v9, v2, s[24:27], s36 offen offset:32 sc1
s_mov_b32 s36, 33570816
buffer_load_dword v10, v2, s[24:27], s36 offen offset:32 sc1
s_mov_b32 s36, 33579008
buffer_load_dword v11, v2, s[24:27], s36 offen offset:32 sc1
s_mov_b64 s[36:37], 0
s_waitcnt vmcnt(3)
v_lshrrev_b32 v8, 4, v8
v_cmp_ne_u32 vcc, s38, v8
s_or_b64 s[36:37], s[36:37], vcc
s_waitcnt vmcnt(2)
v_lshrrev_b32 v9, 4, v9
v_cmp_ne_u32 vcc, s38, v9
s_or_b64 s[36:37], s[36:37], vcc
s_waitcnt vmcnt(1)
v_lshrrev_b32 v10, 4, v10
v_cmp_ne_u32 vcc, s38, v10
s_or_b64 s[36:37], s[36:37], vcc
s_waitcnt vmcnt(0)
v_lshrrev_b32 v11, 4, v11
v_cmp_ne_u32 vcc, s38, v11
s_or_b64 s[36:37], s[36:37], vcc
s_cmp_lg_u64 s[36:37], 0
s_cbranch_scc1 LA_p3
v_mov_b32 v2, 0
v_mov_b32 v3, s7
s_mov_b32 s36, 33619968
s_mov_b64 exec, 1
buffer_store_dword v3, v2, s[24:27], s36 offen sc1
s_mov_b64 exec, -1
LA_fin:
s_endpgm
LA_rare0_0:
s_mov_b32 s72, 0
s_branch LA_rare0b
LA_rare0_1:
s_mov_b32 s72, 1
s_branch LA_rare0b
LA_rare0_2:
s_mov_b32 s72, 2
s_branch LA_rare0b
LA_rare4:
s_mov_b32 s72, 3
LA_rare0b:
s_waitcnt lgkmcnt(0)
v_max3_f32 v16, v128, v129, v130
v_max3_f32 v16, v16, v131, v136
v_max3_f32 v16, v16, v137, v138
v_max_f32 v16, v16, v139
v_log_f32 v18, v14
s_nop 0
v_add_f32 v18, 0xc1000000, v18
v_max_f32 v16, v16, v18
v_mov_b32 v18, v16
s_nop 1
v_permlane32_swap_b32 v16, v18
v_max_f32 v16, v16, v18
v_mov_b32 v18, v16
s_nop 1
v_permlane16_swap_b32 v16, v18
v_max_f32 v16, v16, v18
v_ceil_f32 v16, v16
v_add_f32 v16, 0x40e00000, v16
v_max3_f32 v17, v132, v133, v134
v_max3_f32 v17, v17, v135, v140
v_max3_f32 v17, v17, v141, v142
v_max_f32 v17, v17, v143
v_log_f32 v18, v15
s_nop 0
v_add_f32 v18, 0xc1000000, v18
v_max_f32 v17, v17, v18
v_mov_b32 v18, v17
s_nop 1
v_permlane32_swap_b32 v17, v18
v_max_f32 v17, v17, v18
v_mov_b32 v18, v17
s_nop 1
v_permlane16_swap_b32 v17, v18
v_max_f32 v17, v17, v18
v_ceil_f32 v17, v17
v_add_f32 v17, 0x40e00000, v17
v_max_f32 v16, 0, v16
v_cvt_i32_f32 v18, v16
v_sub_u32 v18, 0, v18
v_max_f32 v17, 0, v17
v_cvt_i32_f32 v19, v17
v_sub_u32 v19, 0, v19
v_sub_f32 v240, v240, v16
v_sub_f32 v241, v241, v16
v_sub_f32 v242, v242, v16
v_sub_f32 v243, v243, v16
v_sub_f32 v244, v244, v17
v_sub_f32 v245, v245, v17
v_sub_f32 v246, v246, v17
v_sub_f32 v247, v247, v17
v_sub_f32 v144, v144, v16
v_sub_f32 v145, v145, v16
v_sub_f32 v146, v146, v16
v_sub_f32 v147, v147, v16
v_sub_f32 v148, v148, v17
v_sub_f32 v149, v149, v17
v_sub_f32 v150, v150, v17
v_sub_f32 v151, v151, v17
v_sub_f32 v152, v152, v16
v_sub_f32 v153, v153, v16
v_sub_f32 v154, v154, v16
v_sub_f32 v155, v155, v16
v_sub_f32 v156, v156, v17
v_sub_f32 v157, v157, v17
v_sub_f32 v158, v158, v17
v_sub_f32 v159, v159, v17
v_sub_f32 v128, v128, v16
v_sub_f32 v129, v129, v16
v_sub_f32 v130, v130, v16
v_sub_f32 v131, v131, v16
v_sub_f32 v132, v132, v17
v_sub_f32 v133, v133, v17
v_sub_f32 v134, v134, v17
v_sub_f32 v135, v135, v17
v_sub_f32 v136, v136, v16
v_sub_f32 v137, v137, v16
v_sub_f32 v138, v138, v16
v_sub_f32 v139, v139, v16
v_sub_f32 v140, v140, v17
v_sub_f32 v141, v141, v17
v_sub_f32 v142, v142, v17
v_sub_f32 v143, v143, v17
v_ldexp_f32 v14, v14, v18
v_ldexp_f32 v15, v15, v19
v_ldexp_f32 v64, v64, v18
v_ldexp_f32 v65, v65, v18
v_ldexp_f32 v66, v66, v18
v_ldexp_f32 v67, v67, v18
v_ldexp_f32 v68, v68, v19
v_ldexp_f32 v69, v69, v19
v_ldexp_f32 v70, v70, v19
v_ldexp_f32 v71, v71, v19
v_ldexp_f32 v72, v72, v18
v_ldexp_f32 v73, v73, v18
v_ldexp_f32 v74, v74, v18
v_ldexp_f32 v75, v75, v18
v_ldexp_f32 v76, v76, v19
v_ldexp_f32 v77, v77, v19
v_ldexp_f32 v78, v78, v19
v_ldexp_f32 v79, v79, v19
v_ldexp_f32 v80, v80, v18
v_ldexp_f32 v81, v81, v18
v_ldexp_f32 v82, v82, v18
v_ldexp_f32 v83, v83, v18
v_ldexp_f32 v84, v84, v19
v_ldexp_f32 v85, v85, v19
v_ldexp_f32 v86, v86, v19
v_ldexp_f32 v87, v87, v19
v_ldexp_f32 v88, v88, v18
v_ldexp_f32 v89, v89, v18
v_ldexp_f32 v90, v90, v18
v_ldexp_f32 v91, v91, v18
v_ldexp_f32 v92, v92, v19
v_ldexp_f32 v93, v93, v19
v_ldexp_f32 v94, v94, v19
v_ldexp_f32 v95, v95, v19
v_ldexp_f32 v96, v96, v18
v_ldexp_f32 v97, v97, v18
v_ldexp_f32 v98, v98, v18
v_ldexp_f32 v99, v99, v18
v_ldexp_f32 v100, v100, v19
v_ldexp_f32 v101, v101, v19
v_ldexp_f32 v102, v102, v19
v_ldexp_f32 v103, v103, v19
v_ldexp_f32 v104, v104, v18
v_ldexp_f32 v105, v105, v18
v_ldexp_f32 v106, v106, v18
v_ldexp_f32 v107, v107, v18
v_ldexp_f32 v108, v108, v19
v_ldexp_f32 v109, v109, v19
v_ldexp_f32 v110, v110, v19
v_ldexp_f32 v111, v111, v19
v_ldexp_f32 v112, v112, v18
v_ldexp_f32 v113, v113, v18
v_ldexp_f32 v114, v114, v18
v_ldexp_f32 v115, v115, v18
v_ldexp_f32 v116, v116, v19
v_ldexp_f32 v117, v117, v19
v_ldexp_f32 v118, v118, v19
v_ldexp_f32 v119, v119, v19
v_ldexp_f32 v120, v120, v18
v_ldexp_f32 v121, v121, v18
v_ldexp_f32 v122, v122, v18
v_ldexp_f32 v123, v123, v18
v_ldexp_f32 v124, v124, v19
v_ldexp_f32 v125, v125, v19
v_ldexp_f32 v126, v126, v19
v_ldexp_f32 v127, v127, v19
v_exp_f32 v16, v128
v_exp_f32 v17, v129
v_exp_f32 v18, v130
v_exp_f32 v19, v131
v_cvt_pk_bf16_f32 v160, v16, v17
v_exp_f32 v16, v132
v_exp_f32 v17, v133
v_cvt_pk_bf16_f32 v161, v18, v19
v_dot2_f32_bf16 v24, v160, s70, v14
v_exp_f32 v18, v134
v_exp_f32 v19, v135
v_cvt_pk_bf16_f32 v164, v16, v17
v_dot2_f32_bf16 v24, v161, s70, v24
v_cvt_pk_bf16_f32 v165, v18, v19
v_dot2_f32_bf16 v25, v164, s70, v15
v_dot2_f32_bf16 v25, v165, s70, v25
v_exp_f32 v16, v136
v_exp_f32 v17, v137
v_exp_f32 v18, v138
v_exp_f32 v19, v139
v_cvt_pk_bf16_f32 v162, v16, v17
v_exp_f32 v16, v140
v_exp_f32 v17, v141
v_cvt_pk_bf16_f32 v163, v18, v19
v_dot2_f32_bf16 v24, v162, s70, v24
v_exp_f32 v18, v142
v_exp_f32 v19, v143
v_cvt_pk_bf16_f32 v166, v16, v17
v_dot2_f32_bf16 v24, v163, s70, v24
v_cvt_pk_bf16_f32 v167, v18, v19
v_dot2_f32_bf16 v25, v166, s70, v25
v_dot2_f32_bf16 v25, v167, s70, v25
s_cmp_eq_u32 s72, 0
s_cbranch_scc1 LA_back0_0
s_cmp_eq_u32 s72, 1
s_cbranch_scc1 LA_back0_1
s_cmp_eq_u32 s72, 2
s_cbranch_scc1 LA_back0_2
s_branch LA_back4
LA_rare1_0:
s_mov_b32 s72, 0
s_branch LA_rare1b
LA_rare1_1:
s_mov_b32 s72, 1
s_branch LA_rare1b
LA_rare1_2:
s_mov_b32 s72, 2
LA_rare1b:
s_waitcnt lgkmcnt(0)
v_max3_f32 v16, v144, v145, v146
v_max3_f32 v16, v16, v147, v152
v_max3_f32 v16, v16, v153, v154
v_max_f32 v16, v16, v155
v_log_f32 v18, v24
s_nop 0
v_add_f32 v18, 0xc1000000, v18
v_max_f32 v16, v16, v18
v_mov_b32 v18, v16
s_nop 1
v_permlane32_swap_b32 v16, v18
v_max_f32 v16, v16, v18
v_mov_b32 v18, v16
s_nop 1
v_permlane16_swap_b32 v16, v18
v_max_f32 v16, v16, v18
v_ceil_f32 v16, v16
v_add_f32 v16, 0x40e00000, v16
v_max3_f32 v17, v148, v149, v150
v_max3_f32 v17, v17, v151, v156
v_max3_f32 v17, v17, v157, v158
v_max_f32 v17, v17, v159
v_log_f32 v18, v25
s_nop 0
v_add_f32 v18, 0xc1000000, v18
v_max_f32 v17, v17, v18
v_mov_b32 v18, v17
s_nop 1
v_permlane32_swap_b32 v17, v18
v_max_f32 v17, v17, v18
v_mov_b32 v18, v17
s_nop 1
v_permlane16_swap_b32 v17, v18
v_max_f32 v17, v17, v18
v_ceil_f32 v17, v17
v_add_f32 v17, 0x40e00000, v17
v_max_f32 v16, 0, v16
v_cvt_i32_f32 v18, v16
v_sub_u32 v18, 0, v18
v_max_f32 v17, 0, v17
v_cvt_i32_f32 v19, v17
v_sub_u32 v19, 0, v19
v_sub_f32 v240, v240, v16
v_sub_f32 v241, v241, v16
v_sub_f32 v242, v242, v16
v_sub_f32 v243, v243, v16
v_sub_f32 v244, v244, v17
v_sub_f32 v245, v245, v17
v_sub_f32 v246, v246, v17
v_sub_f32 v247, v247, v17
v_sub_f32 v128, v128, v16
v_sub_f32 v129, v129, v16
v_sub_f32 v130, v130, v16
v_sub_f32 v131, v131, v16
v_sub_f32 v132, v132, v17
v_sub_f32 v133, v133, v17
v_sub_f32 v134, v134, v17
v_sub_f32 v135, v135, v17
v_sub_f32 v136, v136, v16
v_sub_f32 v137, v137, v16
v_sub_f32 v138, v138, v16
v_sub_f32 v139, v139, v16
v_sub_f32 v140, v140, v17
v_sub_f32 v141, v141, v17
v_sub_f32 v142, v142, v17
v_sub_f32 v143, v143, v17
v_sub_f32 v144, v144, v16
v_sub_f32 v145, v145, v16
v_sub_f32 v146, v146, v16
v_sub_f32 v147, v147, v16
v_sub_f32 v148, v148, v17
v_sub_f32 v149, v149, v17
v_sub_f32 v150, v150, v17
v_sub_f32 v151, v151, v17
v_sub_f32 v152, v152, v16
v_sub_f32 v153, v153, v16
v_sub_f32 v154, v154, v16
v_sub_f32 v155, v155, v16
v_sub_f32 v156, v156, v17
v_sub_f32 v157, v157, v17
v_sub_f32 v158, v158, v17
v_sub_f32 v159, v159, v17
v_ldexp_f32 v24, v24, v18
v_ldexp_f32 v25, v25, v19
v_ldexp_f32 v64, v64, v18
v_ldexp_f32 v65, v65, v18
v_ldexp_f32 v66, v66, v18
v_ldexp_f32 v67, v67, v18
v_ldexp_f32 v68, v68, v19
v_ldexp_f32 v69, v69, v19
v_ldexp_f32 v70, v70, v19
v_ldexp_f32 v71, v71, v19
v_ldexp_f32 v72, v72, v18
v_ldexp_f32 v73, v73, v18
v_ldexp_f32 v74, v74, v18
v_ldexp_f32 v75, v75, v18
v_ldexp_f32 v76, v76, v19
v_ldexp_f32 v77, v77, v19
v_ldexp_f32 v78, v78, v19
v_ldexp_f32 v79, v79, v19
v_ldexp_f32 v80, v80, v18
v_ldexp_f32 v81, v81, v18
v_ldexp_f32 v82, v82, v18
v_ldexp_f32 v83, v83, v18
v_ldexp_f32 v84, v84, v19
v_ldexp_f32 v85, v85, v19
v_ldexp_f32 v86, v86, v19
v_ldexp_f32 v87, v87, v19
v_ldexp_f32 v88, v88, v18
v_ldexp_f32 v89, v89, v18
v_ldexp_f32 v90, v90, v18
v_ldexp_f32 v91, v91, v18
v_ldexp_f32 v92, v92, v19
v_ldexp_f32 v93, v93, v19
v_ldexp_f32 v94, v94, v19
v_ldexp_f32 v95, v95, v19
v_ldexp_f32 v96, v96, v18
v_ldexp_f32 v97, v97, v18
v_ldexp_f32 v98, v98, v18
v_ldexp_f32 v99, v99, v18
v_ldexp_f32 v100, v100, v19
v_ldexp_f32 v101, v101, v19
v_ldexp_f32 v102, v102, v19
v_ldexp_f32 v103, v103, v19
v_ldexp_f32 v104, v104, v18
v_ldexp_f32 v105, v105, v18
v_ldexp_f32 v106, v106, v18
v_ldexp_f32 v107, v107, v18
v_ldexp_f32 v108, v108, v19
v_ldexp_f32 v109, v109, v19
v_ldexp_f32 v110, v110, v19
v_ldexp_f32 v111, v111, v19
v_ldexp_f32 v112, v112, v18
v_ldexp_f32 v113, v113, v18
v_ldexp_f32 v114, v114, v18
v_ldexp_f32 v115, v115, v18
v_ldexp_f32 v116, v116, v19
v_ldexp_f32 v117, v117, v19
v_ldexp_f32 v118, v118, v19
v_ldexp_f32 v119, v119, v19
v_ldexp_f32 v120, v120, v18
v_ldexp_f32 v121, v121, v18
v_ldexp_f32 v122, v122, v18
v_ldexp_f32 v123, v123, v18
v_ldexp_f32 v124, v124, v19
v_ldexp_f32 v125, v125, v19
v_ldexp_f32 v126, v126, v19
v_ldexp_f32 v127, v127, v19
v_exp_f32 v16, v144
v_exp_f32 v17, v145
v_exp_f32 v18, v146
v_exp_f32 v19, v147
v_cvt_pk_bf16_f32 v168, v16, v17
v_exp_f32 v16, v148
v_exp_f32 v17, v149
v_cvt_pk_bf16_f32 v169, v18, v19
v_dot2_f32_bf16 v14, v168, s70, v24
v_exp_f32 v18, v150
v_exp_f32 v19, v151
v_cvt_pk_bf16_f32 v172, v16, v17
v_dot2_f32_bf16 v14, v169, s70, v14
v_cvt_pk_bf16_f32 v173, v18, v19
v_dot2_f32_bf16 v15, v172, s70, v25
v_dot2_f32_bf16 v15, v173, s70, v15
v_exp_f32 v16, v152
v_exp_f32 v17, v153
v_exp_f32 v18, v154
v_exp_f32 v19, v155
v_cvt_pk_bf16_f32 v170, v16, v17
v_exp_f32 v16, v156
v_exp_f32 v17, v157
v_cvt_pk_bf16_f32 v171, v18, v19
v_dot2_f32_bf16 v14, v170, s70, v14
v_exp_f32 v18, v158
v_exp_f32 v19, v159
v_cvt_pk_bf16_f32 v174, v16, v17
v_dot2_f32_bf16 v14, v171, s70, v14
v_cvt_pk_bf16_f32 v175, v18, v19
v_dot2_f32_bf16 v15, v174, s70, v15
v_dot2_f32_bf16 v15, v175, s70, v15
s_cmp_eq_u32 s72, 0
s_cbranch_scc1 LA_back1_0
s_cmp_eq_u32 s72, 1
s_cbranch_scc1 LA_back1_1
s_branch LA_back1_2
LA_rare2:
v_max3_f32 v16, v144, v145, v146
v_max3_f32 v16, v16, v147, v152
v_max3_f32 v16, v16, v153, v154
v_max_f32 v16, v16, v155
v_log_f32 v18, v24
s_nop 0
v_add_f32 v18, 0xc1000000, v18
v_max_f32 v16, v16, v18
v_mov_b32 v18, v16
s_nop 1
v_permlane32_swap_b32 v16, v18
v_max_f32 v16, v16, v18
v_mov_b32 v18, v16
s_nop 1
v_permlane16_swap_b32 v16, v18
v_max_f32 v16, v16, v18
v_ceil_f32 v16, v16
v_add_f32 v16, 0x40e00000, v16
v_max3_f32 v17, v148, v149, v150
v_max3_f32 v17, v17, v151, v156
v_max3_f32 v17, v17, v157, v158
v_max_f32 v17, v17, v159
v_log_f32 v18, v25
s_nop 0
v_add_f32 v18, 0xc1000000, v18
v_max_f32 v17, v17, v18
v_mov_b32 v18, v17
s_nop 1
v_permlane32_swap_b32 v17, v18
v_max_f32 v17, v17, v18
v_mov_b32 v18, v17
s_nop 1
v_permlane16_swap_b32 v17, v18
v_max_f32 v17, v17, v18
v_ceil_f32 v17, v17
v_add_f32 v17, 0x40e00000, v17
v_max_f32 v16, 0, v16
v_cvt_i32_f32 v18, v16
v_sub_u32 v18, 0, v18
v_max_f32 v17, 0, v17
v_cvt_i32_f32 v19, v17
v_sub_u32 v19, 0, v19
v_sub_f32 v240, v240, v16
v_sub_f32 v241, v241, v16
v_sub_f32 v242, v242, v16
v_sub_f32 v243, v243, v16
v_sub_f32 v244, v244, v17
v_sub_f32 v245, v245, v17
v_sub_f32 v246, v246, v17
v_sub_f32 v247, v247, v17
v_sub_f32 v128, v128, v16
v_sub_f32 v129, v129, v16
v_sub_f32 v130, v130, v16
v_sub_f32 v131, v131, v16
v_sub_f32 v132, v132, v17
v_sub_f32 v133, v133, v17
v_sub_f32 v134, v134, v17
v_sub_f32 v135, v135, v17
v_sub_f32 v136, v136, v16
v_sub_f32 v137, v137, v16
v_sub_f32 v138, v138, v16
v_sub_f32 v139, v139, v16
v_sub_f32 v140, v140, v17
v_sub_f32 v141, v141, v17
v_sub_f32 v142, v142, v17
v_sub_f32 v143, v143, v17
v_sub_f32 v144, v144, v16
v_sub_f32 v145, v145, v16
v_sub_f32 v146, v146, v16
v_sub_f32 v147, v147, v16
v_sub_f32 v148, v148, v17
v_sub_f32 v149, v149, v17
v_sub_f32 v150, v150, v17
v_sub_f32 v151, v151, v17
v_sub_f32 v152, v152, v16
v_sub_f32 v153, v153, v16
v_sub_f32 v154, v154, v16
v_sub_f32 v155, v155, v16
v_sub_f32 v156, v156, v17
v_sub_f32 v157, v157, v17
v_sub_f32 v158, v158, v17
v_sub_f32 v159, v159, v17
v_ldexp_f32 v24, v24, v18
v_ldexp_f32 v25, v25, v19
v_ldexp_f32 v64, v64, v18
v_ldexp_f32 v65, v65, v18
v_ldexp_f32 v66, v66, v18
v_ldexp_f32 v67, v67, v18
v_ldexp_f32 v68, v68, v19
v_ldexp_f32 v69, v69, v19
v_ldexp_f32 v70, v70, v19
v_ldexp_f32 v71, v71, v19
v_ldexp_f32 v72, v72, v18
v_ldexp_f32 v73, v73, v18
v_ldexp_f32 v74, v74, v18
v_ldexp_f32 v75, v75, v18
v_ldexp_f32 v76, v76, v19
v_ldexp_f32 v77, v77, v19
v_ldexp_f32 v78, v78, v19
v_ldexp_f32 v79, v79, v19
v_ldexp_f32 v80, v80, v18
v_ldexp_f32 v81, v81, v18
v_ldexp_f32 v82, v82, v18
v_ldexp_f32 v83, v83, v18
v_ldexp_f32 v84, v84, v19
v_ldexp_f32 v85, v85, v19
v_ldexp_f32 v86, v86, v19
v_ldexp_f32 v87, v87, v19
v_ldexp_f32 v88, v88, v18
v_ldexp_f32 v89, v89, v18
v_ldexp_f32 v90, v90, v18
v_ldexp_f32 v91, v91, v18
v_ldexp_f32 v92, v92, v19
v_ldexp_f32 v93, v93, v19
v_ldexp_f32 v94, v94, v19
v_ldexp_f32 v95, v95, v19
v_ldexp_f32 v96, v96, v18
v_ldexp_f32 v97, v97, v18
v_ldexp_f32 v98, v98, v18
v_ldexp_f32 v99, v99, v18
v_ldexp_f32 v100, v100, v19
v_ldexp_f32 v101, v101, v19
v_ldexp_f32 v102, v102, v19
v_ldexp_f32 v103, v103, v19
v_ldexp_f32 v104, v104, v18
v_ldexp_f32 v105, v105, v18
v_ldexp_f32 v106, v106, v18
v_ldexp_f32 v107, v107, v18
v_ldexp_f32 v108, v108, v19
v_ldexp_f32 v109, v109, v19
v_ldexp_f32 v110, v110, v19
v_ldexp_f32 v111, v111, v19
v_ldexp_f32 v112, v112, v18
v_ldexp_f32 v113, v113, v18
v_ldexp_f32 v114, v114, v18
v_ldexp_f32 v115, v115, v18
v_ldexp_f32 v116, v116, v19
v_ldexp_f32 v117, v117, v19
v_ldexp_f32 v118, v118, v19
v_ldexp_f32 v119, v119, v19
v_ldexp_f32 v120, v120, v18
v_ldexp_f32 v121, v121, v18
v_ldexp_f32 v122, v122, v18
v_ldexp_f32 v123, v123, v18
v_ldexp_f32 v124, v124, v19
v_ldexp_f32 v125, v125, v19
v_ldexp_f32 v126, v126, v19
v_ldexp_f32 v127, v127, v19
v_exp_f32 v16, v128
v_exp_f32 v17, v129
v_exp_f32 v18, v130
v_exp_f32 v19, v131
v_cvt_pk_bf16_f32 v160, v16, v17
v_exp_f32 v16, v132
v_exp_f32 v17, v133
v_cvt_pk_bf16_f32 v161, v18, v19
v_exp_f32 v18, v134
v_exp_f32 v19, v135
v_cvt_pk_bf16_f32 v164, v16, v17
v_cvt_pk_bf16_f32 v165, v18, v19
v_exp_f32 v16, v136
v_exp_f32 v17, v137
v_exp_f32 v18, v138
v_exp_f32 v19, v139
v_cvt_pk_bf16_f32 v162, v16, v17
v_exp_f32 v16, v140
v_exp_f32 v17, v141
v_cvt_pk_bf16_f32 v163, v18, v19
v_exp_f32 v18, v142
v_exp_f32 v19, v143
v_cvt_pk_bf16_f32 v166, v16, v17
v_cvt_pk_bf16_f32 v167, v18, v19
v_exp_f32 v16, v144
v_exp_f32 v17, v145
v_exp_f32 v18, v146
v_exp_f32 v19, v147
v_cvt_pk_bf16_f32 v168, v16, v17
v_exp_f32 v16, v148
v_exp_f32 v17, v149
v_cvt_pk_bf16_f32 v169, v18, v19
v_dot2_f32_bf16 v14, v168, s70, v24
v_exp_f32 v18, v150
v_exp_f32 v19, v151
v_cvt_pk_bf16_f32 v172, v16, v17
v_dot2_f32_bf16 v14, v169, s70, v14
v_cvt_pk_bf16_f32 v173, v18, v19
v_dot2_f32_bf16 v15, v172, s70, v25
v_dot2_f32_bf16 v15, v173, s70, v15
v_exp_f32 v16, v152
v_exp_f32 v17, v153
v_exp_f32 v18, v154
v_exp_f32 v19, v155
v_cvt_pk_bf16_f32 v170, v16, v17
v_exp_f32 v16, v156
v_exp_f32 v17, v157
v_cvt_pk_bf16_f32 v171, v18, v19
v_dot2_f32_bf16 v14, v170, s70, v14
v_exp_f32 v18, v158
v_exp_f32 v19, v159
v_cvt_pk_bf16_f32 v174, v16, v17
v_dot2_f32_bf16 v14, v171, s70, v14
v_cvt_pk_bf16_f32 v175, v18, v19
v_dot2_f32_bf16 v15, v174, s70, v15
v_dot2_f32_bf16 v15, v175, s70, v15
s_branch LA_back2
LA_rare3:
s_waitcnt lgkmcnt(0)
v_max3_f32 v16, v144, v145, v146
v_max3_f32 v16, v16, v147, v152
v_max3_f32 v16, v16, v153, v154
v_max_f32 v16, v16, v155
v_log_f32 v18, v24
s_nop 0
v_add_f32 v18, 0xc1000000, v18
v_max_f32 v16, v16, v18
v_mov_b32 v18, v16
s_nop 1
v_permlane32_swap_b32 v16, v18
v_max_f32 v16, v16, v18
v_mov_b32 v18, v16
s_nop 1
v_permlane16_swap_b32 v16, v18
v_max_f32 v16, v16, v18
v_ceil_f32 v16, v16
v_add_f32 v16, 0x40e00000, v16
v_max3_f32 v17, v148, v149, v150
v_max3_f32 v17, v17, v151, v156
v_max3_f32 v17, v17, v157, v158
v_max_f32 v17, v17, v159
v_log_f32 v18, v25
s_nop 0
v_add_f32 v18, 0xc1000000, v18
v_max_f32 v17, v17, v18
v_mov_b32 v18, v17
s_nop 1
v_permlane32_swap_b32 v17, v18
v_max_f32 v17, v17, v18
v_mov_b32 v18, v17
s_nop 1
v_permlane16_swap_b32 v17, v18
v_max_f32 v17, v17, v18
v_ceil_f32 v17, v17
v_add_f32 v17, 0x40e00000, v17
v_max_f32 v16, 0, v16
v_cvt_i32_f32 v18, v16
v_sub_u32 v18, 0, v18
v_max_f32 v17, 0, v17
v_cvt_i32_f32 v19, v17
v_sub_u32 v19, 0, v19
v_sub_f32 v144, v144, v16
v_sub_f32 v145, v145, v16
v_sub_f32 v146, v146, v16
v_sub_f32 v147, v147, v16
v_sub_f32 v148, v148, v17
v_sub_f32 v149, v149, v17
v_sub_f32 v150, v150, v17
v_sub_f32 v151, v151, v17
v_sub_f32 v152, v152, v16
v_sub_f32 v153, v153, v16
v_sub_f32 v154, v154, v16
v_sub_f32 v155, v155, v16
v_sub_f32 v156, v156, v17
v_sub_f32 v157, v157, v17
v_sub_f32 v158, v158, v17
v_sub_f32 v159, v159, v17
v_ldexp_f32 v24, v24, v18
v_ldexp_f32 v25, v25, v19
v_ldexp_f32 v64, v64, v18
v_ldexp_f32 v65, v65, v18
v_ldexp_f32 v66, v66, v18
v_ldexp_f32 v67, v67, v18
v_ldexp_f32 v68, v68, v19
v_ldexp_f32 v69, v69, v19
v_ldexp_f32 v70, v70, v19
v_ldexp_f32 v71, v71, v19
v_ldexp_f32 v72, v72, v18
v_ldexp_f32 v73, v73, v18
v_ldexp_f32 v74, v74, v18
v_ldexp_f32 v75, v75, v18
v_ldexp_f32 v76, v76, v19
v_ldexp_f32 v77, v77, v19
v_ldexp_f32 v78, v78, v19
v_ldexp_f32 v79, v79, v19
v_ldexp_f32 v80, v80, v18
v_ldexp_f32 v81, v81, v18
v_ldexp_f32 v82, v82, v18
v_ldexp_f32 v83, v83, v18
v_ldexp_f32 v84, v84, v19
v_ldexp_f32 v85, v85, v19
v_ldexp_f32 v86, v86, v19
v_ldexp_f32 v87, v87, v19
v_ldexp_f32 v88, v88, v18
v_ldexp_f32 v89, v89, v18
v_ldexp_f32 v90, v90, v18
v_ldexp_f32 v91, v91, v18
v_ldexp_f32 v92, v92, v19
v_ldexp_f32 v93, v93, v19
v_ldexp_f32 v94, v94, v19
v_ldexp_f32 v95, v95, v19
v_ldexp_f32 v96, v96, v18
v_ldexp_f32 v97, v97, v18
v_ldexp_f32 v98, v98, v18
v_ldexp_f32 v99, v99, v18
v_ldexp_f32 v100, v100, v19
v_ldexp_f32 v101, v101, v19
v_ldexp_f32 v102, v102, v19
v_ldexp_f32 v103, v103, v19
v_ldexp_f32 v104, v104, v18
v_ldexp_f32 v105, v105, v18
v_ldexp_f32 v106, v106, v18
v_ldexp_f32 v107, v107, v18
v_ldexp_f32 v108, v108, v19
v_ldexp_f32 v109, v109, v19
v_ldexp_f32 v110, v110, v19
v_ldexp_f32 v111, v111, v19
v_ldexp_f32 v112, v112, v18
v_ldexp_f32 v113, v113, v18
v_ldexp_f32 v114, v114, v18
v_ldexp_f32 v115, v115, v18
v_ldexp_f32 v116, v116, v19
v_ldexp_f32 v117, v117, v19
v_ldexp_f32 v118, v118, v19
v_ldexp_f32 v119, v119, v19
v_ldexp_f32 v120, v120, v18
v_ldexp_f32 v121, v121, v18
v_ldexp_f32 v122, v122, v18
v_ldexp_f32 v123, v123, v18
v_ldexp_f32 v124, v124, v19
v_ldexp_f32 v125, v125, v19
v_ldexp_f32 v126, v126, v19
v_ldexp_f32 v127, v127, v19
v_exp_f32 v16, v144
v_exp_f32 v17, v145
v_exp_f32 v18, v146
v_exp_f32 v19, v147
v_cvt_pk_bf16_f32 v168, v16, v17
v_exp_f32 v16, v148
v_exp_f32 v17, v149
v_cvt_pk_bf16_f32 v169, v18, v19
v_dot2_f32_bf16 v14, v168, s70, v24
v_exp_f32 v18, v150
v_exp_f32 v19, v151
v_cvt_pk_bf16_f32 v172, v16, v17
v_dot2_f32_bf16 v14, v169, s70, v14
v_cvt_pk_bf16_f32 v173, v18, v19
v_dot2_f32_bf16 v15, v172, s70, v25
v_dot2_f32_bf16 v15, v173, s70, v15
v_exp_f32 v16, v152
v_exp_f32 v17, v153
v_exp_f32 v18, v154
v_exp_f32 v19, v155
v_cvt_pk_bf16_f32 v170, v16, v17
v_exp_f32 v16, v156
v_exp_f32 v17, v157
v_cvt_pk_bf16_f32 v171, v18, v19
v_dot2_f32_bf16 v14, v170, s70, v14
v_exp_f32 v18, v158
v_exp_f32 v19, v159
v_cvt_pk_bf16_f32 v174, v16, v17
v_dot2_f32_bf16 v14, v171, s70, v14
v_cvt_pk_bf16_f32 v175, v18, v19
v_dot2_f32_bf16 v15, v174, s70, v15
v_dot2_f32_bf16 v15, v175, s70, v15
s_branch LA_back3
L_H:
v_lshrrev_b32 v16, 4, v1
v_and_b32 v17, 15, v1
v_add_u32 v19, 0, v16
v_xor_b32 v19, v19, v17
v_lshlrev_b32 v19, 4, v19
v_lshl_add_u32 v160, v16, 8, v19
v_add_u32 v19, 4, v16
v_xor_b32 v19, v19, v17
v_lshlrev_b32 v19, 4, v19
v_lshl_add_u32 v161, v16, 8, v19
v_add_u32 v19, 8, v16
v_xor_b32 v19, v19, v17
v_lshlrev_b32 v19, 4, v19
v_lshl_add_u32 v162, v16, 8, v19
v_add_u32 v19, 12, v16
v_xor_b32 v19, v19, v17
v_lshlrev_b32 v19, 4, v19
v_lshl_add_u32 v163, v16, 8, v19
s_mov_b32 s76, s58
s_and_b32 s77, s59, 0xffff
s_mov_b32 s78, 0x200000
s_mov_b32 s79, 0x20000
s_mov_b32 s28, s56
s_and_b32 s29, s57, 0xffff
s_mov_b32 s30, 0x400000
s_mov_b32 s31, 0x20000
s_bfe_u32 s38, s2, 0x20003
s_add_u32 s36, s38, 0
s_and_b32 s36, s36, 3
s_lshl_b32 s36, s36, 1
s_lshl_b32 s37, s34, 3
s_add_u32 s36, s36, s37
s_lshl_b32 s36, s36, 17
s_lshl_b32 s37, s38, 8
s_add_u32 s36, s36, s37
s_lshl_b32 s37, s4, 14
s_add_u32 s80, s36, s37
s_add_u32 s36, s38, 1
s_and_b32 s36, s36, 3
s_lshl_b32 s36, s36, 1
s_lshl_b32 s37, s34, 3
s_add_u32 s36, s36, s37
s_lshl_b32 s36, s36, 17
s_lshl_b32 s37, s38, 8
s_add_u32 s36, s36, s37
s_lshl_b32 s37, s4, 14
s_add_u32 s81, s36, s37
s_add_u32 s36, s38, 2
s_and_b32 s36, s36, 3
s_lshl_b32 s36, s36, 1
s_lshl_b32 s37, s34, 3
s_add_u32 s36, s36, s37
s_lshl_b32 s36, s36, 17
s_lshl_b32 s37, s38, 8
s_add_u32 s36, s36, s37
s_lshl_b32 s37, s4, 14
s_add_u32 s82, s36, s37
s_add_u32 s36, s38, 3
s_and_b32 s36, s36, 3
s_lshl_b32 s36, s36, 1
s_lshl_b32 s37, s34, 3
s_add_u32 s36, s36, s37
s_lshl_b32 s36, s36, 17
s_lshl_b32 s37, s38, 8
s_add_u32 s36, s36, s37
s_lshl_b32 s37, s4, 14
s_add_u32 s83, s36, s37
s_waitcnt vmcnt(6)
s_barrier
s_add_u32 m0, s5, 16384
s_add_u32 s37, s43, 1048576
buffer_load_dwordx4 v166, s[20:23], s37 offen lds
s_add_u32 m0, s5, 17408
s_add_u32 s37, s43, 1081344
buffer_load_dwordx4 v166, s[20:23], s37 offen lds
s_add_u32 m0, s5, 18432
s_add_u32 s37, s43, 1114112
buffer_load_dwordx4 v167, s[20:23], s37 offen lds
s_add_u32 m0, s5, 19456
s_add_u32 s37, s43, 1146880
buffer_load_dwordx4 v167, s[20:23], s37 offen lds
s_add_u32 m0, s5, 98304
s_add_u32 s37, s43, 1048832
buffer_load_dwordx4 v166, s[20:23], s37 offen lds
s_add_u32 m0, s5, 99328
s_add_u32 s37, s43, 1081600
buffer_load_dwordx4 v166, s[20:23], s37 offen lds
s_add_u32 m0, s5, 100352
s_add_u32 s37, s43, 1114368
buffer_load_dwordx4 v167, s[20:23], s37 offen lds
s_add_u32 m0, s5, 101376
s_add_u32 s37, s43, 1147136
buffer_load_dwordx4 v167, s[20:23], s37 offen lds
s_add_u32 m0, s5, 81920
s_add_u32 s37, s42, 256
buffer_load_dwordx4 v168, s[16:19], s37 offen lds
s_add_u32 m0, s5, 82944
s_add_u32 s37, s42, 8448
buffer_load_dwordx4 v169, s[16:19], s37 offen lds
s_add_u32 m0, s5, 83968
s_add_u32 s37, s42, 16640
buffer_load_dwordx4 v168, s[16:19], s37 offen lds
s_add_u32 m0, s5, 84992
s_add_u32 s37, s42, 24832
buffer_load_dwordx4 v169, s[16:19], s37 offen lds
s_waitcnt vmcnt(12)
s_barrier
s_add_u32 m0, s5, 32768
s_add_u32 s37, s43, 1572864
buffer_load_dwordx4 v166, s[20:23], s37 offen lds
s_add_u32 m0, s5, 33792
s_add_u32 s37, s43, 1605632
buffer_load_dwordx4 v166, s[20:23], s37 offen lds
s_add_u32 m0, s5, 34816
s_add_u32 s37, s43, 1638400
buffer_load_dwordx4 v167, s[20:23], s37 offen lds
s_add_u32 m0, s5, 35840
s_add_u32 s37, s43, 1671168
buffer_load_dwordx4 v167, s[20:23], s37 offen lds
s_add_u32 m0, s5, 114688
s_add_u32 s37, s43, 1573120
buffer_load_dwordx4 v166, s[20:23], s37 offen lds
s_add_u32 m0, s5, 115712
s_add_u32 s37, s43, 1605888
buffer_load_dwordx4 v166, s[20:23], s37 offen lds
s_add_u32 m0, s5, 116736
s_add_u32 s37, s43, 1638656
buffer_load_dwordx4 v167, s[20:23], s37 offen lds
s_add_u32 m0, s5, 117760
s_add_u32 s37, s43, 1671424
buffer_load_dwordx4 v167, s[20:23], s37 offen lds
s_add_u32 m0, s5, 65536
s_add_u32 s37, s42, 384
buffer_load_dwordx4 v168, s[16:19], s37 offen lds
s_add_u32 m0, s5, 66560
s_add_u32 s37, s42, 8576
buffer_load_dwordx4 v169, s[16:19], s37 offen lds
s_add_u32 m0, s5, 67584
s_add_u32 s37, s42, 16768
buffer_load_dwordx4 v168, s[16:19], s37 offen lds
s_add_u32 m0, s5, 68608
s_add_u32 s37, s42, 24960
buffer_load_dwordx4 v169, s[16:19], s37 offen lds
s_waitcnt vmcnt(12)
s_barrier
s_add_u32 m0, s5, 49152
s_add_u32 s37, s43, 2097152
buffer_load_dwordx4 v166, s[20:23], s37 offen lds
s_add_u32 m0, s5, 50176
s_add_u32 s37, s43, 2129920
buffer_load_dwordx4 v166, s[20:23], s37 offen lds
s_add_u32 m0, s5, 51200
s_add_u32 s37, s43, 2162688
buffer_load_dwordx4 v167, s[20:23], s37 offen lds
s_add_u32 m0, s5, 52224
s_add_u32 s37, s43, 2195456
buffer_load_dwordx4 v167, s[20:23], s37 offen lds
s_add_u32 m0, s5, 131072
s_add_u32 s37, s43, 2097408
buffer_load_dwordx4 v166, s[20:23], s37 offen lds
s_add_u32 m0, s5, 132096
s_add_u32 s37, s43, 2130176
buffer_load_dwordx4 v166, s[20:23], s37 offen lds
s_add_u32 m0, s5, 133120
s_add_u32 s37, s43, 2162944
buffer_load_dwordx4 v167, s[20:23], s37 offen lds
s_add_u32 m0, s5, 134144
s_add_u32 s37, s43, 2195712
buffer_load_dwordx4 v167, s[20:23], s37 offen lds
s_add_u32 m0, s5, 147456
s_add_u32 s37, s42, 512
buffer_load_dwordx4 v168, s[16:19], s37 offen lds
s_add_u32 m0, s5, 148480
s_add_u32 s37, s42, 8704
buffer_load_dwordx4 v169, s[16:19], s37 offen lds
s_add_u32 m0, s5, 149504
s_add_u32 s37, s42, 16896
buffer_load_dwordx4 v168, s[16:19], s37 offen lds
s_add_u32 m0, s5, 150528
s_add_u32 s37, s42, 25088
buffer_load_dwordx4 v169, s[16:19], s37 offen lds
s_bfe_u32 s38, s2, 0x20003
s_xor_b32 s39, s4, s34
s_add_u32 s36, s38, 1
s_and_b32 s36, s36, 3
s_lshl_b32 s36, s36, 1
s_lshl_b32 s37, s34, 3
s_add_u32 s36, s36, s37
s_lshl_b32 s37, s32, 5
s_add_u32 s37, s37, s36
s_lshl_b32 s37, s37, 2
s_add_u32 s37, s37, s39
s_lshl_b32 s84, s37, 13
s_add_u32 s36, s38, 2
s_and_b32 s36, s36, 3
s_lshl_b32 s36, s36, 1
s_lshl_b32 s37, s34, 3
s_add_u32 s36, s36, s37
s_lshl_b32 s37, s32, 5
s_add_u32 s37, s37, s36
s_lshl_b32 s37, s37, 2
s_add_u32 s37, s37, s39
s_lshl_b32 s85, s37, 13
s_add_u32 s36, s38, 3
s_and_b32 s36, s36, 3
s_lshl_b32 s36, s36, 1
s_lshl_b32 s37, s34, 3
s_add_u32 s36, s36, s37
s_lshl_b32 s37, s32, 5
s_add_u32 s37, s37, s36
s_lshl_b32 s37, s37, 2
s_add_u32 s37, s37, s39
s_lshl_b32 s86, s37, 13
v_lshrrev_b32 v16, 2, v1
v_add_u32 v16, s38, v16
v_add_u32 v16, 1, v16
v_and_b32 v16, 3, v16
v_lshlrev_b32 v16, 10, v16
s_and_b32 s36, s2, 0xe7
s_lshl_b32 s36, s36, 7
s_add_u32 s36, s36, 33554432
v_and_b32 v21, 3, v1
v_lshl_add_u32 v21, v21, 2, v16
v_add_u32 v21, s36, v21
s_and_b32 s36, s2, 7
s_lshl_b32 s73, s36, 7
s_lshr_b32 s37, s2, 3
s_lshl_b32 s37, s37, 2
s_add_u32 s73, s73, s37
s_add_u32 s73, s73, 33624064
s_and_b32 s36, s2, 7
s_lshl_b32 s36, s36, 7
s_add_u32 s36, s36, 33624064
v_and_b32 v0, 31, v1
v_lshlrev_b32 v0, 2, v0
v_add_u32 v0, s36, v0
s_lshl_b32 s74, s7, 6
v_mov_b32 v2, v160
v_mov_b32 v3, v161
v_mov_b32 v4, v162
v_mov_b32 v5, v163
v_mov_b32 v6, v164
v_mov_b32 v8, v170
v_mov_b32 v7, v165
v_mov_b32 v9, v171
s_lshl_b32 s36, s4, 6
v_xor_b32 v13, s36, v174
v_xor_b32 v16, 32, v13
v_add_u32 v14, 49152, v13
v_add_u32 v17, 49152, v16
v_add_u32 v11, 49152, v20
v_add_u32 v15, 98304, v13
v_add_u32 v18, 98304, v16
v_add_u32 v12, 98304, v20
s_waitcnt vmcnt(12)
s_barrier
s_add_u32 m0, s5, 16384
s_add_u32 s37, s43, 2621440
buffer_load_dwordx4 v166, s[20:23], s37 offen lds
s_add_u32 m0, s5, 17408
s_add_u32 s37, s43, 2654208
buffer_load_dwordx4 v166, s[20:23], s37 offen lds
s_add_u32 m0, s5, 18432
s_add_u32 s37, s43, 2686976
buffer_load_dwordx4 v167, s[20:23], s37 offen lds
s_add_u32 m0, s5, 19456
s_add_u32 s37, s43, 2719744
buffer_load_dwordx4 v167, s[20:23], s37 offen lds
s_add_u32 m0, s5, 98304
s_add_u32 s37, s43, 2621696
buffer_load_dwordx4 v166, s[20:23], s37 offen lds
s_add_u32 m0, s5, 99328
s_add_u32 s37, s43, 2654464
buffer_load_dwordx4 v166, s[20:23], s37 offen lds
s_add_u32 m0, s5, 100352
s_add_u32 s37, s43, 2687232
buffer_load_dwordx4 v167, s[20:23], s37 offen lds
s_add_u32 m0, s5, 101376
s_add_u32 s37, s43, 2720000
buffer_load_dwordx4 v167, s[20:23], s37 offen lds
s_add_u32 m0, s5, 81920
s_add_u32 s37, s42, 640
buffer_load_dwordx4 v168, s[16:19], s37 offen lds
s_add_u32 m0, s5, 82944
s_add_u32 s37, s42, 8832
buffer_load_dwordx4 v169, s[16:19], s37 offen lds
s_add_u32 m0, s5, 83968
s_add_u32 s37, s42, 17024
buffer_load_dwordx4 v168, s[16:19], s37 offen lds
s_add_u32 m0, s5, 84992
s_add_u32 s37, s42, 25216
buffer_load_dwordx4 v169, s[16:19], s37 offen lds
s_waitcnt vmcnt(12)
s_barrier
s_add_u32 m0, s5, 32768
s_add_u32 s37, s43, 3145728
buffer_load_dwordx4 v166, s[20:23], s37 offen lds
s_add_u32 m0, s5, 33792
s_add_u32 s37, s43, 3178496
buffer_load_dwordx4 v166, s[20:23], s37 offen lds
s_add_u32 m0, s5, 34816
s_add_u32 s37, s43, 3211264
buffer_load_dwordx4 v167, s[20:23], s37 offen lds
s_add_u32 m0, s5, 35840
s_add_u32 s37, s43, 3244032
buffer_load_dwordx4 v167, s[20:23], s37 offen lds
s_add_u32 m0, s5, 114688
s_add_u32 s37, s43, 3145984
buffer_load_dwordx4 v166, s[20:23], s37 offen lds
s_add_u32 m0, s5, 115712
s_add_u32 s37, s43, 3178752
buffer_load_dwordx4 v166, s[20:23], s37 offen lds
s_add_u32 m0, s5, 116736
s_add_u32 s37, s43, 3211520
buffer_load_dwordx4 v167, s[20:23], s37 offen lds
s_add_u32 m0, s5, 117760
s_add_u32 s37, s43, 3244288
buffer_load_dwordx4 v167, s[20:23], s37 offen lds
s_add_u32 m0, s5, 65536
s_add_u32 s37, s42, 768
buffer_load_dwordx4 v168, s[16:19], s37 offen lds
s_add_u32 m0, s5, 66560
s_add_u32 s37, s42, 8960
buffer_load_dwordx4 v169, s[16:19], s37 offen lds
s_add_u32 m0, s5, 67584
s_add_u32 s37, s42, 17152
buffer_load_dwordx4 v168, s[16:19], s37 offen lds
s_add_u32 m0, s5, 68608
s_add_u32 s37, s42, 25344
buffer_load_dwordx4 v169, s[16:19], s37 offen lds
s_add_u32 s36, s40, 0
s_add_u32 m0, s5, 0
s_nop 0
buffer_load_dwordx4 v2, s[8:11], s36 offen offset:0 nt lds
buffer_load_dwordx4 v3, s[8:11], s36 offen offset:1024 nt lds
buffer_load_dwordx4 v4, s[8:11], s36 offen offset:2048 nt lds
buffer_load_dwordx4 v5, s[8:11], s36 offen offset:3072 nt lds
s_waitcnt vmcnt(16)
s_barrier
s_add_u32 m0, s5, 49152
s_add_u32 s37, s43, 3670016
buffer_load_dwordx4 v166, s[20:23], s37 offen lds
s_add_u32 m0, s5, 50176
s_add_u32 s37, s43, 3702784
buffer_load_dwordx4 v166, s[20:23], s37 offen lds
s_add_u32 m0, s5, 51200
s_add_u32 s37, s43, 3735552
buffer_load_dwordx4 v167, s[20:23], s37 offen lds
s_add_u32 m0, s5, 52224
s_add_u32 s37, s43, 3768320
buffer_load_dwordx4 v167, s[20:23], s37 offen lds
s_add_u32 m0, s5, 131072
s_add_u32 s37, s43, 3670272
buffer_load_dwordx4 v166, s[20:23], s37 offen lds
s_add_u32 m0, s5, 132096
s_add_u32 s37, s43, 3703040
buffer_load_dwordx4 v166, s[20:23], s37 offen lds
s_add_u32 m0, s5, 133120
s_add_u32 s37, s43, 3735808
buffer_load_dwordx4 v167, s[20:23], s37 offen lds
s_add_u32 m0, s5, 134144
s_add_u32 s37, s43, 3768576
buffer_load_dwordx4 v167, s[20:23], s37 offen lds
s_add_u32 m0, s5, 147456
s_add_u32 s37, s42, 896
buffer_load_dwordx4 v168, s[16:19], s37 offen lds
s_add_u32 m0, s5, 148480
s_add_u32 s37, s42, 9088
buffer_load_dwordx4 v169, s[16:19], s37 offen lds
s_add_u32 m0, s5, 149504
s_add_u32 s37, s42, 17280
buffer_load_dwordx4 v168, s[16:19], s37 offen lds
s_add_u32 m0, s5, 150528
s_add_u32 s37, s42, 25472
buffer_load_dwordx4 v169, s[16:19], s37 offen lds
s_waitcnt vmcnt(16)
s_barrier
s_add_u32 s36, s40, 0
s_add_u32 m0, s5, 81920
s_nop 0
buffer_load_dwordx4 v6, s[12:15], s36 offen offset:0 nt lds
buffer_load_dwordx4 v7, s[12:15], s36 offen offset:1024 nt lds
buffer_load_dwordx4 v6, s[12:15], s36 offen offset:2048 nt lds
buffer_load_dwordx4 v7, s[12:15], s36 offen offset:3072 nt lds
s_add_u32 s36, s40, 16384
s_add_u32 m0, s5, 16384
s_nop 0
buffer_load_dwordx4 v2, s[8:11], s36 offen offset:0 nt lds
buffer_load_dwordx4 v3, s[8:11], s36 offen offset:1024 nt lds
buffer_load_dwordx4 v4, s[8:11], s36 offen offset:2048 nt lds
buffer_load_dwordx4 v5, s[8:11], s36 offen offset:3072 nt lds
s_waitcnt vmcnt(8)
s_barrier
s_add_u32 s36, s40, 16384
s_add_u32 m0, s5, 98304
s_nop 0
buffer_load_dwordx4 v6, s[12:15], s36 offen offset:0 nt lds
buffer_load_dwordx4 v7, s[12:15], s36 offen offset:1024 nt lds
buffer_load_dwordx4 v6, s[12:15], s36 offen offset:2048 nt lds
buffer_load_dwordx4 v7, s[12:15], s36 offen offset:3072 nt lds
s_barrier
s_barrier
s_add_u32 s36, s40, 32768
s_add_u32 m0, s5, 32768
s_nop 0
buffer_load_dwordx4 v2, s[8:11], s36 offen offset:0 nt lds
buffer_load_dwordx4 v3, s[8:11], s36 offen offset:1024 nt lds
buffer_load_dwordx4 v4, s[8:11], s36 offen offset:2048 nt lds
buffer_load_dwordx4 v5, s[8:11], s36 offen offset:3072 nt lds
s_add_u32 s36, s40, 32768
s_add_u32 m0, s5, 114688
s_nop 0
buffer_load_dwordx4 v6, s[12:15], s36 offen offset:0 nt lds
buffer_load_dwordx4 v7, s[12:15], s36 offen offset:1024 nt lds
buffer_load_dwordx4 v6, s[12:15], s36 offen offset:2048 nt lds
buffer_load_dwordx4 v7, s[12:15], s36 offen offset:3072 nt lds
s_waitcnt vmcnt(12)
s_waitcnt lgkmcnt(0)
s_barrier
s_cmp_ge_u32 s4, 4
s_cbranch_scc1 LL0
s_waitcnt vmcnt(0)
LL0:
s_add_u32 s36, s40, 49152
s_add_u32 m0, s5, 0
s_nop 0
buffer_load_dwordx4 v2, s[8:11], s36 offen offset:0 nt lds
buffer_load_dwordx4 v3, s[8:11], s36 offen offset:1024 nt lds
buffer_load_dwordx4 v4, s[8:11], s36 offen offset:2048 nt lds
buffer_load_dwordx4 v5, s[8:11], s36 offen offset:3072 nt lds
s_waitcnt vmcnt(8)
s_waitcnt lgkmcnt(0)
s_barrier
s_cmp_ge_u32 s4, 4
s_cbranch_scc1 LL1
s_waitcnt vmcnt(0)
LL1:
s_add_u32 m0, s5, 49152
s_add_u32 s37, s80, 0
buffer_load_dwordx4 v8, s[28:31], s37 offen lds
s_add_u32 m0, s5, 50176
s_add_u32 s37, s80, 4096
buffer_load_dwordx4 v9, s[28:31], s37 offen lds
s_add_u32 s36, s40, 65536
s_add_u32 m0, s5, 16384
s_nop 0
buffer_load_dwordx4 v2, s[8:11], s36 offen offset:0 nt lds
buffer_load_dwordx4 v3, s[8:11], s36 offen offset:1024 nt lds
buffer_load_dwordx4 v4, s[8:11], s36 offen offset:2048 nt lds
buffer_load_dwordx4 v5, s[8:11], s36 offen offset:3072 nt lds
s_add_u32 s36, s40, 49152
s_add_u32 m0, s5, 81920
s_nop 0
buffer_load_dwordx4 v6, s[12:15], s36 offen offset:0 nt lds
buffer_load_dwordx4 v7, s[12:15], s36 offen offset:1024 nt lds
buffer_load_dwordx4 v6, s[12:15], s36 offen offset:2048 nt lds
buffer_load_dwordx4 v7, s[12:15], s36 offen offset:3072 nt lds
s_waitcnt vmcnt(10)
s_waitcnt lgkmcnt(0)
s_barrier
s_cmp_ge_u32 s4, 4
s_cbranch_scc1 LL2
s_waitcnt vmcnt(0)
LL2:
s_cmp_lg_u32 s4, 0
s_cbranch_scc1 LE2b
s_add_u32 s36, s74, 2
v_mov_b32 v232, s36
v_mov_b32 v233, 0
s_mov_b64 exec, 1
buffer_store_dword v232, v233, s[24:27], s73 offen
s_mov_b64 exec, -1
LE2b:
s_add_u32 m0, s5, 51200
s_add_u32 s37, s80, 8192
buffer_load_dwordx4 v8, s[28:31], s37 offen lds
s_add_u32 m0, s5, 52224
s_add_u32 s37, s80, 12288
buffer_load_dwordx4 v9, s[28:31], s37 offen lds
s_add_u32 s36, s40, 81920
s_add_u32 m0, s5, 32768
s_nop 0
buffer_load_dwordx4 v2, s[8:11], s36 offen offset:0 nt lds
buffer_load_dwordx4 v3, s[8:11], s36 offen offset:1024 nt lds
buffer_load_dwordx4 v4, s[8:11], s36 offen offset:2048 nt lds
buffer_load_dwordx4 v5, s[8:11], s36 offen offset:3072 nt lds
s_add_u32 s36, s40, 65536
s_add_u32 m0, s5, 98304
s_nop 0
buffer_load_dwordx4 v6, s[12:15], s36 offen offset:0 nt lds
buffer_load_dwordx4 v7, s[12:15], s36 offen offset:1024 nt lds
buffer_load_dwordx4 v6, s[12:15], s36 offen offset:2048 nt lds
buffer_load_dwordx4 v7, s[12:15], s36 offen offset:3072 nt lds
s_waitcnt vmcnt(10)
s_waitcnt lgkmcnt(0)
s_barrier
s_cmp_ge_u32 s4, 4
s_cbranch_scc1 LL3
s_waitcnt vmcnt(0)
LL3:
s_cmp_lg_u32 s4, 0
s_cbranch_scc1 LE3b
LE3b:
s_cmp_lg_u32 s4, 0
s_cbranch_scc1 LE3c
buffer_load_dword v22, v0, s[24:27], 0 offen sc1
LE3c:
s_add_u32 m0, s5, 131072
s_add_u32 s37, s80, 65536
buffer_load_dwordx4 v8, s[28:31], s37 offen lds
s_add_u32 m0, s5, 132096
s_add_u32 s37, s80, 69632
buffer_load_dwordx4 v9, s[28:31], s37 offen lds
s_add_u32 s36, s40, 98304
s_add_u32 m0, s5, 0
s_nop 0
buffer_load_dwordx4 v2, s[8:11], s36 offen offset:0 nt lds
buffer_load_dwordx4 v3, s[8:11], s36 offen offset:1024 nt lds
buffer_load_dwordx4 v4, s[8:11], s36 offen offset:2048 nt lds
buffer_load_dwordx4 v5, s[8:11], s36 offen offset:3072 nt lds
s_add_u32 s36, s40, 81920
s_add_u32 m0, s5, 114688
s_nop 0
buffer_load_dwordx4 v6, s[12:15], s36 offen offset:0 nt lds
buffer_load_dwordx4 v7, s[12:15], s36 offen offset:1024 nt lds
buffer_load_dwordx4 v6, s[12:15], s36 offen offset:2048 nt lds
buffer_load_dwordx4 v7, s[12:15], s36 offen offset:3072 nt lds
s_waitcnt vmcnt(10)
v_subrev_u32 v19, s74, v22
s_waitcnt lgkmcnt(0)
s_barrier
s_cmp_ge_u32 s4, 4
s_cbranch_scc1 LL4
s_waitcnt vmcnt(2)
LL4:
s_cmp_lg_u32 s4, 0
s_cbranch_scc1 LE4b
s_add_u32 s36, s74, 4
v_mov_b32 v232, s36
v_mov_b32 v233, 0
s_mov_b64 exec, 1
buffer_store_dword v232, v233, s[24:27], s73 offen
s_mov_b64 exec, -1
LE4b:
s_add_u32 m0, s5, 133120
s_add_u32 s37, s80, 73728
buffer_load_dwordx4 v8, s[28:31], s37 offen lds
s_add_u32 m0, s5, 134144
s_add_u32 s37, s80, 77824
buffer_load_dwordx4 v9, s[28:31], s37 offen lds
s_add_u32 s36, s40, 114688
s_add_u32 m0, s5, 16384
s_nop 0
buffer_load_dwordx4 v2, s[8:11], s36 offen offset:0 nt lds
buffer_load_dwordx4 v3, s[8:11], s36 offen offset:1024 nt lds
buffer_load_dwordx4 v4, s[8:11], s36 offen offset:2048 nt lds
buffer_load_dwordx4 v5, s[8:11], s36 offen offset:3072 nt lds
s_add_u32 s36, s40, 98304
s_add_u32 m0, s5, 81920
s_nop 0
buffer_load_dwordx4 v6, s[12:15], s36 offen offset:0 nt lds
buffer_load_dwordx4 v7, s[12:15], s36 offen offset:1024 nt lds
buffer_load_dwordx4 v6, s[12:15], s36 offen offset:2048 nt lds
buffer_load_dwordx4 v7, s[12:15], s36 offen offset:3072 nt lds
ds_read_b64_tr_b16 v[88:89], v13 offset:49152
ds_read_b64_tr_b16 v[90:91], v13 offset:53248
ds_read_b64_tr_b16 v[92:93], v16 offset:49152
ds_read_b64_tr_b16 v[94:95], v16 offset:53248
ds_read_b64_tr_b16 v[96:97], v14 offset:8192
ds_read_b64_tr_b16 v[98:99], v14 offset:12288
ds_read_b64_tr_b16 v[100:101], v17 offset:8192
ds_read_b64_tr_b16 v[102:103], v17 offset:12288
s_waitcnt vmcnt(10)
s_waitcnt lgkmcnt(0)
s_barrier
s_cmp_ge_u32 s4, 4
s_cbranch_scc1 LL5
s_waitcnt vmcnt(4)
LL5:
s_cmp_lg_u32 s4, 0
s_cbranch_scc1 LE5b
v_cmp_gt_u32 vcc, 3, v19
s_bcnt1_i32_b64 s36, vcc
s_cmp_lt_u32 s36, 8
s_cbranch_scc1 LE5b
s_waitcnt vmcnt(0)
LE5b:
s_cmp_lg_u32 s4, 0
s_cbranch_scc1 LE5c
buffer_load_dword v22, v0, s[24:27], 0 offen sc1
LE5c:
s_add_u32 m0, s5, 49152
s_add_u32 s37, s81, 0
buffer_load_dwordx4 v8, s[28:31], s37 offen lds
s_add_u32 m0, s5, 50176
s_add_u32 s37, s81, 4096
buffer_load_dwordx4 v9, s[28:31], s37 offen lds
s_add_u32 s36, s40, 131072
s_add_u32 m0, s5, 32768
s_nop 0
buffer_load_dwordx4 v2, s[8:11], s36 offen offset:0 nt lds
buffer_load_dwordx4 v3, s[8:11], s36 offen offset:1024 nt lds
buffer_load_dwordx4 v4, s[8:11], s36 offen offset:2048 nt lds
buffer_load_dwordx4 v5, s[8:11], s36 offen offset:3072 nt lds
s_add_u32 s36, s40, 114688
s_add_u32 m0, s5, 98304
s_nop 0
buffer_load_dwordx4 v6, s[12:15], s36 offen offset:0 nt lds
buffer_load_dwordx4 v7, s[12:15], s36 offen offset:1024 nt lds
buffer_load_dwordx4 v6, s[12:15], s36 offen offset:2048 nt lds
buffer_load_dwordx4 v7, s[12:15], s36 offen offset:3072 nt lds
s_waitcnt vmcnt(10)
v_subrev_u32 v19, s74, v22
s_waitcnt lgkmcnt(0)
s_barrier
s_cmp_lg_u32 s4, 0
s_cbranch_scc1 LE6b
s_add_u32 s36, s74, 6
v_mov_b32 v232, s36
v_mov_b32 v233, 0
s_mov_b64 exec, 1
buffer_store_dword v232, v233, s[24:27], s73 offen
s_mov_b64 exec, -1
v_cmp_gt_u32 vcc, 4, v19
s_bcnt1_i32_b64 s36, vcc
s_cmp_lt_u32 s36, 8
s_cbranch_scc1 LE6b
s_waitcnt vmcnt(0)
LE6b:
s_add_u32 m0, s5, 51200
s_add_u32 s37, s81, 8192
buffer_load_dwordx4 v8, s[28:31], s37 offen lds
s_add_u32 m0, s5, 52224
s_add_u32 s37, s81, 12288
buffer_load_dwordx4 v9, s[28:31], s37 offen lds
s_add_u32 s36, s40, 147456
s_add_u32 m0, s5, 0
s_nop 0
buffer_load_dwordx4 v2, s[8:11], s36 offen offset:0 nt lds
buffer_load_dwordx4 v3, s[8:11], s36 offen offset:1024 nt lds
buffer_load_dwordx4 v4, s[8:11], s36 offen offset:2048 nt lds
buffer_load_dwordx4 v5, s[8:11], s36 offen offset:3072 nt lds
s_add_u32 s36, s40, 131072
s_add_u32 m0, s5, 114688
s_nop 0
buffer_load_dwordx4 v6, s[12:15], s36 offen offset:0 nt lds
buffer_load_dwordx4 v7, s[12:15], s36 offen offset:1024 nt lds
buffer_load_dwordx4 v6, s[12:15], s36 offen offset:2048 nt lds
buffer_load_dwordx4 v7, s[12:15], s36 offen offset:3072 nt lds
ds_read_b64_tr_b16 v[104:105], v15 offset:32768
ds_read_b64_tr_b16 v[106:107], v15 offset:36864
ds_read_b64_tr_b16 v[108:109], v18 offset:32768
ds_read_b64_tr_b16 v[110:111], v18 offset:36864
ds_read_b64_tr_b16 v[112:113], v15 offset:40960
ds_read_b64_tr_b16 v[114:115], v15 offset:45056
ds_read_b64_tr_b16 v[116:117], v18 offset:40960
ds_read_b64_tr_b16 v[118:119], v18 offset:45056
s_waitcnt vmcnt(10)
s_waitcnt lgkmcnt(0)
s_barrier
s_cmp_lg_u32 s4, 0
s_cbranch_scc1 LE7b
v_cmp_gt_u32 vcc, 5, v19
s_bcnt1_i32_b64 s36, vcc
s_cmp_lt_u32 s36, 8
s_cbranch_scc1 LE7b
s_waitcnt vmcnt(0)
LE7b:
s_cmp_lg_u32 s4, 0
s_cbranch_scc1 LE7c
buffer_load_dword v22, v0, s[24:27], 0 offen sc1
LE7c:
s_add_u32 m0, s5, 131072
s_add_u32 s37, s81, 65536
buffer_load_dwordx4 v8, s[28:31], s37 offen lds
s_add_u32 m0, s5, 132096
s_add_u32 s37, s81, 69632
buffer_load_dwordx4 v9, s[28:31], s37 offen lds
s_add_u32 s36, s40, 163840
s_add_u32 m0, s5, 16384
s_nop 0
buffer_load_dwordx4 v2, s[8:11], s36 offen offset:0 nt lds
buffer_load_dwordx4 v3, s[8:11], s36 offen offset:1024 nt lds
buffer_load_dwordx4 v4, s[8:11], s36 offen offset:2048 nt lds
buffer_load_dwordx4 v5, s[8:11], s36 offen offset:3072 nt lds
s_add_u32 s36, s40, 147456
s_add_u32 m0, s5, 81920
s_nop 0
buffer_load_dwordx4 v6, s[12:15], s36 offen offset:0 nt lds
buffer_load_dwordx4 v7, s[12:15], s36 offen offset:1024 nt lds
buffer_load_dwordx4 v6, s[12:15], s36 offen offset:2048 nt lds
buffer_load_dwordx4 v7, s[12:15], s36 offen offset:3072 nt lds
s_waitcnt vmcnt(10)
v_subrev_u32 v19, s74, v22
s_waitcnt lgkmcnt(0)
s_barrier
s_cmp_lg_u32 s4, 0
s_cbranch_scc1 LE8b
s_add_u32 s36, s74, 8
v_mov_b32 v232, s36
v_mov_b32 v233, 0
s_mov_b64 exec, 1
buffer_store_dword v232, v233, s[24:27], s73 offen
s_mov_b64 exec, -1
v_cmp_gt_u32 vcc, 6, v19
s_bcnt1_i32_b64 s36, vcc
s_cmp_lt_u32 s36, 8
s_cbranch_scc1 LE8b
s_waitcnt vmcnt(0)
LE8b:
s_add_u32 m0, s5, 133120
s_add_u32 s37, s81, 73728
buffer_load_dwordx4 v8, s[28:31], s37 offen lds
s_add_u32 m0, s5, 134144
s_add_u32 s37, s81, 77824
buffer_load_dwordx4 v9, s[28:31], s37 offen lds
s_add_u32 s36, s40, 180224
s_add_u32 m0, s5, 32768
s_nop 0
buffer_load_dwordx4 v2, s[8:11], s36 offen offset:0 nt lds
buffer_load_dwordx4 v3, s[8:11], s36 offen offset:1024 nt lds
buffer_load_dwordx4 v4, s[8:11], s36 offen offset:2048 nt lds
buffer_load_dwordx4 v5, s[8:11], s36 offen offset:3072 nt lds
s_add_u32 s36, s40, 163840
s_add_u32 m0, s5, 98304
s_nop 0
buffer_load_dwordx4 v6, s[12:15], s36 offen offset:0 nt lds
buffer_load_dwordx4 v7, s[12:15], s36 offen offset:1024 nt lds
buffer_load_dwordx4 v6, s[12:15], s36 offen offset:2048 nt lds
buffer_load_dwordx4 v7, s[12:15], s36 offen offset:3072 nt lds
ds_read_b64_tr_b16 v[120:121], v13 offset:49152
ds_read_b64_tr_b16 v[122:123], v13 offset:53248
ds_read_b64_tr_b16 v[124:125], v16 offset:49152
ds_read_b64_tr_b16 v[126:127], v16 offset:53248
ds_read_b64_tr_b16 v[128:129], v14 offset:8192
ds_read_b64_tr_b16 v[130:131], v14 offset:12288
ds_read_b64_tr_b16 v[132:133], v17 offset:8192
ds_read_b64_tr_b16 v[134:135], v17 offset:12288
s_waitcnt vmcnt(10)
s_waitcnt lgkmcnt(0)
s_barrier
s_cmp_lg_u32 s4, 0
s_cbranch_scc1 LE9b
v_cmp_gt_u32 vcc, 7, v19
s_bcnt1_i32_b64 s36, vcc
s_cmp_lt_u32 s36, 8
s_cbranch_scc1 LE9b
s_waitcnt vmcnt(0)
LE9b:
s_cmp_lg_u32 s4, 0
s_cbranch_scc1 LE9c
buffer_load_dword v22, v0, s[24:27], 0 offen sc1
LE9c:
s_add_u32 m0, s5, 49152
s_add_u32 s37, s82, 0
buffer_load_dwordx4 v8, s[28:31], s37 offen lds
s_add_u32 m0, s5, 50176
s_add_u32 s37, s82, 4096
buffer_load_dwordx4 v9, s[28:31], s37 offen lds
s_add_u32 s36, s40, 196608
s_add_u32 m0, s5, 0
s_nop 0
buffer_load_dwordx4 v2, s[8:11], s36 offen offset:0 nt lds
buffer_load_dwordx4 v3, s[8:11], s36 offen offset:1024 nt lds
buffer_load_dwordx4 v4, s[8:11], s36 offen offset:2048 nt lds
buffer_load_dwordx4 v5, s[8:11], s36 offen offset:3072 nt lds
s_add_u32 s36, s40, 180224
s_add_u32 m0, s5, 114688
s_nop 0
buffer_load_dwordx4 v6, s[12:15], s36 offen offset:0 nt lds
buffer_load_dwordx4 v7, s[12:15], s36 offen offset:1024 nt lds
buffer_load_dwordx4 v6, s[12:15], s36 offen offset:2048 nt lds
buffer_load_dwordx4 v7, s[12:15], s36 offen offset:3072 nt lds
s_waitcnt vmcnt(10)
v_subrev_u32 v19, s74, v22
s_waitcnt lgkmcnt(0)
s_barrier
s_cmp_lg_u32 s4, 0
s_cbranch_scc1 LE10b
s_add_u32 s36, s74, 10
v_mov_b32 v232, s36
v_mov_b32 v233, 0
s_mov_b64 exec, 1
buffer_store_dword v232, v233, s[24:27], s73 offen
s_mov_b64 exec, -1
v_cmp_gt_u32 vcc, 8, v19
s_bcnt1_i32_b64 s36, vcc
s_cmp_lt_u32 s36, 8
s_cbranch_scc1 LE10b
s_waitcnt vmcnt(0)
LE10b:
s_add_u32 m0, s5, 51200
s_add_u32 s37, s82, 8192
buffer_load_dwordx4 v8, s[28:31], s37 offen lds
s_add_u32 m0, s5, 52224
s_add_u32 s37, s82, 12288
buffer_load_dwordx4 v9, s[28:31], s37 offen lds
s_add_u32 s36, s40, 212992
s_add_u32 m0, s5, 16384
s_nop 0
buffer_load_dwordx4 v2, s[8:11], s36 offen offset:0 nt lds
buffer_load_dwordx4 v3, s[8:11], s36 offen offset:1024 nt lds
buffer_load_dwordx4 v4, s[8:11], s36 offen offset:2048 nt lds
buffer_load_dwordx4 v5, s[8:11], s36 offen offset:3072 nt lds
s_add_u32 s36, s40, 196608
s_add_u32 m0, s5, 81920
s_nop 0
buffer_load_dwordx4 v6, s[12:15], s36 offen offset:0 nt lds
buffer_load_dwordx4 v7, s[12:15], s36 offen offset:1024 nt lds
buffer_load_dwordx4 v6, s[12:15], s36 offen offset:2048 nt lds
buffer_load_dwordx4 v7, s[12:15], s36 offen offset:3072 nt lds
ds_read_b64_tr_b16 v[136:137], v15 offset:32768
ds_read_b64_tr_b16 v[138:139], v15 offset:36864
ds_read_b64_tr_b16 v[140:141], v18 offset:32768
ds_read_b64_tr_b16 v[142:143], v18 offset:36864
ds_read_b64_tr_b16 v[144:145], v15 offset:40960
ds_read_b64_tr_b16 v[146:147], v15 offset:45056
ds_read_b64_tr_b16 v[148:149], v18 offset:40960
ds_read_b64_tr_b16 v[150:151], v18 offset:45056
s_waitcnt vmcnt(10)
s_waitcnt lgkmcnt(0)
s_barrier
s_cmp_lg_u32 s4, 0
s_cbranch_scc1 LE11b
v_cmp_gt_u32 vcc, 9, v19
s_bcnt1_i32_b64 s36, vcc
s_cmp_lt_u32 s36, 8
s_cbranch_scc1 LE11b
s_waitcnt vmcnt(0)
LE11b:
s_cmp_lg_u32 s4, 0
s_cbranch_scc1 LE11c
buffer_load_dword v22, v0, s[24:27], 0 offen sc1
LE11c:
s_add_u32 m0, s5, 131072
s_add_u32 s37, s82, 65536
buffer_load_dwordx4 v8, s[28:31], s37 offen lds
s_add_u32 m0, s5, 132096
s_add_u32 s37, s82, 69632
buffer_load_dwordx4 v9, s[28:31], s37 offen lds
s_add_u32 s36, s40, 229376
s_add_u32 m0, s5, 32768
s_nop 0
buffer_load_dwordx4 v2, s[8:11], s36 offen offset:0 nt lds
buffer_load_dwordx4 v3, s[8:11], s36 offen offset:1024 nt lds
buffer_load_dwordx4 v4, s[8:11], s36 offen offset:2048 nt lds
buffer_load_dwordx4 v5, s[8:11], s36 offen offset:3072 nt lds
s_add_u32 s36, s40, 212992
s_add_u32 m0, s5, 98304
s_nop 0
buffer_load_dwordx4 v6, s[12:15], s36 offen offset:0 nt lds
buffer_load_dwordx4 v7, s[12:15], s36 offen offset:1024 nt lds
buffer_load_dwordx4 v6, s[12:15], s36 offen offset:2048 nt lds
buffer_load_dwordx4 v7, s[12:15], s36 offen offset:3072 nt lds
s_waitcnt vmcnt(10)
v_subrev_u32 v19, s74, v22
s_waitcnt lgkmcnt(0)
s_barrier
s_cmp_lg_u32 s4, 0
s_cbranch_scc1 LE12b
s_add_u32 s36, s74, 12
v_mov_b32 v232, s36
v_mov_b32 v233, 0
s_mov_b64 exec, 1
buffer_store_dword v232, v233, s[24:27], s73 offen
s_mov_b64 exec, -1
v_cmp_gt_u32 vcc, 10, v19
s_bcnt1_i32_b64 s36, vcc
s_cmp_lt_u32 s36, 8
s_cbranch_scc1 LE12b
s_waitcnt vmcnt(0)
LE12b:
s_add_u32 m0, s5, 133120
s_add_u32 s37, s82, 73728
buffer_load_dwordx4 v8, s[28:31], s37 offen lds
s_add_u32 m0, s5, 134144
s_add_u32 s37, s82, 77824
buffer_load_dwordx4 v9, s[28:31], s37 offen lds
s_add_u32 s36, s40, 245760
s_add_u32 m0, s5, 0
s_nop 0
buffer_load_dwordx4 v2, s[8:11], s36 offen offset:0 nt lds
buffer_load_dwordx4 v3, s[8:11], s36 offen offset:1024 nt lds
buffer_load_dwordx4 v4, s[8:11], s36 offen offset:2048 nt lds
buffer_load_dwordx4 v5, s[8:11], s36 offen offset:3072 nt lds
s_add_u32 s36, s40, 229376
s_add_u32 m0, s5, 114688
s_nop 0
buffer_load_dwordx4 v6, s[12:15], s36 offen offset:0 nt lds
buffer_load_dwordx4 v7, s[12:15], s36 offen offset:1024 nt lds
buffer_load_dwordx4 v6, s[12:15], s36 offen offset:2048 nt lds
buffer_load_dwordx4 v7, s[12:15], s36 offen offset:3072 nt lds
ds_read_b64_tr_b16 v[152:153], v13 offset:49152
ds_read_b64_tr_b16 v[154:155], v13 offset:53248
ds_read_b64_tr_b16 v[156:157], v16 offset:49152
ds_read_b64_tr_b16 v[158:159], v16 offset:53248
ds_read_b64_tr_b16 v[160:161], v14 offset:8192
ds_read_b64_tr_b16 v[162:163], v14 offset:12288
ds_read_b64_tr_b16 v[164:165], v17 offset:8192
ds_read_b64_tr_b16 v[166:167], v17 offset:12288
s_waitcnt vmcnt(10)
s_waitcnt lgkmcnt(0)
s_barrier
s_cmp_lg_u32 s4, 0
s_cbranch_scc1 LE13b
v_cmp_gt_u32 vcc, 11, v19
s_bcnt1_i32_b64 s36, vcc
s_cmp_lt_u32 s36, 8
s_cbranch_scc1 LE13b
s_waitcnt vmcnt(0)
LE13b:
s_cmp_lg_u32 s4, 0
s_cbranch_scc1 LE13c
buffer_load_dword v22, v0, s[24:27], 0 offen sc1
LE13c:
s_add_u32 m0, s5, 49152
s_add_u32 s37, s83, 0
buffer_load_dwordx4 v8, s[28:31], s37 offen lds
s_add_u32 m0, s5, 50176
s_add_u32 s37, s83, 4096
buffer_load_dwordx4 v9, s[28:31], s37 offen lds
s_add_u32 s36, s41, 0
s_add_u32 m0, s5, 16384
s_nop 0
buffer_load_dwordx4 v2, s[8:11], s36 offen offset:0 nt lds
buffer_load_dwordx4 v3, s[8:11], s36 offen offset:1024 nt lds
buffer_load_dwordx4 v4, s[8:11], s36 offen offset:2048 nt lds
buffer_load_dwordx4 v5, s[8:11], s36 offen offset:3072 nt lds
s_add_u32 s36, s40, 245760
s_add_u32 m0, s5, 81920
s_nop 0
buffer_load_dwordx4 v6, s[12:15], s36 offen offset:0 nt lds
buffer_load_dwordx4 v7, s[12:15], s36 offen offset:1024 nt lds
buffer_load_dwordx4 v6, s[12:15], s36 offen offset:2048 nt lds
buffer_load_dwordx4 v7, s[12:15], s36 offen offset:3072 nt lds
s_waitcnt vmcnt(10)
v_subrev_u32 v19, s74, v22
s_waitcnt lgkmcnt(0)
s_barrier
s_cmp_lg_u32 s4, 0
s_cbranch_scc1 LE14b
s_add_u32 s36, s74, 14
v_mov_b32 v232, s36
v_mov_b32 v233, 0
s_mov_b64 exec, 1
buffer_store_dword v232, v233, s[24:27], s73 offen
s_mov_b64 exec, -1
v_cmp_gt_u32 vcc, 12, v19
s_bcnt1_i32_b64 s36, vcc
s_cmp_lt_u32 s36, 8
s_cbranch_scc1 LE14b
s_waitcnt vmcnt(0)
LE14b:
s_add_u32 m0, s5, 51200
s_add_u32 s37, s83, 8192
buffer_load_dwordx4 v8, s[28:31], s37 offen lds
s_add_u32 m0, s5, 52224
s_add_u32 s37, s83, 12288
buffer_load_dwordx4 v9, s[28:31], s37 offen lds
s_add_u32 s36, s41, 16384
s_add_u32 m0, s5, 32768
s_nop 0
buffer_load_dwordx4 v2, s[8:11], s36 offen offset:0 nt lds
buffer_load_dwordx4 v3, s[8:11], s36 offen offset:1024 nt lds
buffer_load_dwordx4 v4, s[8:11], s36 offen offset:2048 nt lds
buffer_load_dwordx4 v5, s[8:11], s36 offen offset:3072 nt lds
s_add_u32 s36, s41, 0
s_add_u32 m0, s5, 98304
s_nop 0
buffer_load_dwordx4 v6, s[12:15], s36 offen offset:0 nt lds
buffer_load_dwordx4 v7, s[12:15], s36 offen offset:1024 nt lds
buffer_load_dwordx4 v6, s[12:15], s36 offen offset:2048 nt lds
buffer_load_dwordx4 v7, s[12:15], s36 offen offset:3072 nt lds
ds_read_b64_tr_b16 v[168:169], v15 offset:32768
ds_read_b64_tr_b16 v[170:171], v15 offset:36864
ds_read_b64_tr_b16 v[172:173], v18 offset:32768
ds_read_b64_tr_b16 v[174:175], v18 offset:36864
ds_read_b64_tr_b16 v[176:177], v15 offset:40960
ds_read_b64_tr_b16 v[178:179], v15 offset:45056
ds_read_b64_tr_b16 v[180:181], v18 offset:40960
ds_read_b64_tr_b16 v[182:183], v18 offset:45056
s_waitcnt vmcnt(10)
s_waitcnt lgkmcnt(0)
s_barrier
s_cmp_ge_u32 s4, 4
s_cbranch_scc1 LL15
s_waitcnt vmcnt(2)
LL15:
s_cmp_lg_u32 s4, 0
s_cbranch_scc1 LE15b
v_cmp_gt_u32 vcc, 13, v19
s_bcnt1_i32_b64 s36, vcc
s_cmp_lt_u32 s36, 8
s_cbranch_scc1 LE15b
s_waitcnt vmcnt(0)
LE15b:
s_cmp_lg_u32 s4, 0
s_cbranch_scc1 LE15c
buffer_load_dword v22, v0, s[24:27], 0 offen sc1
LE15c:
s_add_u32 m0, s5, 131072
s_add_u32 s37, s83, 65536
buffer_load_dwordx4 v8, s[28:31], s37 offen lds
s_add_u32 m0, s5, 132096
s_add_u32 s37, s83, 69632
buffer_load_dwordx4 v9, s[28:31], s37 offen lds
s_add_u32 s36, s41, 32768
s_add_u32 m0, s5, 0
s_nop 0
buffer_load_dwordx4 v2, s[8:11], s36 offen offset:0 nt lds
buffer_load_dwordx4 v3, s[8:11], s36 offen offset:1024 nt lds
buffer_load_dwordx4 v4, s[8:11], s36 offen offset:2048 nt lds
buffer_load_dwordx4 v5, s[8:11], s36 offen offset:3072 nt lds
s_add_u32 s36, s41, 16384
s_add_u32 m0, s5, 114688
s_nop 0
buffer_load_dwordx4 v6, s[12:15], s36 offen offset:0 nt lds
buffer_load_dwordx4 v7, s[12:15], s36 offen offset:1024 nt lds
buffer_load_dwordx4 v6, s[12:15], s36 offen offset:2048 nt lds
buffer_load_dwordx4 v7, s[12:15], s36 offen offset:3072 nt lds
s_waitcnt vmcnt(10)
v_subrev_u32 v19, s74, v22
s_waitcnt lgkmcnt(0)
s_barrier
s_cmp_ge_u32 s4, 4
s_cbranch_scc1 LL16
s_waitcnt vmcnt(2)
LL16:
s_cmp_lg_u32 s4, 0
s_cbranch_scc1 LE16b
s_add_u32 s36, s74, 16
v_mov_b32 v232, s36
v_mov_b32 v233, 0
s_mov_b64 exec, 1
buffer_store_dword v232, v233, s[24:27], s73 offen
s_mov_b64 exec, -1
v_cmp_gt_u32 vcc, 14, v19
s_bcnt1_i32_b64 s36, vcc
s_cmp_lt_u32 s36, 8
s_cbranch_scc1 LE16b
s_waitcnt vmcnt(0)
LE16b:
s_add_u32 m0, s5, 133120
s_add_u32 s37, s83, 73728
buffer_load_dwordx4 v8, s[28:31], s37 offen lds
s_add_u32 m0, s5, 134144
s_add_u32 s37, s83, 77824
buffer_load_dwordx4 v9, s[28:31], s37 offen lds
s_add_u32 s36, s41, 49152
s_add_u32 m0, s5, 16384
s_nop 0
buffer_load_dwordx4 v2, s[8:11], s36 offen offset:0 nt lds
buffer_load_dwordx4 v3, s[8:11], s36 offen offset:1024 nt lds
buffer_load_dwordx4 v4, s[8:11], s36 offen offset:2048 nt lds
buffer_load_dwordx4 v5, s[8:11], s36 offen offset:3072 nt lds
s_add_u32 s36, s41, 32768
s_add_u32 m0, s5, 81920
s_nop 0
buffer_load_dwordx4 v6, s[12:15], s36 offen offset:0 nt lds
buffer_load_dwordx4 v7, s[12:15], s36 offen offset:1024 nt lds
buffer_load_dwordx4 v6, s[12:15], s36 offen offset:2048 nt lds
buffer_load_dwordx4 v7, s[12:15], s36 offen offset:3072 nt lds
ds_read_b64_tr_b16 v[184:185], v13 offset:49152
ds_read_b64_tr_b16 v[186:187], v13 offset:53248
ds_read_b64_tr_b16 v[188:189], v16 offset:49152
ds_read_b64_tr_b16 v[190:191], v16 offset:53248
ds_read_b64_tr_b16 v[192:193], v14 offset:8192
ds_read_b64_tr_b16 v[194:195], v14 offset:12288
ds_read_b64_tr_b16 v[196:197], v17 offset:8192
ds_read_b64_tr_b16 v[198:199], v17 offset:12288
s_waitcnt vmcnt(10)
s_waitcnt lgkmcnt(0)
s_barrier
s_cmp_ge_u32 s4, 4
s_cbranch_scc1 LL17
s_waitcnt vmcnt(2)
LL17:
s_cmp_lg_u32 s4, 0
s_cbranch_scc1 LE17b
v_cmp_gt_u32 vcc, 15, v19
s_bcnt1_i32_b64 s36, vcc
s_cmp_lt_u32 s36, 8
s_cbranch_scc1 LE17b
s_waitcnt vmcnt(0)
LE17b:
s_cmp_lg_u32 s4, 0
s_cbranch_scc1 LE17c
buffer_load_dword v22, v0, s[24:27], 0 offen sc1
LE17c:
s_add_u32 m0, s5, 49152
s_add_u32 s37, s80, 131072
buffer_load_dwordx4 v8, s[28:31], s37 offen lds
s_add_u32 m0, s5, 50176
s_add_u32 s37, s80, 135168
buffer_load_dwordx4 v9, s[28:31], s37 offen lds
s_add_u32 s36, s41, 65536
s_add_u32 m0, s5, 32768
s_nop 0
buffer_load_dwordx4 v2, s[8:11], s36 offen offset:0 nt lds
buffer_load_dwordx4 v3, s[8:11], s36 offen offset:1024 nt lds
buffer_load_dwordx4 v4, s[8:11], s36 offen offset:2048 nt lds
buffer_load_dwordx4 v5, s[8:11], s36 offen offset:3072 nt lds
s_add_u32 s36, s41, 49152
s_add_u32 m0, s5, 98304
s_nop 0
buffer_load_dwordx4 v6, s[12:15], s36 offen offset:0 nt lds
buffer_load_dwordx4 v7, s[12:15], s36 offen offset:1024 nt lds
buffer_load_dwordx4 v6, s[12:15], s36 offen offset:2048 nt lds
buffer_load_dwordx4 v7, s[12:15], s36 offen offset:3072 nt lds
s_waitcnt vmcnt(10)
v_subrev_u32 v19, s74, v22
s_waitcnt lgkmcnt(0)
s_barrier
s_cmp_ge_u32 s4, 4
s_cbranch_scc1 LL18
s_waitcnt vmcnt(2)
LL18:
s_cmp_lg_u32 s4, 0
s_cbranch_scc1 LE18b
s_add_u32 s36, s74, 18
v_mov_b32 v232, s36
v_mov_b32 v233, 0
s_mov_b64 exec, 1
buffer_store_dword v232, v233, s[24:27], s73 offen
s_mov_b64 exec, -1
v_cmp_gt_u32 vcc, 16, v19
s_bcnt1_i32_b64 s36, vcc
s_cmp_lt_u32 s36, 8
s_cbranch_scc1 LE18b
s_waitcnt vmcnt(0)
LE18b:
s_add_u32 m0, s5, 51200
s_add_u32 s37, s80, 139264
buffer_load_dwordx4 v8, s[28:31], s37 offen lds
s_add_u32 m0, s5, 52224
s_add_u32 s37, s80, 143360
buffer_load_dwordx4 v9, s[28:31], s37 offen lds
s_add_u32 s36, s41, 81920
s_add_u32 m0, s5, 0
s_nop 0
buffer_load_dwordx4 v2, s[8:11], s36 offen offset:0 nt lds
buffer_load_dwordx4 v3, s[8:11], s36 offen offset:1024 nt lds
buffer_load_dwordx4 v4, s[8:11], s36 offen offset:2048 nt lds
buffer_load_dwordx4 v5, s[8:11], s36 offen offset:3072 nt lds
s_add_u32 s36, s41, 65536
s_add_u32 m0, s5, 114688
s_nop 0
buffer_load_dwordx4 v6, s[12:15], s36 offen offset:0 nt lds
buffer_load_dwordx4 v7, s[12:15], s36 offen offset:1024 nt lds
buffer_load_dwordx4 v6, s[12:15], s36 offen offset:2048 nt lds
buffer_load_dwordx4 v7, s[12:15], s36 offen offset:3072 nt lds
ds_read_b64_tr_b16 v[200:201], v15 offset:32768
ds_read_b64_tr_b16 v[202:203], v15 offset:36864
ds_read_b64_tr_b16 v[204:205], v18 offset:32768
ds_read_b64_tr_b16 v[206:207], v18 offset:36864
ds_read_b64_tr_b16 v[208:209], v15 offset:40960
ds_read_b64_tr_b16 v[210:211], v15 offset:45056
ds_read_b64_tr_b16 v[212:213], v18 offset:40960
ds_read_b64_tr_b16 v[214:215], v18 offset:45056
s_waitcnt vmcnt(10)
s_waitcnt lgkmcnt(0)
s_barrier
s_cmp_ge_u32 s4, 4
s_cbranch_scc1 LL19
s_waitcnt vmcnt(2)
LL19:
s_cmp_lg_u32 s4, 0
s_cbranch_scc1 LE19b
v_cmp_gt_u32 vcc, 17, v19
s_bcnt1_i32_b64 s36, vcc
s_cmp_lt_u32 s36, 8
s_cbranch_scc1 LE19b
s_waitcnt vmcnt(0)
LE19b:
s_cmp_lg_u32 s4, 0
s_cbranch_scc1 LE19c
buffer_load_dword v22, v0, s[24:27], 0 offen sc1
LE19c:
s_add_u32 m0, s5, 131072
s_add_u32 s37, s80, 196608
buffer_load_dwordx4 v8, s[28:31], s37 offen lds
s_add_u32 m0, s5, 132096
s_add_u32 s37, s80, 200704
buffer_load_dwordx4 v9, s[28:31], s37 offen lds
s_add_u32 s36, s41, 98304
s_add_u32 m0, s5, 16384
s_nop 0
buffer_load_dwordx4 v2, s[8:11], s36 offen offset:0 nt lds
buffer_load_dwordx4 v3, s[8:11], s36 offen offset:1024 nt lds
buffer_load_dwordx4 v4, s[8:11], s36 offen offset:2048 nt lds
buffer_load_dwordx4 v5, s[8:11], s36 offen offset:3072 nt lds
s_add_u32 s36, s41, 81920
s_add_u32 m0, s5, 81920
s_nop 0
buffer_load_dwordx4 v6, s[12:15], s36 offen offset:0 nt lds
buffer_load_dwordx4 v7, s[12:15], s36 offen offset:1024 nt lds
buffer_load_dwordx4 v6, s[12:15], s36 offen offset:2048 nt lds
buffer_load_dwordx4 v7, s[12:15], s36 offen offset:3072 nt lds
ds_read_b128 v[232:235], v11 offset:16384
ds_read_b128 v[236:239], v11 offset:17408
ds_read_b128 v[240:243], v11 offset:24576
ds_read_b128 v[244:247], v11 offset:25600
s_waitcnt lgkmcnt(3)
v_mfma_f32_16x16x32_bf16 v[24:27], v[88:91], v[232:235], 0
v_mfma_f32_16x16x32_bf16 v[28:31], v[92:95], v[232:235], 0
s_waitcnt lgkmcnt(2)
v_mfma_f32_16x16x32_bf16 v[32:35], v[88:91], v[236:239], 0
v_mfma_f32_16x16x32_bf16 v[36:39], v[92:95], v[236:239], 0
s_waitcnt lgkmcnt(1)
v_mfma_f32_16x16x32_bf16 v[40:43], v[88:91], v[240:243], 0
v_mfma_f32_16x16x32_bf16 v[44:47], v[92:95], v[240:243], 0
s_waitcnt lgkmcnt(0)
v_mfma_f32_16x16x32_bf16 v[48:51], v[88:91], v[244:247], 0
v_mfma_f32_16x16x32_bf16 v[52:55], v[92:95], v[244:247], 0
s_waitcnt vmcnt(10)
v_subrev_u32 v19, s74, v22
s_waitcnt lgkmcnt(0)
s_barrier
s_cmp_ge_u32 s4, 4
s_cbranch_scc1 LL20
s_waitcnt vmcnt(2)
LL20:
s_cmp_lg_u32 s4, 0
s_cbranch_scc1 LE20b
s_add_u32 s36, s74, 20
v_mov_b32 v232, s36
v_mov_b32 v233, 0
s_mov_b64 exec, 1
buffer_store_dword v232, v233, s[24:27], s73 offen
s_mov_b64 exec, -1
v_cmp_gt_u32 vcc, 18, v19
s_bcnt1_i32_b64 s36, vcc
s_cmp_lt_u32 s36, 8
s_cbranch_scc1 LE20b
s_waitcnt vmcnt(0)
LE20b:
s_add_u32 m0, s5, 133120
s_add_u32 s37, s80, 204800
buffer_load_dwordx4 v8, s[28:31], s37 offen lds
s_add_u32 m0, s5, 134144
s_add_u32 s37, s80, 208896
buffer_load_dwordx4 v9, s[28:31], s37 offen lds
s_add_u32 s36, s41, 114688
s_add_u32 m0, s5, 32768
s_nop 0
buffer_load_dwordx4 v2, s[8:11], s36 offen offset:0 nt lds
buffer_load_dwordx4 v3, s[8:11], s36 offen offset:1024 nt lds
buffer_load_dwordx4 v4, s[8:11], s36 offen offset:2048 nt lds
buffer_load_dwordx4 v5, s[8:11], s36 offen offset:3072 nt lds
s_add_u32 s36, s41, 98304
s_add_u32 m0, s5, 98304
s_nop 0
buffer_load_dwordx4 v6, s[12:15], s36 offen offset:0 nt lds
buffer_load_dwordx4 v7, s[12:15], s36 offen offset:1024 nt lds
buffer_load_dwordx4 v6, s[12:15], s36 offen offset:2048 nt lds
buffer_load_dwordx4 v7, s[12:15], s36 offen offset:3072 nt lds
ds_read_b64_tr_b16 v[216:217], v13 offset:49152
ds_read_b64_tr_b16 v[218:219], v13 offset:53248
ds_read_b64_tr_b16 v[220:221], v16 offset:49152
ds_read_b64_tr_b16 v[222:223], v16 offset:53248
ds_read_b64_tr_b16 v[224:225], v14 offset:8192
ds_read_b64_tr_b16 v[226:227], v14 offset:12288
ds_read_b64_tr_b16 v[228:229], v17 offset:8192
ds_read_b64_tr_b16 v[230:231], v17 offset:12288
ds_read_b128 v[232:235], v12 offset:49152
ds_read_b128 v[236:239], v12 offset:50176
ds_read_b128 v[240:243], v12 offset:57344
ds_read_b128 v[244:247], v12 offset:58368
s_waitcnt lgkmcnt(3)
v_mfma_f32_16x16x32_bf16 v[56:59], v[88:91], v[232:235], 0
v_mfma_f32_16x16x32_bf16 v[60:63], v[92:95], v[232:235], 0
s_waitcnt lgkmcnt(2)
v_mfma_f32_16x16x32_bf16 v[64:67], v[88:91], v[236:239], 0
v_mfma_f32_16x16x32_bf16 v[68:71], v[92:95], v[236:239], 0
s_waitcnt lgkmcnt(1)
v_mfma_f32_16x16x32_bf16 v[72:75], v[88:91], v[240:243], 0
v_mfma_f32_16x16x32_bf16 v[76:79], v[92:95], v[240:243], 0
s_waitcnt lgkmcnt(0)
v_mfma_f32_16x16x32_bf16 v[80:83], v[88:91], v[244:247], 0
v_mfma_f32_16x16x32_bf16 v[84:87], v[92:95], v[244:247], 0
s_waitcnt vmcnt(10)
s_waitcnt lgkmcnt(0)
s_barrier
s_cmp_ge_u32 s4, 4
s_cbranch_scc1 LL21
s_waitcnt vmcnt(2)
LL21:
s_cmp_lg_u32 s4, 0
s_cbranch_scc1 LE21b
v_cmp_gt_u32 vcc, 19, v19
s_bcnt1_i32_b64 s36, vcc
s_cmp_lt_u32 s36, 8
s_cbranch_scc1 LE21b
s_waitcnt vmcnt(0)
LE21b:
s_cmp_lg_u32 s4, 0
s_cbranch_scc1 LE21c
buffer_load_dword v22, v0, s[24:27], 0 offen sc1
LE21c:
s_add_u32 m0, s5, 49152
s_add_u32 s37, s81, 131072
buffer_load_dwordx4 v8, s[28:31], s37 offen lds
s_add_u32 m0, s5, 50176
s_add_u32 s37, s81, 135168
buffer_load_dwordx4 v9, s[28:31], s37 offen lds
s_add_u32 s36, s41, 131072
s_add_u32 m0, s5, 0
s_nop 0
buffer_load_dwordx4 v2, s[8:11], s36 offen offset:0 nt lds
buffer_load_dwordx4 v3, s[8:11], s36 offen offset:1024 nt lds
buffer_load_dwordx4 v4, s[8:11], s36 offen offset:2048 nt lds
buffer_load_dwordx4 v5, s[8:11], s36 offen offset:3072 nt lds
s_add_u32 s36, s41, 114688
s_add_u32 m0, s5, 114688
s_nop 0
buffer_load_dwordx4 v6, s[12:15], s36 offen offset:0 nt lds
buffer_load_dwordx4 v7, s[12:15], s36 offen offset:1024 nt lds
buffer_load_dwordx4 v6, s[12:15], s36 offen offset:2048 nt lds
buffer_load_dwordx4 v7, s[12:15], s36 offen offset:3072 nt lds
ds_read_b128 v[232:235], v11 offset:18432
ds_read_b128 v[236:239], v11 offset:19456
ds_read_b128 v[240:243], v11 offset:26624
ds_read_b128 v[244:247], v11 offset:27648
s_waitcnt lgkmcnt(3)
v_mfma_f32_16x16x32_bf16 v[24:27], v[96:99], v[232:235], v[24:27]
v_mfma_f32_16x16x32_bf16 v[28:31], v[100:103], v[232:235], v[28:31]
s_waitcnt lgkmcnt(2)
v_mfma_f32_16x16x32_bf16 v[32:35], v[96:99], v[236:239], v[32:35]
v_mfma_f32_16x16x32_bf16 v[36:39], v[100:103], v[236:239], v[36:39]
s_waitcnt lgkmcnt(1)
v_mfma_f32_16x16x32_bf16 v[40:43], v[96:99], v[240:243], v[40:43]
v_mfma_f32_16x16x32_bf16 v[44:47], v[100:103], v[240:243], v[44:47]
s_waitcnt lgkmcnt(0)
v_mfma_f32_16x16x32_bf16 v[48:51], v[96:99], v[244:247], v[48:51]
v_mfma_f32_16x16x32_bf16 v[52:55], v[100:103], v[244:247], v[52:55]
s_waitcnt vmcnt(10)
v_subrev_u32 v19, s74, v22
s_waitcnt lgkmcnt(0)
s_barrier
s_cmp_ge_u32 s4, 4
s_cbranch_scc1 LL22
s_waitcnt vmcnt(2)
LL22:
s_cmp_lg_u32 s4, 0
s_cbranch_scc1 LE22b
s_add_u32 s36, s74, 22
v_mov_b32 v232, s36
v_mov_b32 v233, 0
s_mov_b64 exec, 1
buffer_store_dword v232, v233, s[24:27], s73 offen
s_mov_b64 exec, -1
v_cmp_gt_u32 vcc, 20, v19
s_bcnt1_i32_b64 s36, vcc
s_cmp_lt_u32 s36, 8
s_cbranch_scc1 LE22b
s_waitcnt vmcnt(0)
LE22b:
s_add_u32 m0, s5, 51200
s_add_u32 s37, s81, 139264
buffer_load_dwordx4 v8, s[28:31], s37 offen lds
s_add_u32 m0, s5, 52224
s_add_u32 s37, s81, 143360
buffer_load_dwordx4 v9, s[28:31], s37 offen lds
s_add_u32 s36, s41, 147456
s_add_u32 m0, s5, 16384
s_nop 0
buffer_load_dwordx4 v2, s[8:11], s36 offen offset:0 nt lds
buffer_load_dwordx4 v3, s[8:11], s36 offen offset:1024 nt lds
buffer_load_dwordx4 v4, s[8:11], s36 offen offset:2048 nt lds
buffer_load_dwordx4 v5, s[8:11], s36 offen offset:3072 nt lds
s_add_u32 s36, s41, 131072
s_add_u32 m0, s5, 81920
s_nop 0
buffer_load_dwordx4 v6, s[12:15], s36 offen offset:0 nt lds
buffer_load_dwordx4 v7, s[12:15], s36 offen offset:1024 nt lds
buffer_load_dwordx4 v6, s[12:15], s36 offen offset:2048 nt lds
buffer_load_dwordx4 v7, s[12:15], s36 offen offset:3072 nt lds
ds_read_b128 v[232:235], v12 offset:51200
ds_read_b128 v[236:239], v12 offset:52224
ds_read_b128 v[240:243], v12 offset:59392
ds_read_b128 v[244:247], v12 offset:60416
s_waitcnt lgkmcnt(3)
v_mfma_f32_16x16x32_bf16 v[56:59], v[96:99], v[232:235], v[56:59]
v_mfma_f32_16x16x32_bf16 v[60:63], v[100:103], v[232:235], v[60:63]
s_waitcnt lgkmcnt(2)
v_mfma_f32_16x16x32_bf16 v[64:67], v[96:99], v[236:239], v[64:67]
v_mfma_f32_16x16x32_bf16 v[68:71], v[100:103], v[236:239], v[68:71]
s_waitcnt lgkmcnt(1)
v_mfma_f32_16x16x32_bf16 v[72:75], v[96:99], v[240:243], v[72:75]
v_mfma_f32_16x16x32_bf16 v[76:79], v[100:103], v[240:243], v[76:79]
s_waitcnt lgkmcnt(0)
v_mfma_f32_16x16x32_bf16 v[80:83], v[96:99], v[244:247], v[80:83]
v_mfma_f32_16x16x32_bf16 v[84:87], v[100:103], v[244:247], v[84:87]
ds_read_b64_tr_b16 v[88:89], v15 offset:32768
ds_read_b64_tr_b16 v[90:91], v15 offset:36864
ds_read_b64_tr_b16 v[92:93], v18 offset:32768
ds_read_b64_tr_b16 v[94:95], v18 offset:36864
ds_read_b64_tr_b16 v[96:97], v15 offset:40960
ds_read_b64_tr_b16 v[98:99], v15 offset:45056
ds_read_b64_tr_b16 v[100:101], v18 offset:40960
ds_read_b64_tr_b16 v[102:103], v18 offset:45056
s_waitcnt vmcnt(10)
s_waitcnt lgkmcnt(0)
s_barrier
s_cmp_ge_u32 s4, 4
s_cbranch_scc1 LL23
s_waitcnt vmcnt(2)
LL23:
s_cmp_lg_u32 s4, 0
s_cbranch_scc1 LE23b
v_cmp_gt_u32 vcc, 21, v19
s_bcnt1_i32_b64 s36, vcc
s_cmp_lt_u32 s36, 8
s_cbranch_scc1 LE23b
s_waitcnt vmcnt(0)
LE23b:
s_cmp_lg_u32 s4, 0
s_cbranch_scc1 LE23c
buffer_load_dword v22, v0, s[24:27], 0 offen sc1
LE23c:
s_add_u32 s36, s41, 163840
s_add_u32 m0, s5, 32768
s_nop 0
buffer_load_dwordx4 v2, s[8:11], s36 offen offset:0 nt lds
buffer_load_dwordx4 v3, s[8:11], s36 offen offset:1024 nt lds
buffer_load_dwordx4 v4, s[8:11], s36 offen offset:2048 nt lds
buffer_load_dwordx4 v5, s[8:11], s36 offen offset:3072 nt lds
s_add_u32 s36, s41, 147456
s_add_u32 m0, s5, 98304
s_nop 0
buffer_load_dwordx4 v6, s[12:15], s36 offen offset:0 nt lds
buffer_load_dwordx4 v7, s[12:15], s36 offen offset:1024 nt lds
buffer_load_dwordx4 v6, s[12:15], s36 offen offset:2048 nt lds
buffer_load_dwordx4 v7, s[12:15], s36 offen offset:3072 nt lds
ds_read_b128 v[232:235], v11 offset:20480
ds_read_b128 v[236:239], v11 offset:21504
ds_read_b128 v[240:243], v11 offset:28672
ds_read_b128 v[244:247], v11 offset:29696
s_waitcnt lgkmcnt(3)
v_mfma_f32_16x16x32_bf16 v[24:27], v[104:107], v[232:235], v[24:27]
v_mfma_f32_16x16x32_bf16 v[28:31], v[108:111], v[232:235], v[28:31]
s_waitcnt lgkmcnt(2)
v_mfma_f32_16x16x32_bf16 v[32:35], v[104:107], v[236:239], v[32:35]
v_mfma_f32_16x16x32_bf16 v[36:39], v[108:111], v[236:239], v[36:39]
s_waitcnt lgkmcnt(1)
v_mfma_f32_16x16x32_bf16 v[40:43], v[104:107], v[240:243], v[40:43]
v_mfma_f32_16x16x32_bf16 v[44:47], v[108:111], v[240:243], v[44:47]
s_waitcnt lgkmcnt(0)
v_mfma_f32_16x16x32_bf16 v[48:51], v[104:107], v[244:247], v[48:51]
v_mfma_f32_16x16x32_bf16 v[52:55], v[108:111], v[244:247], v[52:55]
s_waitcnt vmcnt(8)
v_subrev_u32 v19, s74, v22
s_waitcnt lgkmcnt(0)
s_barrier
s_cmp_ge_u32 s4, 4
s_cbranch_scc1 LL24
s_waitcnt vmcnt(2)
LL24:
s_cmp_lg_u32 s4, 0
s_cbranch_scc1 LE24b
s_add_u32 s36, s74, 24
v_mov_b32 v232, s36
v_mov_b32 v233, 0
s_mov_b64 exec, 1
buffer_store_dword v232, v233, s[24:27], s73 offen
s_mov_b64 exec, -1
v_cmp_gt_u32 vcc, 22, v19
s_bcnt1_i32_b64 s36, vcc
s_cmp_lt_u32 s36, 8
s_cbranch_scc1 LE24b
s_waitcnt vmcnt(0)
LE24b:
s_add_u32 m0, s5, 131072
s_add_u32 s37, s82, 131072
buffer_load_dwordx4 v8, s[28:31], s37 offen lds
s_add_u32 m0, s5, 132096
s_add_u32 s37, s82, 135168
buffer_load_dwordx4 v9, s[28:31], s37 offen lds
s_add_u32 s36, s41, 180224
s_add_u32 m0, s5, 0
s_nop 0
buffer_load_dwordx4 v2, s[8:11], s36 offen offset:0 nt lds
buffer_load_dwordx4 v3, s[8:11], s36 offen offset:1024 nt lds
buffer_load_dwordx4 v4, s[8:11], s36 offen offset:2048 nt lds
buffer_load_dwordx4 v5, s[8:11], s36 offen offset:3072 nt lds
s_add_u32 s36, s41, 163840
s_add_u32 m0, s5, 114688
s_nop 0
buffer_load_dwordx4 v6, s[12:15], s36 offen offset:0 nt lds
buffer_load_dwordx4 v7, s[12:15], s36 offen offset:1024 nt lds
buffer_load_dwordx4 v6, s[12:15], s36 offen offset:2048 nt lds
buffer_load_dwordx4 v7, s[12:15], s36 offen offset:3072 nt lds
ds_read_b128 v[232:235], v12 offset:53248
ds_read_b128 v[236:239], v12 offset:54272
ds_read_b128 v[240:243], v12 offset:61440
ds_read_b128 v[244:247], v12 offset:62464
s_waitcnt lgkmcnt(3)
v_mfma_f32_16x16x32_bf16 v[56:59], v[104:107], v[232:235], v[56:59]
v_mfma_f32_16x16x32_bf16 v[60:63], v[108:111], v[232:235], v[60:63]
s_waitcnt lgkmcnt(2)
v_mfma_f32_16x16x32_bf16 v[64:67], v[104:107], v[236:239], v[64:67]
v_mfma_f32_16x16x32_bf16 v[68:71], v[108:111], v[236:239], v[68:71]
s_waitcnt lgkmcnt(1)
v_mfma_f32_16x16x32_bf16 v[72:75], v[104:107], v[240:243], v[72:75]
v_mfma_f32_16x16x32_bf16 v[76:79], v[108:111], v[240:243], v[76:79]
s_waitcnt lgkmcnt(0)
v_mfma_f32_16x16x32_bf16 v[80:83], v[104:107], v[244:247], v[80:83]
v_mfma_f32_16x16x32_bf16 v[84:87], v[108:111], v[244:247], v[84:87]
s_waitcnt vmcnt(10)
s_waitcnt lgkmcnt(0)
s_barrier
s_cmp_ge_u32 s4, 4
s_cbranch_scc1 LL25
s_waitcnt vmcnt(2)
LL25:
s_cmp_lg_u32 s4, 0
s_cbranch_scc1 LE25b
v_cmp_gt_u32 vcc, 23, v19
s_bcnt1_i32_b64 s36, vcc
s_cmp_lt_u32 s36, 8
s_cbranch_scc1 LE25b
s_waitcnt vmcnt(0)
LE25b:
s_cmp_lg_u32 s4, 0
s_cbranch_scc1 LE25c
buffer_load_dword v22, v0, s[24:27], 0 offen sc1
LE25c:
s_add_u32 m0, s5, 133120
s_add_u32 s37, s82, 139264
buffer_load_dwordx4 v8, s[28:31], s37 offen lds
s_add_u32 m0, s5, 134144
s_add_u32 s37, s82, 143360
buffer_load_dwordx4 v9, s[28:31], s37 offen lds
s_add_u32 s36, s41, 196608
s_add_u32 m0, s5, 16384
s_nop 0
buffer_load_dwordx4 v2, s[8:11], s36 offen offset:0 nt lds
buffer_load_dwordx4 v3, s[8:11], s36 offen offset:1024 nt lds
buffer_load_dwordx4 v4, s[8:11], s36 offen offset:2048 nt lds
buffer_load_dwordx4 v5, s[8:11], s36 offen offset:3072 nt lds
s_add_u32 s36, s41, 180224
s_add_u32 m0, s5, 81920
s_nop 0
buffer_load_dwordx4 v6, s[12:15], s36 offen offset:0 nt lds
buffer_load_dwordx4 v7, s[12:15], s36 offen offset:1024 nt lds
buffer_load_dwordx4 v6, s[12:15], s36 offen offset:2048 nt lds
buffer_load_dwordx4 v7, s[12:15], s36 offen offset:3072 nt lds
ds_read_b128 v[232:235], v11 offset:22528
ds_read_b128 v[236:239], v11 offset:23552
ds_read_b128 v[240:243], v11 offset:30720
ds_read_b128 v[244:247], v11 offset:31744
s_waitcnt lgkmcnt(3)
v_mfma_f32_16x16x32_bf16 v[24:27], v[112:115], v[232:235], v[24:27]
v_mfma_f32_16x16x32_bf16 v[28:31], v[116:119], v[232:235], v[28:31]
s_waitcnt lgkmcnt(2)
v_mfma_f32_16x16x32_bf16 v[32:35], v[112:115], v[236:239], v[32:35]
v_mfma_f32_16x16x32_bf16 v[36:39], v[116:119], v[236:239], v[36:39]
s_waitcnt lgkmcnt(1)
v_mfma_f32_16x16x32_bf16 v[40:43], v[112:115], v[240:243], v[40:43]
v_mfma_f32_16x16x32_bf16 v[44:47], v[116:119], v[240:243], v[44:47]
s_waitcnt lgkmcnt(0)
v_mfma_f32_16x16x32_bf16 v[48:51], v[112:115], v[244:247], v[48:51]
v_mfma_f32_16x16x32_bf16 v[52:55], v[116:119], v[244:247], v[52:55]
s_waitcnt vmcnt(10)
v_subrev_u32 v19, s74, v22
s_waitcnt lgkmcnt(0)
s_barrier
s_cmp_ge_u32 s4, 4
s_cbranch_scc1 LL26
s_waitcnt vmcnt(2)
LL26:
s_cmp_lg_u32 s4, 0
s_cbranch_scc1 LE26b
s_add_u32 s36, s74, 26
v_mov_b32 v232, s36
v_mov_b32 v233, 0
s_mov_b64 exec, 1
buffer_store_dword v232, v233, s[24:27], s73 offen
s_mov_b64 exec, -1
v_cmp_gt_u32 vcc, 24, v19
s_bcnt1_i32_b64 s36, vcc
s_cmp_lt_u32 s36, 8
s_cbranch_scc1 LE26b
s_waitcnt vmcnt(0)
LE26b:
s_add_u32 s36, s41, 212992
s_add_u32 m0, s5, 32768
s_nop 0
buffer_load_dwordx4 v2, s[8:11], s36 offen offset:0 nt lds
buffer_load_dwordx4 v3, s[8:11], s36 offen offset:1024 nt lds
buffer_load_dwordx4 v4, s[8:11], s36 offen offset:2048 nt lds
buffer_load_dwordx4 v5, s[8:11], s36 offen offset:3072 nt lds
s_add_u32 s36, s41, 196608
s_add_u32 m0, s5, 98304
s_nop 0
buffer_load_dwordx4 v6, s[12:15], s36 offen offset:0 nt lds
buffer_load_dwordx4 v7, s[12:15], s36 offen offset:1024 nt lds
buffer_load_dwordx4 v6, s[12:15], s36 offen offset:2048 nt lds
buffer_load_dwordx4 v7, s[12:15], s36 offen offset:3072 nt lds
s_cmp_lg_u32 s3, 7
s_cbranch_scc1 L_cp1_26_e
s_getpc_b64 s[92:93]
L_cp1_26_p:
s_sub_u32 s92, s92, L_cp1_26_p-standalone__mha_block_cached__near_ridge_kernel
s_subb_u32 s93, s93, 0
s_and_b32 s93, s93, 0xffff
s_mov_b32 s94, L_code_end-standalone__mha_block_cached__near_ridge_kernel
s_mov_b32 s95, 0x20000
s_lshr_b32 s36, s2, 3
s_lshl_b32 s36, s36, 7
v_lshlrev_b32 v254, 12, v1
s_mov_b64 exec, 0xffff
buffer_load_dword v10, v254, s[92:95], s36 offen
s_mov_b64 exec, -1
L_cp1_26_e:
ds_read_b128 v[232:235], v12 offset:55296
ds_read_b128 v[236:239], v12 offset:56320
ds_read_b128 v[240:243], v12 offset:63488
ds_read_b128 v[244:247], v12 offset:64512
s_waitcnt lgkmcnt(3)
v_mfma_f32_16x16x32_bf16 v[56:59], v[112:115], v[232:235], v[56:59]
v_mfma_f32_16x16x32_bf16 v[60:63], v[116:119], v[232:235], v[60:63]
s_waitcnt lgkmcnt(2)
v_mfma_f32_16x16x32_bf16 v[64:67], v[112:115], v[236:239], v[64:67]
v_mfma_f32_16x16x32_bf16 v[68:71], v[116:119], v[236:239], v[68:71]
s_waitcnt lgkmcnt(1)
v_mfma_f32_16x16x32_bf16 v[72:75], v[112:115], v[240:243], v[72:75]
v_mfma_f32_16x16x32_bf16 v[76:79], v[116:119], v[240:243], v[76:79]
s_waitcnt lgkmcnt(0)
v_mfma_f32_16x16x32_bf16 v[80:83], v[112:115], v[244:247], v[80:83]
v_mfma_f32_16x16x32_bf16 v[84:87], v[116:119], v[244:247], v[84:87]
ds_read_b64_tr_b16 v[104:105], v13 offset:49152
ds_read_b64_tr_b16 v[106:107], v13 offset:53248
ds_read_b64_tr_b16 v[108:109], v16 offset:49152
ds_read_b64_tr_b16 v[110:111], v16 offset:53248
ds_read_b64_tr_b16 v[112:113], v14 offset:8192
ds_read_b64_tr_b16 v[114:115], v14 offset:12288
ds_read_b64_tr_b16 v[116:117], v17 offset:8192
ds_read_b64_tr_b16 v[118:119], v17 offset:12288
s_waitcnt vmcnt(8)
s_waitcnt lgkmcnt(0)
s_barrier
s_cmp_ge_u32 s4, 4
s_cbranch_scc1 LL27
s_waitcnt vmcnt(2)
LL27:
s_cmp_lg_u32 s4, 0
s_cbranch_scc1 LE27b
v_cmp_gt_u32 vcc, 25, v19
s_bcnt1_i32_b64 s36, vcc
s_cmp_lt_u32 s36, 8
s_cbranch_scc1 LE27b
s_waitcnt vmcnt(0)
LE27b:
s_cmp_lg_u32 s4, 0
s_cbranch_scc1 LE27c
buffer_load_dword v22, v0, s[24:27], 0 offen sc1
LE27c:
s_add_u32 m0, s5, 49152
s_add_u32 s37, s81, 196608
buffer_load_dwordx4 v8, s[28:31], s37 offen lds
s_add_u32 m0, s5, 50176
s_add_u32 s37, s81, 200704
buffer_load_dwordx4 v9, s[28:31], s37 offen lds
s_add_u32 s36, s41, 229376
s_add_u32 m0, s5, 0
s_nop 0
buffer_load_dwordx4 v2, s[8:11], s36 offen offset:0 nt lds
buffer_load_dwordx4 v3, s[8:11], s36 offen offset:1024 nt lds
buffer_load_dwordx4 v4, s[8:11], s36 offen offset:2048 nt lds
buffer_load_dwordx4 v5, s[8:11], s36 offen offset:3072 nt lds
s_add_u32 s36, s41, 212992
s_add_u32 m0, s5, 114688
s_nop 0
buffer_load_dwordx4 v6, s[12:15], s36 offen offset:0 nt lds
buffer_load_dwordx4 v7, s[12:15], s36 offen offset:1024 nt lds
buffer_load_dwordx4 v6, s[12:15], s36 offen offset:2048 nt lds
buffer_load_dwordx4 v7, s[12:15], s36 offen offset:3072 nt lds
s_waitcnt vmcnt(10)
v_subrev_u32 v19, s74, v22
s_waitcnt lgkmcnt(0)
s_barrier
s_cmp_ge_u32 s4, 4
s_cbranch_scc1 LL28
s_waitcnt vmcnt(2)
LL28:
s_cmp_lg_u32 s4, 0
s_cbranch_scc1 LE28b
s_add_u32 s36, s74, 28
v_mov_b32 v232, s36
v_mov_b32 v233, 0
s_mov_b64 exec, 1
buffer_store_dword v232, v233, s[24:27], s73 offen
s_mov_b64 exec, -1
v_cmp_gt_u32 vcc, 26, v19
s_bcnt1_i32_b64 s36, vcc
s_cmp_lt_u32 s36, 8
s_cbranch_scc1 LE28b
s_waitcnt vmcnt(0)
LE28b:
s_add_u32 m0, s5, 51200
s_add_u32 s37, s81, 204800
buffer_load_dwordx4 v8, s[28:31], s37 offen lds
s_add_u32 m0, s5, 52224
s_add_u32 s37, s81, 208896
buffer_load_dwordx4 v9, s[28:31], s37 offen lds
s_mov_b64 exec, 0x111
buffer_load_dword v22, v21, s[24:27], 0 offen offset:32 sc1
s_mov_b64 exec, -1
s_add_u32 s36, s41, 245760
s_add_u32 m0, s5, 16384
s_nop 0
buffer_load_dwordx4 v2, s[8:11], s36 offen offset:0 nt lds
buffer_load_dwordx4 v3, s[8:11], s36 offen offset:1024 nt lds
buffer_load_dwordx4 v4, s[8:11], s36 offen offset:2048 nt lds
buffer_load_dwordx4 v5, s[8:11], s36 offen offset:3072 nt lds
s_add_u32 s36, s41, 229376
s_add_u32 m0, s5, 81920
s_nop 0
buffer_load_dwordx4 v6, s[12:15], s36 offen offset:0 nt lds
buffer_load_dwordx4 v7, s[12:15], s36 offen offset:1024 nt lds
buffer_load_dwordx4 v6, s[12:15], s36 offen offset:2048 nt lds
buffer_load_dwordx4 v7, s[12:15], s36 offen offset:3072 nt lds
s_waitcnt vmcnt(8)
s_waitcnt lgkmcnt(0)
s_barrier
s_add_u32 s36, s41, 245760
s_add_u32 m0, s5, 98304
s_nop 0
buffer_load_dwordx4 v6, s[12:15], s36 offen offset:0 nt lds
buffer_load_dwordx4 v7, s[12:15], s36 offen offset:1024 nt lds
buffer_load_dwordx4 v6, s[12:15], s36 offen offset:2048 nt lds
buffer_load_dwordx4 v7, s[12:15], s36 offen offset:3072 nt lds
s_getreg_b32 s36, hwreg(HW_REG_XCC_ID, 0, 4)
s_lshl_b32 s37, s7, 4
s_or_b32 s37, s37, s36
s_mov_b64 exec, 0x111
v_cmp_ne_u32 vcc, s37, v22
s_mov_b64 exec, -1
s_cmp_eq_u64 vcc, 0
s_cselect_b32 s35, 1, 0
s_xor_b32 s37, s4, s34
s_and_b32 s36, s37, 1
s_lshl_b32 s36, s36, 13
s_lshr_b32 s37, s37, 1
s_mul_i32 s37, s37, 81920
s_add_u32 s36, s36, s37
s_add_u32 s36, s36, 65536
v_add_u32 v22, s36, v20
s_lshl_b32 s36, s32, 5
s_add_u32 s36, s36, s33
s_add_u32 s36, s36, 0
s_lshl_b32 s36, s36, 2
s_add_u32 s36, s36, s4
s_lshl_b32 s36, s36, 13
s_add_u32 s37, s36, 4096
s_cmp_eq_u32 s35, 0
s_cbranch_scc1 LH_pub_s
ds_read_b128 v[232:235], v22 offset:0
ds_read_b128 v[236:239], v22 offset:1024
ds_read_b128 v[240:243], v22 offset:2048
ds_read_b128 v[244:247], v22 offset:3072
ds_read_b128 v[248:251], v22 offset:4096
ds_read_b128 v[252:255], v22 offset:5120
s_waitcnt lgkmcnt(5)
buffer_store_dwordx4 v[232:235], v20, s[24:27], s36 offen offset:0
s_waitcnt lgkmcnt(4)
buffer_store_dwordx4 v[236:239], v20, s[24:27], s36 offen offset:1024
s_waitcnt lgkmcnt(3)
buffer_store_dwordx4 v[240:243], v20, s[24:27], s36 offen offset:2048
s_waitcnt lgkmcnt(2)
buffer_store_dwordx4 v[244:247], v20, s[24:27], s36 offen offset:3072
s_waitcnt lgkmcnt(1)
buffer_store_dwordx4 v[248:251], v20, s[24:27], s37 offen offset:0
s_waitcnt lgkmcnt(0)
buffer_store_dwordx4 v[252:255], v20, s[24:27], s37 offen offset:1024
ds_read_b128 v[232:235], v22 offset:6144
ds_read_b128 v[236:239], v22 offset:7168
s_waitcnt lgkmcnt(1)
buffer_store_dwordx4 v[232:235], v20, s[24:27], s37 offen offset:2048
s_waitcnt lgkmcnt(0)
buffer_store_dwordx4 v[236:239], v20, s[24:27], s37 offen offset:3072
s_branch LH_pub_e
LH_pub_s:
ds_read_b128 v[232:235], v22 offset:0
ds_read_b128 v[236:239], v22 offset:1024
ds_read_b128 v[240:243], v22 offset:2048
ds_read_b128 v[244:247], v22 offset:3072
ds_read_b128 v[248:251], v22 offset:4096
ds_read_b128 v[252:255], v22 offset:5120
s_waitcnt lgkmcnt(5)
buffer_store_dwordx4 v[232:235], v20, s[24:27], s36 offen offset:0 sc1
s_waitcnt lgkmcnt(4)
buffer_store_dwordx4 v[236:239], v20, s[24:27], s36 offen offset:1024 sc1
s_waitcnt lgkmcnt(3)
buffer_store_dwordx4 v[240:243], v20, s[24:27], s36 offen offset:2048 sc1
s_waitcnt lgkmcnt(2)
buffer_store_dwordx4 v[244:247], v20, s[24:27], s36 offen offset:3072 sc1
s_waitcnt lgkmcnt(1)
buffer_store_dwordx4 v[248:251], v20, s[24:27], s37 offen offset:0 sc1
s_waitcnt lgkmcnt(0)
buffer_store_dwordx4 v[252:255], v20, s[24:27], s37 offen offset:1024 sc1
ds_read_b128 v[232:235], v22 offset:6144
ds_read_b128 v[236:239], v22 offset:7168
s_waitcnt lgkmcnt(1)
buffer_store_dwordx4 v[232:235], v20, s[24:27], s37 offen offset:2048 sc1
s_waitcnt lgkmcnt(0)
buffer_store_dwordx4 v[236:239], v20, s[24:27], s37 offen offset:3072 sc1
LH_pub_e:
s_add_u32 m0, s5, 32768
s_add_u32 s37, s82, 196608
buffer_load_dwordx4 v8, s[28:31], s37 offen lds
s_add_u32 m0, s5, 33792
s_add_u32 s37, s82, 200704
buffer_load_dwordx4 v9, s[28:31], s37 offen lds
s_add_u32 m0, s5, 34816
s_add_u32 s37, s82, 204800
buffer_load_dwordx4 v8, s[28:31], s37 offen lds
s_add_u32 m0, s5, 35840
s_add_u32 s37, s82, 208896
buffer_load_dwordx4 v9, s[28:31], s37 offen lds
s_waitcnt vmcnt(16)
s_waitcnt lgkmcnt(0)
s_barrier
s_add_u32 m0, s5, 0
s_add_u32 s37, s83, 131072
buffer_load_dwordx4 v8, s[28:31], s37 offen lds
s_add_u32 m0, s5, 1024
s_add_u32 s37, s83, 135168
buffer_load_dwordx4 v9, s[28:31], s37 offen lds
s_add_u32 m0, s5, 2048
s_add_u32 s37, s83, 139264
buffer_load_dwordx4 v8, s[28:31], s37 offen lds
s_add_u32 m0, s5, 3072
s_add_u32 s37, s83, 143360
buffer_load_dwordx4 v9, s[28:31], s37 offen lds
s_add_u32 m0, s5, 114688
s_add_u32 s37, s83, 196608
buffer_load_dwordx4 v8, s[28:31], s37 offen lds
s_add_u32 m0, s5, 115712
s_add_u32 s37, s83, 200704
buffer_load_dwordx4 v9, s[28:31], s37 offen lds
s_add_u32 m0, s5, 116736
s_add_u32 s37, s83, 204800
buffer_load_dwordx4 v8, s[28:31], s37 offen lds
s_add_u32 m0, s5, 117760
s_add_u32 s37, s83, 208896
buffer_load_dwordx4 v9, s[28:31], s37 offen lds
s_bfe_u32 s38, s2, 0x20003
s_lshl_b32 s39, s32, 2
s_add_u32 s39, s39, s38
s_xor_b32 s36, s34, 1
s_lshl_b32 s37, s39, 2
s_add_u32 s36, s36, s37
s_lshl_b32 s36, s36, 2
s_add_u32 s36, s36, s34
s_lshl_b32 s36, s36, 2
s_add_u32 s36, s36, s4
s_lshl_b32 s36, s36, 12
s_add_u32 s87, s36, 16777216
s_xor_b32 s36, s34, 1
s_lshl_b32 s37, s39, 2
s_add_u32 s37, s37, s34
s_lshl_b32 s37, s37, 2
s_add_u32 s36, s36, s37
s_lshl_b32 s36, s36, 2
s_add_u32 s36, s36, s4
s_lshl_b32 s36, s36, 12
s_add_u32 s96, s36, 16777216
s_xor_b32 s36, s34, 2
s_lshl_b32 s37, s39, 2
s_add_u32 s36, s36, s37
s_lshl_b32 s36, s36, 2
s_add_u32 s36, s36, s34
s_lshl_b32 s36, s36, 2
s_add_u32 s36, s36, s4
s_lshl_b32 s36, s36, 12
s_add_u32 s88, s36, 16777216
s_xor_b32 s36, s34, 2
s_lshl_b32 s37, s39, 2
s_add_u32 s37, s37, s34
s_lshl_b32 s37, s37, 2
s_add_u32 s36, s36, s37
s_lshl_b32 s36, s36, 2
s_add_u32 s36, s36, s4
s_lshl_b32 s36, s36, 12
s_add_u32 s97, s36, 16777216
s_xor_b32 s36, s34, 3
s_lshl_b32 s37, s39, 2
s_add_u32 s36, s36, s37
s_lshl_b32 s36, s36, 2
s_add_u32 s36, s36, s34
s_lshl_b32 s36, s36, 2
s_add_u32 s36, s36, s4
s_lshl_b32 s36, s36, 12
s_add_u32 s89, s36, 16777216
s_xor_b32 s36, s34, 3
s_lshl_b32 s37, s39, 2
s_add_u32 s37, s37, s34
s_lshl_b32 s37, s37, 2
s_add_u32 s36, s36, s37
s_lshl_b32 s36, s36, 2
s_add_u32 s36, s36, s4
s_lshl_b32 s36, s36, 12
s_add_u32 s98, s36, 16777216
v_add_u32 v2, 1, v1
v_xor_b32 v2, s34, v2
s_lshl_b32 s36, s39, 9
s_add_u32 s36, s36, 33587200
s_lshl_b32 s37, s4, 2
s_add_u32 s36, s36, s37
s_lshl_b32 s37, s34, 4
s_add_u32 s37, s37, s36
v_lshlrev_b32 v3, 7, v2
v_add_u32 v3, s37, v3
s_lshl_b32 s37, s34, 7
s_add_u32 s37, s37, s36
v_lshlrev_b32 v5, 4, v2
v_add_u32 v5, s37, v5
v_mov_b32 v4, s7
s_waitcnt vmcnt(12)
s_lshl_b32 s38, s2, 7
s_lshl_b32 s39, s4, 2
s_add_u32 s38, s38, s39
s_add_u32 s38, s38, 33554432
v_mov_b32 v232, s7
v_mov_b32 v233, 0
s_mov_b64 exec, 1
s_cmp_eq_u32 s35, 0
s_cbranch_scc1 LH_fl_s
buffer_store_dword v232, v233, s[24:27], s38 offen
s_branch LH_fl_e
LH_fl_s:
buffer_store_dword v232, v233, s[24:27], s38 offen sc1
LH_fl_e:
s_mov_b64 exec, -1
s_waitcnt lgkmcnt(0)
s_barrier
LH_p0:
s_mov_b64 exec, 0xfff
buffer_load_dword v19, v21, s[24:27], 0 offen offset:0 sc1
s_waitcnt vmcnt(0)
v_cmp_ne_u32 vcc, s7, v19
s_mov_b64 exec, -1
s_cbranch_vccnz LH_p0
s_and_b32 s36, s4, 1
s_lshl_b32 s36, s36, 13
s_lshr_b32 s37, s4, 1
s_mul_i32 s37, s37, 81920
s_add_u32 s36, s36, s37
s_add_u32 m0, s36, 65536
s_add_u32 s37, s84, 0
buffer_load_dwordx4 v20, s[24:27], s37 offen offset:0 sc1 lds
buffer_load_dwordx4 v20, s[24:27], s37 offen offset:1024 sc1 lds
buffer_load_dwordx4 v20, s[24:27], s37 offen offset:2048 sc1 lds
buffer_load_dwordx4 v20, s[24:27], s37 offen offset:3072 sc1 lds
s_add_u32 m0, m0, 4096
s_add_u32 s37, s37, 4096
buffer_load_dwordx4 v20, s[24:27], s37 offen offset:0 sc1 lds
buffer_load_dwordx4 v20, s[24:27], s37 offen offset:1024 sc1 lds
buffer_load_dwordx4 v20, s[24:27], s37 offen offset:2048 sc1 lds
buffer_load_dwordx4 v20, s[24:27], s37 offen offset:3072 sc1 lds
v_mov_b32 v21, v5
s_setprio 3
s_barrier
ds_read_b128 v[232:235], v11 offset:32768
ds_read_b128 v[236:239], v11 offset:33792
ds_read_b128 v[240:243], v11 offset:40960
ds_read_b128 v[244:247], v11 offset:41984
ds_read_b128 v[248:251], v20 offset:16384
s_waitcnt lgkmcnt(4)
v_mfma_f32_16x16x32_bf16 v[24:27], v[216:219], v[232:235], v[24:27]
v_mfma_f32_16x16x32_bf16 v[28:31], v[220:223], v[232:235], v[28:31]
ds_read_b128 v[252:255], v20 offset:17408
s_waitcnt lgkmcnt(4)
v_mfma_f32_16x16x32_bf16 v[32:35], v[216:219], v[236:239], v[32:35]
v_mfma_f32_16x16x32_bf16 v[36:39], v[220:223], v[236:239], v[36:39]
ds_read_b128 v[232:235], v20 offset:24576
s_waitcnt lgkmcnt(4)
v_mfma_f32_16x16x32_bf16 v[40:43], v[216:219], v[240:243], v[40:43]
v_mfma_f32_16x16x32_bf16 v[44:47], v[220:223], v[240:243], v[44:47]
ds_read_b128 v[236:239], v20 offset:25600
s_waitcnt lgkmcnt(4)
v_mfma_f32_16x16x32_bf16 v[48:51], v[216:219], v[244:247], v[48:51]
v_mfma_f32_16x16x32_bf16 v[52:55], v[220:223], v[244:247], v[52:55]
ds_read_b128 v[240:243], v11 offset:34816
s_waitcnt lgkmcnt(4)
v_mfma_f32_16x16x32_bf16 v[56:59], v[216:219], v[248:251], v[56:59]
v_mfma_f32_16x16x32_bf16 v[60:63], v[220:223], v[248:251], v[60:63]
ds_read_b128 v[244:247], v11 offset:35840
s_waitcnt lgkmcnt(4)
v_mfma_f32_16x16x32_bf16 v[64:67], v[216:219], v[252:255], v[64:67]
v_mfma_f32_16x16x32_bf16 v[68:71], v[220:223], v[252:255], v[68:71]
ds_read_b128 v[248:251], v11 offset:43008
s_waitcnt lgkmcnt(4)
v_mfma_f32_16x16x32_bf16 v[72:75], v[216:219], v[232:235], v[72:75]
v_mfma_f32_16x16x32_bf16 v[76:79], v[220:223], v[232:235], v[76:79]
ds_read_b128 v[252:255], v11 offset:44032
s_waitcnt lgkmcnt(4)
v_mfma_f32_16x16x32_bf16 v[80:83], v[216:219], v[236:239], v[80:83]
v_mfma_f32_16x16x32_bf16 v[84:87], v[220:223], v[236:239], v[84:87]
ds_read_b128 v[232:235], v20 offset:18432
s_waitcnt lgkmcnt(4)
v_mfma_f32_16x16x32_bf16 v[24:27], v[224:227], v[240:243], v[24:27]
v_mfma_f32_16x16x32_bf16 v[28:31], v[228:231], v[240:243], v[28:31]
ds_read_b128 v[236:239], v20 offset:19456
s_waitcnt lgkmcnt(4)
v_mfma_f32_16x16x32_bf16 v[32:35], v[224:227], v[244:247], v[32:35]
v_mfma_f32_16x16x32_bf16 v[36:39], v[228:231], v[244:247], v[36:39]
ds_read_b128 v[240:243], v20 offset:26624
s_waitcnt lgkmcnt(4)
v_mfma_f32_16x16x32_bf16 v[40:43], v[224:227], v[248:251], v[40:43]
v_mfma_f32_16x16x32_bf16 v[44:47], v[228:231], v[248:251], v[44:47]
ds_read_b128 v[244:247], v20 offset:27648
s_waitcnt lgkmcnt(4)
v_mfma_f32_16x16x32_bf16 v[48:51], v[224:227], v[252:255], v[48:51]
v_mfma_f32_16x16x32_bf16 v[52:55], v[228:231], v[252:255], v[52:55]
ds_read_b128 v[248:251], v11 offset:36864
s_waitcnt lgkmcnt(4)
v_mfma_f32_16x16x32_bf16 v[56:59], v[224:227], v[232:235], v[56:59]
v_mfma_f32_16x16x32_bf16 v[60:63], v[228:231], v[232:235], v[60:63]
ds_read_b128 v[252:255], v11 offset:37888
s_waitcnt lgkmcnt(4)
v_mfma_f32_16x16x32_bf16 v[64:67], v[224:227], v[236:239], v[64:67]
v_mfma_f32_16x16x32_bf16 v[68:71], v[228:231], v[236:239], v[68:71]
ds_read_b128 v[232:235], v11 offset:45056
s_waitcnt lgkmcnt(4)
v_mfma_f32_16x16x32_bf16 v[72:75], v[224:227], v[240:243], v[72:75]
v_mfma_f32_16x16x32_bf16 v[76:79], v[228:231], v[240:243], v[76:79]
ds_read_b128 v[236:239], v11 offset:46080
s_waitcnt lgkmcnt(4)
v_mfma_f32_16x16x32_bf16 v[80:83], v[224:227], v[244:247], v[80:83]
v_mfma_f32_16x16x32_bf16 v[84:87], v[228:231], v[244:247], v[84:87]
ds_read_b64_tr_b16 v[216:217], v13 offset:49152
ds_read_b64_tr_b16 v[218:219], v13 offset:53248
ds_read_b64_tr_b16 v[220:221], v16 offset:49152
ds_read_b64_tr_b16 v[222:223], v16 offset:53248
ds_read_b64_tr_b16 v[224:225], v14 offset:8192
ds_read_b64_tr_b16 v[226:227], v14 offset:12288
ds_read_b64_tr_b16 v[228:229], v17 offset:8192
ds_read_b64_tr_b16 v[230:231], v17 offset:12288
ds_read_b128 v[240:243], v20 offset:20480
s_waitcnt lgkmcnt(12)
v_mfma_f32_16x16x32_bf16 v[24:27], v[88:91], v[248:251], v[24:27]
v_mfma_f32_16x16x32_bf16 v[28:31], v[92:95], v[248:251], v[28:31]
ds_read_b128 v[244:247], v20 offset:21504
s_waitcnt lgkmcnt(12)
v_mfma_f32_16x16x32_bf16 v[32:35], v[88:91], v[252:255], v[32:35]
v_mfma_f32_16x16x32_bf16 v[36:39], v[92:95], v[252:255], v[36:39]
ds_read_b128 v[248:251], v20 offset:28672
s_waitcnt lgkmcnt(12)
v_mfma_f32_16x16x32_bf16 v[40:43], v[88:91], v[232:235], v[40:43]
v_mfma_f32_16x16x32_bf16 v[44:47], v[92:95], v[232:235], v[44:47]
ds_read_b128 v[252:255], v20 offset:29696
s_waitcnt lgkmcnt(12)
v_mfma_f32_16x16x32_bf16 v[48:51], v[88:91], v[236:239], v[48:51]
v_mfma_f32_16x16x32_bf16 v[52:55], v[92:95], v[236:239], v[52:55]
ds_read_b128 v[232:235], v11 offset:38912
s_waitcnt lgkmcnt(4)
v_mfma_f32_16x16x32_bf16 v[56:59], v[88:91], v[240:243], v[56:59]
v_mfma_f32_16x16x32_bf16 v[60:63], v[92:95], v[240:243], v[60:63]
ds_read_b128 v[236:239], v11 offset:39936
s_waitcnt lgkmcnt(4)
v_mfma_f32_16x16x32_bf16 v[64:67], v[88:91], v[244:247], v[64:67]
v_mfma_f32_16x16x32_bf16 v[68:71], v[92:95], v[244:247], v[68:71]
ds_read_b128 v[240:243], v11 offset:47104
s_waitcnt lgkmcnt(4)
v_mfma_f32_16x16x32_bf16 v[72:75], v[88:91], v[248:251], v[72:75]
v_mfma_f32_16x16x32_bf16 v[76:79], v[92:95], v[248:251], v[76:79]
ds_read_b128 v[244:247], v11 offset:48128
s_waitcnt lgkmcnt(4)
v_mfma_f32_16x16x32_bf16 v[80:83], v[88:91], v[252:255], v[80:83]
v_mfma_f32_16x16x32_bf16 v[84:87], v[92:95], v[252:255], v[84:87]
ds_read_b128 v[248:251], v20 offset:22528
s_waitcnt lgkmcnt(4)
v_mfma_f32_16x16x32_bf16 v[24:27], v[96:99], v[232:235], v[24:27]
v_mfma_f32_16x16x32_bf16 v[28:31], v[100:103], v[232:235], v[28:31]
ds_read_b128 v[252:255], v20 offset:23552
s_waitcnt lgkmcnt(4)
v_mfma_f32_16x16x32_bf16 v[32:35], v[96:99], v[236:239], v[32:35]
v_mfma_f32_16x16x32_bf16 v[36:39], v[100:103], v[236:239], v[36:39]
ds_read_b128 v[232:235], v20 offset:30720
s_waitcnt lgkmcnt(4)
v_mfma_f32_16x16x32_bf16 v[40:43], v[96:99], v[240:243], v[40:43]
v_mfma_f32_16x16x32_bf16 v[44:47], v[100:103], v[240:243], v[44:47]
ds_read_b128 v[236:239], v20 offset:31744
s_waitcnt lgkmcnt(4)
v_mfma_f32_16x16x32_bf16 v[48:51], v[96:99], v[244:247], v[48:51]
v_mfma_f32_16x16x32_bf16 v[52:55], v[100:103], v[244:247], v[52:55]
s_waitcnt vmcnt(0) lgkmcnt(0)
s_barrier
ds_read_b128 v[240:243], v11 offset:16384
v_mfma_f32_16x16x32_bf16 v[56:59], v[96:99], v[248:251], v[56:59]
v_mfma_f32_16x16x32_bf16 v[60:63], v[100:103], v[248:251], v[60:63]
ds_read_b128 v[244:247], v11 offset:17408
v_mfma_f32_16x16x32_bf16 v[64:67], v[96:99], v[252:255], v[64:67]
v_mfma_f32_16x16x32_bf16 v[68:71], v[100:103], v[252:255], v[68:71]
ds_read_b128 v[248:251], v11 offset:24576
v_mfma_f32_16x16x32_bf16 v[72:75], v[96:99], v[232:235], v[72:75]
v_mfma_f32_16x16x32_bf16 v[76:79], v[100:103], v[232:235], v[76:79]
ds_read_b128 v[252:255], v11 offset:25600
v_mfma_f32_16x16x32_bf16 v[80:83], v[96:99], v[236:239], v[80:83]
v_mfma_f32_16x16x32_bf16 v[84:87], v[100:103], v[236:239], v[84:87]
ds_read_b64_tr_b16 v[88:89], v15 offset:32768
ds_read_b64_tr_b16 v[90:91], v15 offset:36864
ds_read_b64_tr_b16 v[92:93], v18 offset:32768
ds_read_b64_tr_b16 v[94:95], v18 offset:36864
ds_read_b64_tr_b16 v[96:97], v15 offset:40960
ds_read_b64_tr_b16 v[98:99], v15 offset:45056
ds_read_b64_tr_b16 v[100:101], v18 offset:40960
ds_read_b64_tr_b16 v[102:103], v18 offset:45056
ds_read_b128 v[232:235], v12 offset:49152
s_waitcnt lgkmcnt(12)
v_mfma_f32_16x16x32_bf16 v[24:27], v[120:123], v[240:243], v[24:27]
v_mfma_f32_16x16x32_bf16 v[28:31], v[124:127], v[240:243], v[28:31]
ds_read_b128 v[236:239], v12 offset:50176
s_waitcnt lgkmcnt(12)
v_mfma_f32_16x16x32_bf16 v[32:35], v[120:123], v[244:247], v[32:35]
v_mfma_f32_16x16x32_bf16 v[36:39], v[124:127], v[244:247], v[36:39]
ds_read_b128 v[240:243], v12 offset:57344
s_waitcnt lgkmcnt(12)
v_mfma_f32_16x16x32_bf16 v[40:43], v[120:123], v[248:251], v[40:43]
v_mfma_f32_16x16x32_bf16 v[44:47], v[124:127], v[248:251], v[44:47]
ds_read_b128 v[244:247], v12 offset:58368
s_waitcnt lgkmcnt(12)
v_mfma_f32_16x16x32_bf16 v[48:51], v[120:123], v[252:255], v[48:51]
v_mfma_f32_16x16x32_bf16 v[52:55], v[124:127], v[252:255], v[52:55]
ds_read_b128 v[248:251], v11 offset:18432
s_waitcnt lgkmcnt(4)
v_mfma_f32_16x16x32_bf16 v[56:59], v[120:123], v[232:235], v[56:59]
v_mfma_f32_16x16x32_bf16 v[60:63], v[124:127], v[232:235], v[60:63]
ds_read_b128 v[252:255], v11 offset:19456
s_waitcnt lgkmcnt(4)
v_mfma_f32_16x16x32_bf16 v[64:67], v[120:123], v[236:239], v[64:67]
v_mfma_f32_16x16x32_bf16 v[68:71], v[124:127], v[236:239], v[68:71]
ds_read_b128 v[232:235], v11 offset:26624
s_waitcnt lgkmcnt(4)
v_mfma_f32_16x16x32_bf16 v[72:75], v[120:123], v[240:243], v[72:75]
v_mfma_f32_16x16x32_bf16 v[76:79], v[124:127], v[240:243], v[76:79]
ds_read_b128 v[236:239], v11 offset:27648
s_waitcnt lgkmcnt(4)
v_mfma_f32_16x16x32_bf16 v[80:83], v[120:123], v[244:247], v[80:83]
v_mfma_f32_16x16x32_bf16 v[84:87], v[124:127], v[244:247], v[84:87]
ds_read_b128 v[240:243], v12 offset:51200
s_waitcnt lgkmcnt(4)
v_mfma_f32_16x16x32_bf16 v[24:27], v[128:131], v[248:251], v[24:27]
v_mfma_f32_16x16x32_bf16 v[28:31], v[132:135], v[248:251], v[28:31]
ds_read_b128 v[244:247], v12 offset:52224
s_waitcnt lgkmcnt(4)
v_mfma_f32_16x16x32_bf16 v[32:35], v[128:131], v[252:255], v[32:35]
v_mfma_f32_16x16x32_bf16 v[36:39], v[132:135], v[252:255], v[36:39]
ds_read_b128 v[248:251], v12 offset:59392
s_waitcnt lgkmcnt(4)
v_mfma_f32_16x16x32_bf16 v[40:43], v[128:131], v[232:235], v[40:43]
v_mfma_f32_16x16x32_bf16 v[44:47], v[132:135], v[232:235], v[44:47]
ds_read_b128 v[252:255], v12 offset:60416
s_waitcnt lgkmcnt(4)
v_mfma_f32_16x16x32_bf16 v[48:51], v[128:131], v[236:239], v[48:51]
v_mfma_f32_16x16x32_bf16 v[52:55], v[132:135], v[236:239], v[52:55]
ds_read_b128 v[232:235], v11 offset:20480
s_waitcnt lgkmcnt(4)
v_mfma_f32_16x16x32_bf16 v[56:59], v[128:131], v[240:243], v[56:59]
v_mfma_f32_16x16x32_bf16 v[60:63], v[132:135], v[240:243], v[60:63]
ds_read_b128 v[236:239], v11 offset:21504
s_waitcnt lgkmcnt(4)
v_mfma_f32_16x16x32_bf16 v[64:67], v[128:131], v[244:247], v[64:67]
v_mfma_f32_16x16x32_bf16 v[68:71], v[132:135], v[244:247], v[68:71]
ds_read_b128 v[240:243], v11 offset:28672
s_waitcnt lgkmcnt(4)
v_mfma_f32_16x16x32_bf16 v[72:75], v[128:131], v[248:251], v[72:75]
v_mfma_f32_16x16x32_bf16 v[76:79], v[132:135], v[248:251], v[76:79]
ds_read_b128 v[244:247], v11 offset:29696
s_waitcnt lgkmcnt(4)
v_mfma_f32_16x16x32_bf16 v[80:83], v[128:131], v[252:255], v[80:83]
v_mfma_f32_16x16x32_bf16 v[84:87], v[132:135], v[252:255], v[84:87]
ds_read_b64_tr_b16 v[120:121], v13 offset:32768
ds_read_b64_tr_b16 v[122:123], v13 offset:36864
ds_read_b64_tr_b16 v[124:125], v16 offset:32768
ds_read_b64_tr_b16 v[126:127], v16 offset:36864
ds_read_b64_tr_b16 v[128:129], v13 offset:40960
ds_read_b64_tr_b16 v[130:131], v13 offset:45056
ds_read_b64_tr_b16 v[132:133], v16 offset:40960
ds_read_b64_tr_b16 v[134:135], v16 offset:45056
ds_read_b128 v[248:251], v12 offset:53248
s_waitcnt lgkmcnt(12)
v_mfma_f32_16x16x32_bf16 v[24:27], v[136:139], v[232:235], v[24:27]
v_mfma_f32_16x16x32_bf16 v[28:31], v[140:143], v[232:235], v[28:31]
ds_read_b128 v[252:255], v12 offset:54272
s_waitcnt lgkmcnt(12)
v_mfma_f32_16x16x32_bf16 v[32:35], v[136:139], v[236:239], v[32:35]
v_mfma_f32_16x16x32_bf16 v[36:39], v[140:143], v[236:239], v[36:39]
ds_read_b128 v[232:235], v12 offset:61440
s_waitcnt lgkmcnt(12)
v_mfma_f32_16x16x32_bf16 v[40:43], v[136:139], v[240:243], v[40:43]
v_mfma_f32_16x16x32_bf16 v[44:47], v[140:143], v[240:243], v[44:47]
ds_read_b128 v[236:239], v12 offset:62464
s_waitcnt lgkmcnt(12)
v_mfma_f32_16x16x32_bf16 v[48:51], v[136:139], v[244:247], v[48:51]
v_mfma_f32_16x16x32_bf16 v[52:55], v[140:143], v[244:247], v[52:55]
ds_read_b128 v[240:243], v11 offset:22528
s_waitcnt lgkmcnt(4)
v_mfma_f32_16x16x32_bf16 v[56:59], v[136:139], v[248:251], v[56:59]
v_mfma_f32_16x16x32_bf16 v[60:63], v[140:143], v[248:251], v[60:63]
ds_read_b128 v[244:247], v11 offset:23552
s_waitcnt lgkmcnt(4)
v_mfma_f32_16x16x32_bf16 v[64:67], v[136:139], v[252:255], v[64:67]
v_mfma_f32_16x16x32_bf16 v[68:71], v[140:143], v[252:255], v[68:71]
ds_read_b128 v[248:251], v11 offset:30720
s_waitcnt lgkmcnt(4)
v_mfma_f32_16x16x32_bf16 v[72:75], v[136:139], v[232:235], v[72:75]
v_mfma_f32_16x16x32_bf16 v[76:79], v[140:143], v[232:235], v[76:79]
ds_read_b128 v[252:255], v11 offset:31744
s_waitcnt lgkmcnt(4)
v_mfma_f32_16x16x32_bf16 v[80:83], v[136:139], v[236:239], v[80:83]
v_mfma_f32_16x16x32_bf16 v[84:87], v[140:143], v[236:239], v[84:87]
ds_read_b128 v[232:235], v12 offset:55296
s_waitcnt lgkmcnt(4)
v_mfma_f32_16x16x32_bf16 v[24:27], v[144:147], v[240:243], v[24:27]
v_mfma_f32_16x16x32_bf16 v[28:31], v[148:151], v[240:243], v[28:31]
ds_read_b128 v[236:239], v12 offset:56320
s_waitcnt lgkmcnt(4)
v_mfma_f32_16x16x32_bf16 v[32:35], v[144:147], v[244:247], v[32:35]
v_mfma_f32_16x16x32_bf16 v[36:39], v[148:151], v[244:247], v[36:39]
ds_read_b128 v[240:243], v12 offset:63488
s_waitcnt lgkmcnt(4)
v_mfma_f32_16x16x32_bf16 v[40:43], v[144:147], v[248:251], v[40:43]
v_mfma_f32_16x16x32_bf16 v[44:47], v[148:151], v[248:251], v[44:47]
ds_read_b128 v[244:247], v12 offset:64512
s_waitcnt lgkmcnt(4)
v_mfma_f32_16x16x32_bf16 v[48:51], v[144:147], v[252:255], v[48:51]
v_mfma_f32_16x16x32_bf16 v[52:55], v[148:151], v[252:255], v[52:55]
s_waitcnt lgkmcnt(0)
s_barrier
ds_read_b128 v[248:251], v11 offset:32768
v_mfma_f32_16x16x32_bf16 v[56:59], v[144:147], v[232:235], v[56:59]
v_mfma_f32_16x16x32_bf16 v[60:63], v[148:151], v[232:235], v[60:63]
ds_read_b128 v[252:255], v11 offset:33792
v_mfma_f32_16x16x32_bf16 v[64:67], v[144:147], v[236:239], v[64:67]
v_mfma_f32_16x16x32_bf16 v[68:71], v[148:151], v[236:239], v[68:71]
ds_read_b128 v[232:235], v11 offset:40960
v_mfma_f32_16x16x32_bf16 v[72:75], v[144:147], v[240:243], v[72:75]
v_mfma_f32_16x16x32_bf16 v[76:79], v[148:151], v[240:243], v[76:79]
ds_read_b128 v[236:239], v11 offset:41984
v_mfma_f32_16x16x32_bf16 v[80:83], v[144:147], v[244:247], v[80:83]
v_mfma_f32_16x16x32_bf16 v[84:87], v[148:151], v[244:247], v[84:87]
ds_read_b64_tr_b16 v[136:137], v13 offset:0
ds_read_b64_tr_b16 v[138:139], v13 offset:4096
ds_read_b64_tr_b16 v[140:141], v16 offset:0
ds_read_b64_tr_b16 v[142:143], v16 offset:4096
ds_read_b64_tr_b16 v[144:145], v13 offset:8192
ds_read_b64_tr_b16 v[146:147], v13 offset:12288
ds_read_b64_tr_b16 v[148:149], v16 offset:8192
ds_read_b64_tr_b16 v[150:151], v16 offset:12288
ds_read_b128 v[240:243], v20 offset:16384
s_waitcnt lgkmcnt(12)
v_mfma_f32_16x16x32_bf16 v[24:27], v[152:155], v[248:251], v[24:27]
v_mfma_f32_16x16x32_bf16 v[28:31], v[156:159], v[248:251], v[28:31]
ds_read_b128 v[244:247], v20 offset:17408
s_waitcnt lgkmcnt(12)
v_mfma_f32_16x16x32_bf16 v[32:35], v[152:155], v[252:255], v[32:35]
v_mfma_f32_16x16x32_bf16 v[36:39], v[156:159], v[252:255], v[36:39]
ds_read_b128 v[248:251], v20 offset:24576
s_waitcnt lgkmcnt(12)
v_mfma_f32_16x16x32_bf16 v[40:43], v[152:155], v[232:235], v[40:43]
v_mfma_f32_16x16x32_bf16 v[44:47], v[156:159], v[232:235], v[44:47]
ds_read_b128 v[252:255], v20 offset:25600
s_waitcnt lgkmcnt(12)
v_mfma_f32_16x16x32_bf16 v[48:51], v[152:155], v[236:239], v[48:51]
v_mfma_f32_16x16x32_bf16 v[52:55], v[156:159], v[236:239], v[52:55]
ds_read_b128 v[232:235], v11 offset:34816
s_waitcnt lgkmcnt(4)
v_mfma_f32_16x16x32_bf16 v[56:59], v[152:155], v[240:243], v[56:59]
v_mfma_f32_16x16x32_bf16 v[60:63], v[156:159], v[240:243], v[60:63]
ds_read_b128 v[236:239], v11 offset:35840
s_waitcnt lgkmcnt(4)
v_mfma_f32_16x16x32_bf16 v[64:67], v[152:155], v[244:247], v[64:67]
v_mfma_f32_16x16x32_bf16 v[68:71], v[156:159], v[244:247], v[68:71]
ds_read_b128 v[240:243], v11 offset:43008
s_waitcnt lgkmcnt(4)
v_mfma_f32_16x16x32_bf16 v[72:75], v[152:155], v[248:251], v[72:75]
v_mfma_f32_16x16x32_bf16 v[76:79], v[156:159], v[248:251], v[76:79]
ds_read_b128 v[244:247], v11 offset:44032
s_waitcnt lgkmcnt(4)
v_mfma_f32_16x16x32_bf16 v[80:83], v[152:155], v[252:255], v[80:83]
v_mfma_f32_16x16x32_bf16 v[84:87], v[156:159], v[252:255], v[84:87]
ds_read_b128 v[248:251], v20 offset:18432
s_waitcnt lgkmcnt(4)
v_mfma_f32_16x16x32_bf16 v[24:27], v[160:163], v[232:235], v[24:27]
v_mfma_f32_16x16x32_bf16 v[28:31], v[164:167], v[232:235], v[28:31]
ds_read_b128 v[252:255], v20 offset:19456
s_waitcnt lgkmcnt(4)
v_mfma_f32_16x16x32_bf16 v[32:35], v[160:163], v[236:239], v[32:35]
v_mfma_f32_16x16x32_bf16 v[36:39], v[164:167], v[236:239], v[36:39]
ds_read_b128 v[232:235], v20 offset:26624
s_waitcnt lgkmcnt(4)
v_mfma_f32_16x16x32_bf16 v[40:43], v[160:163], v[240:243], v[40:43]
v_mfma_f32_16x16x32_bf16 v[44:47], v[164:167], v[240:243], v[44:47]
ds_read_b128 v[236:239], v20 offset:27648
s_waitcnt lgkmcnt(4)
v_mfma_f32_16x16x32_bf16 v[48:51], v[160:163], v[244:247], v[48:51]
v_mfma_f32_16x16x32_bf16 v[52:55], v[164:167], v[244:247], v[52:55]
ds_read_b128 v[240:243], v11 offset:36864
s_waitcnt lgkmcnt(4)
v_mfma_f32_16x16x32_bf16 v[56:59], v[160:163], v[248:251], v[56:59]
v_mfma_f32_16x16x32_bf16 v[60:63], v[164:167], v[248:251], v[60:63]
ds_read_b128 v[244:247], v11 offset:37888
s_waitcnt lgkmcnt(4)
v_mfma_f32_16x16x32_bf16 v[64:67], v[160:163], v[252:255], v[64:67]
v_mfma_f32_16x16x32_bf16 v[68:71], v[164:167], v[252:255], v[68:71]
ds_read_b128 v[248:251], v11 offset:45056
s_waitcnt lgkmcnt(4)
v_mfma_f32_16x16x32_bf16 v[72:75], v[160:163], v[232:235], v[72:75]
v_mfma_f32_16x16x32_bf16 v[76:79], v[164:167], v[232:235], v[76:79]
ds_read_b128 v[252:255], v11 offset:46080
s_waitcnt lgkmcnt(4)
v_mfma_f32_16x16x32_bf16 v[80:83], v[160:163], v[236:239], v[80:83]
v_mfma_f32_16x16x32_bf16 v[84:87], v[164:167], v[236:239], v[84:87]
ds_read_b64_tr_b16 v[152:153], v15 offset:16384
ds_read_b64_tr_b16 v[154:155], v15 offset:20480
ds_read_b64_tr_b16 v[156:157], v18 offset:16384
ds_read_b64_tr_b16 v[158:159], v18 offset:20480
ds_read_b64_tr_b16 v[160:161], v15 offset:24576
ds_read_b64_tr_b16 v[162:163], v15 offset:28672
ds_read_b64_tr_b16 v[164:165], v18 offset:24576
ds_read_b64_tr_b16 v[166:167], v18 offset:28672
ds_read_b128 v[232:235], v20 offset:20480
s_waitcnt lgkmcnt(12)
v_mfma_f32_16x16x32_bf16 v[24:27], v[168:171], v[240:243], v[24:27]
v_mfma_f32_16x16x32_bf16 v[28:31], v[172:175], v[240:243], v[28:31]
ds_read_b128 v[236:239], v20 offset:21504
s_waitcnt lgkmcnt(12)
v_mfma_f32_16x16x32_bf16 v[32:35], v[168:171], v[244:247], v[32:35]
v_mfma_f32_16x16x32_bf16 v[36:39], v[172:175], v[244:247], v[36:39]
ds_read_b128 v[240:243], v20 offset:28672
s_waitcnt lgkmcnt(12)
v_mfma_f32_16x16x32_bf16 v[40:43], v[168:171], v[248:251], v[40:43]
v_mfma_f32_16x16x32_bf16 v[44:47], v[172:175], v[248:251], v[44:47]
ds_read_b128 v[244:247], v20 offset:29696
s_waitcnt lgkmcnt(12)
v_mfma_f32_16x16x32_bf16 v[48:51], v[168:171], v[252:255], v[48:51]
v_mfma_f32_16x16x32_bf16 v[52:55], v[172:175], v[252:255], v[52:55]
ds_read_b128 v[248:251], v11 offset:38912
s_waitcnt lgkmcnt(4)
v_mfma_f32_16x16x32_bf16 v[56:59], v[168:171], v[232:235], v[56:59]
v_mfma_f32_16x16x32_bf16 v[60:63], v[172:175], v[232:235], v[60:63]
ds_read_b128 v[252:255], v11 offset:39936
s_waitcnt lgkmcnt(4)
v_mfma_f32_16x16x32_bf16 v[64:67], v[168:171], v[236:239], v[64:67]
v_mfma_f32_16x16x32_bf16 v[68:71], v[172:175], v[236:239], v[68:71]
ds_read_b128 v[232:235], v11 offset:47104
s_waitcnt lgkmcnt(4)
v_mfma_f32_16x16x32_bf16 v[72:75], v[168:171], v[240:243], v[72:75]
v_mfma_f32_16x16x32_bf16 v[76:79], v[172:175], v[240:243], v[76:79]
ds_read_b128 v[236:239], v11 offset:48128
s_waitcnt lgkmcnt(4)
v_mfma_f32_16x16x32_bf16 v[80:83], v[168:171], v[244:247], v[80:83]
v_mfma_f32_16x16x32_bf16 v[84:87], v[172:175], v[244:247], v[84:87]
ds_read_b128 v[240:243], v20 offset:22528
s_waitcnt lgkmcnt(4)
v_mfma_f32_16x16x32_bf16 v[24:27], v[176:179], v[248:251], v[24:27]
v_mfma_f32_16x16x32_bf16 v[28:31], v[180:183], v[248:251], v[28:31]
ds_read_b128 v[244:247], v20 offset:23552
s_waitcnt lgkmcnt(4)
v_mfma_f32_16x16x32_bf16 v[32:35], v[176:179], v[252:255], v[32:35]
v_mfma_f32_16x16x32_bf16 v[36:39], v[180:183], v[252:255], v[36:39]
ds_read_b128 v[248:251], v20 offset:30720
s_waitcnt lgkmcnt(4)
v_mfma_f32_16x16x32_bf16 v[40:43], v[176:179], v[232:235], v[40:43]
v_mfma_f32_16x16x32_bf16 v[44:47], v[180:183], v[232:235], v[44:47]
ds_read_b128 v[252:255], v20 offset:31744
s_waitcnt lgkmcnt(4)
v_mfma_f32_16x16x32_bf16 v[48:51], v[176:179], v[236:239], v[48:51]
v_mfma_f32_16x16x32_bf16 v[52:55], v[180:183], v[236:239], v[52:55]
ds_read_b128 v[232:235], v11 offset:8192
s_waitcnt lgkmcnt(4)
v_mfma_f32_16x16x32_bf16 v[56:59], v[176:179], v[240:243], v[56:59]
v_mfma_f32_16x16x32_bf16 v[60:63], v[180:183], v[240:243], v[60:63]
ds_read_b128 v[236:239], v11 offset:9216
s_waitcnt lgkmcnt(4)
v_mfma_f32_16x16x32_bf16 v[64:67], v[176:179], v[244:247], v[64:67]
v_mfma_f32_16x16x32_bf16 v[68:71], v[180:183], v[244:247], v[68:71]
ds_read_b128 v[240:243], v11 offset:49152
s_waitcnt lgkmcnt(4)
v_mfma_f32_16x16x32_bf16 v[72:75], v[176:179], v[248:251], v[72:75]
v_mfma_f32_16x16x32_bf16 v[76:79], v[180:183], v[248:251], v[76:79]
ds_read_b128 v[244:247], v11 offset:50176
s_waitcnt lgkmcnt(4)
v_mfma_f32_16x16x32_bf16 v[80:83], v[176:179], v[252:255], v[80:83]
v_mfma_f32_16x16x32_bf16 v[84:87], v[180:183], v[252:255], v[84:87]
ds_read_b128 v[248:251], v12 offset:8192
s_waitcnt lgkmcnt(4)
v_mfma_f32_16x16x32_bf16 v[40:43], v[184:187], v[232:235], v[40:43]
v_mfma_f32_16x16x32_bf16 v[44:47], v[188:191], v[232:235], v[44:47]
ds_read_b128 v[252:255], v12 offset:9216
s_waitcnt lgkmcnt(4)
v_mfma_f32_16x16x32_bf16 v[48:51], v[184:187], v[236:239], v[48:51]
v_mfma_f32_16x16x32_bf16 v[52:55], v[188:191], v[236:239], v[52:55]
ds_read_b128 v[232:235], v11 offset:10240
s_waitcnt lgkmcnt(4)
v_mfma_f32_16x16x32_bf16 v[56:59], v[184:187], v[240:243], v[56:59]
v_mfma_f32_16x16x32_bf16 v[60:63], v[188:191], v[240:243], v[60:63]
ds_read_b128 v[236:239], v11 offset:11264
s_waitcnt lgkmcnt(4)
v_mfma_f32_16x16x32_bf16 v[64:67], v[184:187], v[244:247], v[64:67]
v_mfma_f32_16x16x32_bf16 v[68:71], v[188:191], v[244:247], v[68:71]
ds_read_b128 v[240:243], v11 offset:51200
s_waitcnt lgkmcnt(4)
v_mfma_f32_16x16x32_bf16 v[72:75], v[184:187], v[248:251], v[72:75]
v_mfma_f32_16x16x32_bf16 v[76:79], v[188:191], v[248:251], v[76:79]
ds_read_b128 v[244:247], v11 offset:52224
s_waitcnt lgkmcnt(4)
v_mfma_f32_16x16x32_bf16 v[80:83], v[184:187], v[252:255], v[80:83]
v_mfma_f32_16x16x32_bf16 v[84:87], v[188:191], v[252:255], v[84:87]
ds_read_b128 v[248:251], v12 offset:10240
s_waitcnt lgkmcnt(4)
v_mfma_f32_16x16x32_bf16 v[40:43], v[192:195], v[232:235], v[40:43]
v_mfma_f32_16x16x32_bf16 v[44:47], v[196:199], v[232:235], v[44:47]
ds_read_b128 v[252:255], v12 offset:11264
s_waitcnt lgkmcnt(4)
v_mfma_f32_16x16x32_bf16 v[48:51], v[192:195], v[236:239], v[48:51]
v_mfma_f32_16x16x32_bf16 v[52:55], v[196:199], v[236:239], v[52:55]
ds_read_b128 v[232:235], v11 offset:12288
s_waitcnt lgkmcnt(4)
v_mfma_f32_16x16x32_bf16 v[56:59], v[192:195], v[240:243], v[56:59]
v_mfma_f32_16x16x32_bf16 v[60:63], v[196:199], v[240:243], v[60:63]
ds_read_b128 v[236:239], v11 offset:13312
s_waitcnt lgkmcnt(4)
v_mfma_f32_16x16x32_bf16 v[64:67], v[192:195], v[244:247], v[64:67]
v_mfma_f32_16x16x32_bf16 v[68:71], v[196:199], v[244:247], v[68:71]
ds_read_b128 v[240:243], v11 offset:53248
s_waitcnt lgkmcnt(4)
v_mfma_f32_16x16x32_bf16 v[72:75], v[192:195], v[248:251], v[72:75]
v_mfma_f32_16x16x32_bf16 v[76:79], v[196:199], v[248:251], v[76:79]
ds_read_b128 v[244:247], v11 offset:54272
s_waitcnt lgkmcnt(4)
v_mfma_f32_16x16x32_bf16 v[80:83], v[192:195], v[252:255], v[80:83]
v_mfma_f32_16x16x32_bf16 v[84:87], v[196:199], v[252:255], v[84:87]
ds_read_b128 v[248:251], v12 offset:12288
s_waitcnt lgkmcnt(4)
v_mfma_f32_16x16x32_bf16 v[40:43], v[200:203], v[232:235], v[40:43]
v_mfma_f32_16x16x32_bf16 v[44:47], v[204:207], v[232:235], v[44:47]
ds_read_b128 v[252:255], v12 offset:13312
s_waitcnt lgkmcnt(4)
v_mfma_f32_16x16x32_bf16 v[48:51], v[200:203], v[236:239], v[48:51]
v_mfma_f32_16x16x32_bf16 v[52:55], v[204:207], v[236:239], v[52:55]
ds_read_b128 v[232:235], v11 offset:14336
s_waitcnt lgkmcnt(4)
v_mfma_f32_16x16x32_bf16 v[56:59], v[200:203], v[240:243], v[56:59]
v_mfma_f32_16x16x32_bf16 v[60:63], v[204:207], v[240:243], v[60:63]
ds_read_b128 v[236:239], v11 offset:15360
s_waitcnt lgkmcnt(4)
v_mfma_f32_16x16x32_bf16 v[64:67], v[200:203], v[244:247], v[64:67]
v_mfma_f32_16x16x32_bf16 v[68:71], v[204:207], v[244:247], v[68:71]
ds_read_b128 v[240:243], v11 offset:55296
s_waitcnt lgkmcnt(4)
v_mfma_f32_16x16x32_bf16 v[72:75], v[200:203], v[248:251], v[72:75]
v_mfma_f32_16x16x32_bf16 v[76:79], v[204:207], v[248:251], v[76:79]
ds_read_b128 v[244:247], v11 offset:56320
s_waitcnt lgkmcnt(4)
v_mfma_f32_16x16x32_bf16 v[80:83], v[200:203], v[252:255], v[80:83]
v_mfma_f32_16x16x32_bf16 v[84:87], v[204:207], v[252:255], v[84:87]
ds_read_b128 v[248:251], v12 offset:14336
s_waitcnt lgkmcnt(4)
v_mfma_f32_16x16x32_bf16 v[40:43], v[208:211], v[232:235], v[40:43]
v_mfma_f32_16x16x32_bf16 v[44:47], v[212:215], v[232:235], v[44:47]
ds_read_b128 v[252:255], v12 offset:15360
s_waitcnt lgkmcnt(4)
v_mfma_f32_16x16x32_bf16 v[48:51], v[208:211], v[236:239], v[48:51]
v_mfma_f32_16x16x32_bf16 v[52:55], v[212:215], v[236:239], v[52:55]
s_waitcnt lgkmcnt(0)
s_barrier
ds_read_b128 v[232:235], v11 offset:24576
v_mfma_f32_16x16x32_bf16 v[56:59], v[208:211], v[240:243], v[56:59]
v_mfma_f32_16x16x32_bf16 v[60:63], v[212:215], v[240:243], v[60:63]
ds_read_b128 v[236:239], v11 offset:25600
v_mfma_f32_16x16x32_bf16 v[64:67], v[208:211], v[244:247], v[64:67]
v_mfma_f32_16x16x32_bf16 v[68:71], v[212:215], v[244:247], v[68:71]
ds_read_b128 v[240:243], v12 offset:49152
v_mfma_f32_16x16x32_bf16 v[72:75], v[208:211], v[248:251], v[72:75]
v_mfma_f32_16x16x32_bf16 v[76:79], v[212:215], v[248:251], v[76:79]
ds_read_b128 v[244:247], v12 offset:50176
v_mfma_f32_16x16x32_bf16 v[80:83], v[208:211], v[252:255], v[80:83]
v_mfma_f32_16x16x32_bf16 v[84:87], v[212:215], v[252:255], v[84:87]
ds_read_b128 v[248:251], v12 offset:57344
s_waitcnt lgkmcnt(4)
v_mfma_f32_16x16x32_bf16 v[40:43], v[104:107], v[232:235], v[40:43]
v_mfma_f32_16x16x32_bf16 v[44:47], v[108:111], v[232:235], v[44:47]
ds_read_b128 v[252:255], v12 offset:58368
s_waitcnt lgkmcnt(4)
v_mfma_f32_16x16x32_bf16 v[48:51], v[104:107], v[236:239], v[48:51]
v_mfma_f32_16x16x32_bf16 v[52:55], v[108:111], v[236:239], v[52:55]
ds_read_b128 v[232:235], v11 offset:26624
s_waitcnt lgkmcnt(4)
v_mfma_f32_16x16x32_bf16 v[56:59], v[104:107], v[240:243], v[56:59]
v_mfma_f32_16x16x32_bf16 v[60:63], v[108:111], v[240:243], v[60:63]
ds_read_b128 v[236:239], v11 offset:27648
s_waitcnt lgkmcnt(4)
v_mfma_f32_16x16x32_bf16 v[64:67], v[104:107], v[244:247], v[64:67]
v_mfma_f32_16x16x32_bf16 v[68:71], v[108:111], v[244:247], v[68:71]
ds_read_b128 v[240:243], v12 offset:51200
s_waitcnt lgkmcnt(4)
v_mfma_f32_16x16x32_bf16 v[72:75], v[104:107], v[248:251], v[72:75]
v_mfma_f32_16x16x32_bf16 v[76:79], v[108:111], v[248:251], v[76:79]
ds_read_b128 v[244:247], v12 offset:52224
s_waitcnt lgkmcnt(4)
v_mfma_f32_16x16x32_bf16 v[80:83], v[104:107], v[252:255], v[80:83]
v_mfma_f32_16x16x32_bf16 v[84:87], v[108:111], v[252:255], v[84:87]
ds_read_b128 v[248:251], v12 offset:59392
s_waitcnt lgkmcnt(4)
v_mfma_f32_16x16x32_bf16 v[40:43], v[112:115], v[232:235], v[40:43]
v_mfma_f32_16x16x32_bf16 v[44:47], v[116:119], v[232:235], v[44:47]
ds_read_b128 v[252:255], v12 offset:60416
s_waitcnt lgkmcnt(4)
v_mfma_f32_16x16x32_bf16 v[48:51], v[112:115], v[236:239], v[48:51]
v_mfma_f32_16x16x32_bf16 v[52:55], v[116:119], v[236:239], v[52:55]
ds_read_b128 v[232:235], v11 offset:28672
s_waitcnt lgkmcnt(4)
v_mfma_f32_16x16x32_bf16 v[56:59], v[112:115], v[240:243], v[56:59]
v_mfma_f32_16x16x32_bf16 v[60:63], v[116:119], v[240:243], v[60:63]
ds_read_b128 v[236:239], v11 offset:29696
s_waitcnt lgkmcnt(4)
v_mfma_f32_16x16x32_bf16 v[64:67], v[112:115], v[244:247], v[64:67]
v_mfma_f32_16x16x32_bf16 v[68:71], v[116:119], v[244:247], v[68:71]
ds_read_b128 v[240:243], v12 offset:53248
s_waitcnt lgkmcnt(4)
v_mfma_f32_16x16x32_bf16 v[72:75], v[112:115], v[248:251], v[72:75]
v_mfma_f32_16x16x32_bf16 v[76:79], v[116:119], v[248:251], v[76:79]
ds_read_b128 v[244:247], v12 offset:54272
s_waitcnt lgkmcnt(4)
v_mfma_f32_16x16x32_bf16 v[80:83], v[112:115], v[252:255], v[80:83]
v_mfma_f32_16x16x32_bf16 v[84:87], v[116:119], v[252:255], v[84:87]
ds_read_b128 v[248:251], v12 offset:61440
s_waitcnt lgkmcnt(4)
v_mfma_f32_16x16x32_bf16 v[40:43], v[216:219], v[232:235], v[40:43]
v_mfma_f32_16x16x32_bf16 v[44:47], v[220:223], v[232:235], v[44:47]
ds_read_b128 v[252:255], v12 offset:62464
s_waitcnt lgkmcnt(4)
v_mfma_f32_16x16x32_bf16 v[48:51], v[216:219], v[236:239], v[48:51]
v_mfma_f32_16x16x32_bf16 v[52:55], v[220:223], v[236:239], v[52:55]
ds_read_b128 v[232:235], v11 offset:30720
s_waitcnt lgkmcnt(4)
v_mfma_f32_16x16x32_bf16 v[56:59], v[216:219], v[240:243], v[56:59]
v_mfma_f32_16x16x32_bf16 v[60:63], v[220:223], v[240:243], v[60:63]
ds_read_b128 v[236:239], v11 offset:31744
s_waitcnt lgkmcnt(4)
v_mfma_f32_16x16x32_bf16 v[64:67], v[216:219], v[244:247], v[64:67]
v_mfma_f32_16x16x32_bf16 v[68:71], v[220:223], v[244:247], v[68:71]
ds_read_b128 v[240:243], v12 offset:55296
s_waitcnt lgkmcnt(4)
v_mfma_f32_16x16x32_bf16 v[72:75], v[216:219], v[248:251], v[72:75]
v_mfma_f32_16x16x32_bf16 v[76:79], v[220:223], v[248:251], v[76:79]
ds_read_b128 v[244:247], v12 offset:56320
s_waitcnt lgkmcnt(4)
v_mfma_f32_16x16x32_bf16 v[80:83], v[216:219], v[252:255], v[80:83]
v_mfma_f32_16x16x32_bf16 v[84:87], v[220:223], v[252:255], v[84:87]
ds_read_b128 v[248:251], v12 offset:63488
s_waitcnt lgkmcnt(4)
v_mfma_f32_16x16x32_bf16 v[40:43], v[224:227], v[232:235], v[40:43]
v_mfma_f32_16x16x32_bf16 v[44:47], v[228:231], v[232:235], v[44:47]
ds_read_b128 v[252:255], v12 offset:64512
s_waitcnt lgkmcnt(4)
v_mfma_f32_16x16x32_bf16 v[48:51], v[224:227], v[236:239], v[48:51]
v_mfma_f32_16x16x32_bf16 v[52:55], v[228:231], v[236:239], v[52:55]
s_waitcnt lgkmcnt(0)
s_barrier
ds_read_b128 v[232:235], v20 offset:40960
v_mfma_f32_16x16x32_bf16 v[56:59], v[224:227], v[240:243], v[56:59]
v_mfma_f32_16x16x32_bf16 v[60:63], v[228:231], v[240:243], v[60:63]
ds_read_b128 v[236:239], v20 offset:41984
v_mfma_f32_16x16x32_bf16 v[64:67], v[224:227], v[244:247], v[64:67]
v_mfma_f32_16x16x32_bf16 v[68:71], v[228:231], v[244:247], v[68:71]
ds_read_b128 v[240:243], v20 offset:43008
v_mfma_f32_16x16x32_bf16 v[72:75], v[224:227], v[248:251], v[72:75]
v_mfma_f32_16x16x32_bf16 v[76:79], v[228:231], v[248:251], v[76:79]
ds_read_b128 v[244:247], v20 offset:44032
v_mfma_f32_16x16x32_bf16 v[80:83], v[224:227], v[252:255], v[80:83]
v_mfma_f32_16x16x32_bf16 v[84:87], v[228:231], v[252:255], v[84:87]
ds_read_b128 v[248:251], v20 offset:45056
s_waitcnt lgkmcnt(4)
v_mfma_f32_16x16x32_bf16 v[40:43], v[88:91], v[232:235], v[40:43]
v_mfma_f32_16x16x32_bf16 v[44:47], v[92:95], v[232:235], v[44:47]
ds_read_b128 v[252:255], v20 offset:46080
s_waitcnt lgkmcnt(4)
v_mfma_f32_16x16x32_bf16 v[48:51], v[88:91], v[236:239], v[48:51]
v_mfma_f32_16x16x32_bf16 v[52:55], v[92:95], v[236:239], v[52:55]
ds_read_b128 v[232:235], v20 offset:47104
s_waitcnt lgkmcnt(4)
v_mfma_f32_16x16x32_bf16 v[40:43], v[96:99], v[240:243], v[40:43]
v_mfma_f32_16x16x32_bf16 v[44:47], v[100:103], v[240:243], v[44:47]
ds_read_b128 v[236:239], v20 offset:48128
s_waitcnt lgkmcnt(4)
v_mfma_f32_16x16x32_bf16 v[48:51], v[96:99], v[244:247], v[48:51]
v_mfma_f32_16x16x32_bf16 v[52:55], v[100:103], v[244:247], v[52:55]
ds_read_b128 v[240:243], v11 offset:40960
s_waitcnt lgkmcnt(4)
v_mfma_f32_16x16x32_bf16 v[40:43], v[120:123], v[248:251], v[40:43]
v_mfma_f32_16x16x32_bf16 v[44:47], v[124:127], v[248:251], v[44:47]
ds_read_b128 v[244:247], v11 offset:41984
s_waitcnt lgkmcnt(4)
v_mfma_f32_16x16x32_bf16 v[48:51], v[120:123], v[252:255], v[48:51]
v_mfma_f32_16x16x32_bf16 v[52:55], v[124:127], v[252:255], v[52:55]
ds_read_b128 v[248:251], v11 offset:43008
s_waitcnt lgkmcnt(4)
v_mfma_f32_16x16x32_bf16 v[40:43], v[128:131], v[232:235], v[40:43]
v_mfma_f32_16x16x32_bf16 v[44:47], v[132:135], v[232:235], v[44:47]
ds_read_b128 v[252:255], v11 offset:44032
s_waitcnt lgkmcnt(4)
v_mfma_f32_16x16x32_bf16 v[48:51], v[128:131], v[236:239], v[48:51]
v_mfma_f32_16x16x32_bf16 v[52:55], v[132:135], v[236:239], v[52:55]
ds_read_b128 v[232:235], v11 offset:45056
s_waitcnt lgkmcnt(4)
v_mfma_f32_16x16x32_bf16 v[40:43], v[136:139], v[240:243], v[40:43]
v_mfma_f32_16x16x32_bf16 v[44:47], v[140:143], v[240:243], v[44:47]
ds_read_b128 v[236:239], v11 offset:46080
s_waitcnt lgkmcnt(4)
v_mfma_f32_16x16x32_bf16 v[48:51], v[136:139], v[244:247], v[48:51]
v_mfma_f32_16x16x32_bf16 v[52:55], v[140:143], v[244:247], v[52:55]
ds_read_b128 v[240:243], v11 offset:47104
s_waitcnt lgkmcnt(4)
v_mfma_f32_16x16x32_bf16 v[40:43], v[144:147], v[248:251], v[40:43]
v_mfma_f32_16x16x32_bf16 v[44:47], v[148:151], v[248:251], v[44:47]
ds_read_b128 v[244:247], v11 offset:48128
s_waitcnt lgkmcnt(4)
v_mfma_f32_16x16x32_bf16 v[48:51], v[144:147], v[252:255], v[48:51]
v_mfma_f32_16x16x32_bf16 v[52:55], v[148:151], v[252:255], v[52:55]
ds_read_b128 v[248:251], v12 offset:32768
s_waitcnt lgkmcnt(4)
v_mfma_f32_16x16x32_bf16 v[40:43], v[152:155], v[232:235], v[40:43]
v_mfma_f32_16x16x32_bf16 v[44:47], v[156:159], v[232:235], v[44:47]
ds_read_b128 v[252:255], v12 offset:33792
s_waitcnt lgkmcnt(4)
v_mfma_f32_16x16x32_bf16 v[48:51], v[152:155], v[236:239], v[48:51]
v_mfma_f32_16x16x32_bf16 v[52:55], v[156:159], v[236:239], v[52:55]
ds_read_b128 v[232:235], v12 offset:34816
s_waitcnt lgkmcnt(4)
v_mfma_f32_16x16x32_bf16 v[40:43], v[160:163], v[240:243], v[40:43]
v_mfma_f32_16x16x32_bf16 v[44:47], v[164:167], v[240:243], v[44:47]
ds_read_b128 v[236:239], v12 offset:35840
s_waitcnt lgkmcnt(4)
v_mfma_f32_16x16x32_bf16 v[48:51], v[160:163], v[244:247], v[48:51]
v_mfma_f32_16x16x32_bf16 v[52:55], v[164:167], v[244:247], v[52:55]
ds_read_b128 v[240:243], v12 offset:36864
s_waitcnt lgkmcnt(4)
v_mfma_f32_16x16x32_bf16 v[56:59], v[88:91], v[248:251], v[56:59]
v_mfma_f32_16x16x32_bf16 v[60:63], v[92:95], v[248:251], v[60:63]
ds_read_b128 v[244:247], v12 offset:37888
s_waitcnt lgkmcnt(4)
v_mfma_f32_16x16x32_bf16 v[64:67], v[88:91], v[252:255], v[64:67]
v_mfma_f32_16x16x32_bf16 v[68:71], v[92:95], v[252:255], v[68:71]
ds_read_b128 v[248:251], v12 offset:38912
s_waitcnt lgkmcnt(4)
v_mfma_f32_16x16x32_bf16 v[56:59], v[96:99], v[232:235], v[56:59]
v_mfma_f32_16x16x32_bf16 v[60:63], v[100:103], v[232:235], v[60:63]
v_cvt_pk_bf16_f32 v168, v40, v41
v_cvt_pk_bf16_f32 v169, v42, v43
v_cvt_pk_bf16_f32 v170, v44, v45
v_cvt_pk_bf16_f32 v171, v46, v47
v_cvt_pk_bf16_f32 v172, v48, v49
v_cvt_pk_bf16_f32 v173, v50, v51
v_cvt_pk_bf16_f32 v174, v52, v53
v_cvt_pk_bf16_f32 v175, v54, v55
buffer_store_dwordx4 v[168:171], v20, s[24:27], s87 offen offset:0 sc1
buffer_store_dwordx4 v[172:175], v20, s[24:27], s87 offen offset:1024 sc1
ds_read_b128 v[252:255], v12 offset:39936
s_waitcnt lgkmcnt(4)
v_mfma_f32_16x16x32_bf16 v[64:67], v[96:99], v[236:239], v[64:67]
v_mfma_f32_16x16x32_bf16 v[68:71], v[100:103], v[236:239], v[68:71]
ds_read_b128 v[232:235], v20 offset:16384
s_waitcnt lgkmcnt(4)
v_mfma_f32_16x16x32_bf16 v[56:59], v[120:123], v[240:243], v[56:59]
v_mfma_f32_16x16x32_bf16 v[60:63], v[124:127], v[240:243], v[60:63]
ds_read_b128 v[236:239], v20 offset:17408
s_waitcnt lgkmcnt(4)
v_mfma_f32_16x16x32_bf16 v[64:67], v[120:123], v[244:247], v[64:67]
v_mfma_f32_16x16x32_bf16 v[68:71], v[124:127], v[244:247], v[68:71]
ds_read_b128 v[240:243], v20 offset:18432
s_waitcnt lgkmcnt(4)
v_mfma_f32_16x16x32_bf16 v[56:59], v[128:131], v[248:251], v[56:59]
v_mfma_f32_16x16x32_bf16 v[60:63], v[132:135], v[248:251], v[60:63]
ds_read_b128 v[244:247], v20 offset:19456
s_waitcnt lgkmcnt(4)
v_mfma_f32_16x16x32_bf16 v[64:67], v[128:131], v[252:255], v[64:67]
v_mfma_f32_16x16x32_bf16 v[68:71], v[132:135], v[252:255], v[68:71]
ds_read_b128 v[248:251], v20 offset:20480
s_waitcnt lgkmcnt(4)
v_mfma_f32_16x16x32_bf16 v[56:59], v[136:139], v[232:235], v[56:59]
v_mfma_f32_16x16x32_bf16 v[60:63], v[140:143], v[232:235], v[60:63]
ds_read_b128 v[252:255], v20 offset:21504
s_waitcnt lgkmcnt(4)
v_mfma_f32_16x16x32_bf16 v[64:67], v[136:139], v[236:239], v[64:67]
v_mfma_f32_16x16x32_bf16 v[68:71], v[140:143], v[236:239], v[68:71]
ds_read_b128 v[232:235], v20 offset:22528
s_waitcnt lgkmcnt(4)
v_mfma_f32_16x16x32_bf16 v[56:59], v[144:147], v[240:243], v[56:59]
v_mfma_f32_16x16x32_bf16 v[60:63], v[148:151], v[240:243], v[60:63]
ds_read_b128 v[236:239], v20 offset:23552
s_waitcnt lgkmcnt(4)
v_mfma_f32_16x16x32_bf16 v[64:67], v[144:147], v[244:247], v[64:67]
v_mfma_f32_16x16x32_bf16 v[68:71], v[148:151], v[244:247], v[68:71]
ds_read_b128 v[240:243], v12 offset:40960
s_waitcnt lgkmcnt(4)
v_mfma_f32_16x16x32_bf16 v[56:59], v[152:155], v[248:251], v[56:59]
v_mfma_f32_16x16x32_bf16 v[60:63], v[156:159], v[248:251], v[60:63]
ds_read_b128 v[244:247], v12 offset:41984
s_waitcnt lgkmcnt(4)
v_mfma_f32_16x16x32_bf16 v[64:67], v[152:155], v[252:255], v[64:67]
v_mfma_f32_16x16x32_bf16 v[68:71], v[156:159], v[252:255], v[68:71]
ds_read_b128 v[248:251], v12 offset:43008
s_waitcnt lgkmcnt(4)
v_mfma_f32_16x16x32_bf16 v[56:59], v[160:163], v[232:235], v[56:59]
v_mfma_f32_16x16x32_bf16 v[60:63], v[164:167], v[232:235], v[60:63]
ds_read_b128 v[252:255], v12 offset:44032
s_waitcnt lgkmcnt(4)
v_mfma_f32_16x16x32_bf16 v[64:67], v[160:163], v[236:239], v[64:67]
v_mfma_f32_16x16x32_bf16 v[68:71], v[164:167], v[236:239], v[68:71]
ds_read_b128 v[232:235], v12 offset:45056
s_waitcnt lgkmcnt(4)
v_mfma_f32_16x16x32_bf16 v[72:75], v[88:91], v[240:243], v[72:75]
v_mfma_f32_16x16x32_bf16 v[76:79], v[92:95], v[240:243], v[76:79]
ds_read_b128 v[236:239], v12 offset:46080
s_waitcnt lgkmcnt(4)
v_mfma_f32_16x16x32_bf16 v[80:83], v[88:91], v[244:247], v[80:83]
v_mfma_f32_16x16x32_bf16 v[84:87], v[92:95], v[244:247], v[84:87]
ds_read_b128 v[240:243], v12 offset:47104
s_waitcnt lgkmcnt(4)
v_mfma_f32_16x16x32_bf16 v[72:75], v[96:99], v[248:251], v[72:75]
v_mfma_f32_16x16x32_bf16 v[76:79], v[100:103], v[248:251], v[76:79]
v_cvt_pk_bf16_f32 v176, v56, v57
v_cvt_pk_bf16_f32 v177, v58, v59
v_cvt_pk_bf16_f32 v178, v60, v61
v_cvt_pk_bf16_f32 v179, v62, v63
v_cvt_pk_bf16_f32 v180, v64, v65
v_cvt_pk_bf16_f32 v181, v66, v67
v_cvt_pk_bf16_f32 v182, v68, v69
v_cvt_pk_bf16_f32 v183, v70, v71
buffer_store_dwordx4 v[176:179], v20, s[24:27], s88 offen offset:0 sc1
buffer_store_dwordx4 v[180:183], v20, s[24:27], s88 offen offset:1024 sc1
ds_read_b128 v[244:247], v12 offset:48128
s_waitcnt lgkmcnt(4)
v_mfma_f32_16x16x32_bf16 v[80:83], v[96:99], v[252:255], v[80:83]
v_mfma_f32_16x16x32_bf16 v[84:87], v[100:103], v[252:255], v[84:87]
ds_read_b128 v[248:251], v20 offset:24576
s_waitcnt lgkmcnt(4)
v_mfma_f32_16x16x32_bf16 v[72:75], v[120:123], v[232:235], v[72:75]
v_mfma_f32_16x16x32_bf16 v[76:79], v[124:127], v[232:235], v[76:79]
ds_read_b128 v[252:255], v20 offset:25600
s_waitcnt lgkmcnt(4)
v_mfma_f32_16x16x32_bf16 v[80:83], v[120:123], v[236:239], v[80:83]
v_mfma_f32_16x16x32_bf16 v[84:87], v[124:127], v[236:239], v[84:87]
ds_read_b128 v[232:235], v20 offset:26624
s_waitcnt lgkmcnt(4)
v_mfma_f32_16x16x32_bf16 v[72:75], v[128:131], v[240:243], v[72:75]
v_mfma_f32_16x16x32_bf16 v[76:79], v[132:135], v[240:243], v[76:79]
ds_read_b128 v[236:239], v20 offset:27648
s_waitcnt lgkmcnt(4)
v_mfma_f32_16x16x32_bf16 v[80:83], v[128:131], v[244:247], v[80:83]
v_mfma_f32_16x16x32_bf16 v[84:87], v[132:135], v[244:247], v[84:87]
ds_read_b128 v[240:243], v20 offset:28672
s_waitcnt lgkmcnt(4)
v_mfma_f32_16x16x32_bf16 v[72:75], v[136:139], v[248:251], v[72:75]
v_mfma_f32_16x16x32_bf16 v[76:79], v[140:143], v[248:251], v[76:79]
ds_read_b128 v[244:247], v20 offset:29696
s_waitcnt lgkmcnt(4)
v_mfma_f32_16x16x32_bf16 v[80:83], v[136:139], v[252:255], v[80:83]
v_mfma_f32_16x16x32_bf16 v[84:87], v[140:143], v[252:255], v[84:87]
ds_read_b128 v[248:251], v20 offset:30720
s_waitcnt lgkmcnt(4)
v_mfma_f32_16x16x32_bf16 v[72:75], v[144:147], v[232:235], v[72:75]
v_mfma_f32_16x16x32_bf16 v[76:79], v[148:151], v[232:235], v[76:79]
ds_read_b128 v[252:255], v20 offset:31744
s_waitcnt lgkmcnt(4)
v_mfma_f32_16x16x32_bf16 v[80:83], v[144:147], v[236:239], v[80:83]
v_mfma_f32_16x16x32_bf16 v[84:87], v[148:151], v[236:239], v[84:87]
ds_read_b128 v[232:235], v20 offset:32768
s_waitcnt lgkmcnt(4)
v_mfma_f32_16x16x32_bf16 v[72:75], v[152:155], v[240:243], v[72:75]
v_mfma_f32_16x16x32_bf16 v[76:79], v[156:159], v[240:243], v[76:79]
ds_read_b128 v[236:239], v20 offset:33792
s_waitcnt lgkmcnt(4)
v_mfma_f32_16x16x32_bf16 v[80:83], v[152:155], v[244:247], v[80:83]
v_mfma_f32_16x16x32_bf16 v[84:87], v[156:159], v[244:247], v[84:87]
ds_read_b128 v[240:243], v20 offset:34816
s_waitcnt lgkmcnt(4)
v_mfma_f32_16x16x32_bf16 v[72:75], v[160:163], v[248:251], v[72:75]
v_mfma_f32_16x16x32_bf16 v[76:79], v[164:167], v[248:251], v[76:79]
ds_read_b128 v[244:247], v20 offset:35840
s_waitcnt lgkmcnt(4)
v_mfma_f32_16x16x32_bf16 v[80:83], v[160:163], v[252:255], v[80:83]
v_mfma_f32_16x16x32_bf16 v[84:87], v[164:167], v[252:255], v[84:87]
ds_read_b128 v[248:251], v20 offset:36864
s_waitcnt lgkmcnt(4)
v_mfma_f32_16x16x32_bf16 v[24:27], v[88:91], v[232:235], v[24:27]
v_mfma_f32_16x16x32_bf16 v[28:31], v[92:95], v[232:235], v[28:31]
ds_read_b128 v[252:255], v20 offset:37888
s_waitcnt lgkmcnt(4)
v_mfma_f32_16x16x32_bf16 v[32:35], v[88:91], v[236:239], v[32:35]
v_mfma_f32_16x16x32_bf16 v[36:39], v[92:95], v[236:239], v[36:39]
ds_read_b128 v[232:235], v20 offset:38912
s_waitcnt lgkmcnt(4)
v_mfma_f32_16x16x32_bf16 v[24:27], v[96:99], v[240:243], v[24:27]
v_mfma_f32_16x16x32_bf16 v[28:31], v[100:103], v[240:243], v[28:31]
v_cvt_pk_bf16_f32 v168, v72, v73
v_cvt_pk_bf16_f32 v169, v74, v75
v_cvt_pk_bf16_f32 v170, v76, v77
v_cvt_pk_bf16_f32 v171, v78, v79
v_cvt_pk_bf16_f32 v172, v80, v81
v_cvt_pk_bf16_f32 v173, v82, v83
v_cvt_pk_bf16_f32 v174, v84, v85
v_cvt_pk_bf16_f32 v175, v86, v87
buffer_store_dwordx4 v[168:171], v20, s[24:27], s89 offen offset:0 sc1
buffer_store_dwordx4 v[172:175], v20, s[24:27], s89 offen offset:1024 sc1
ds_read_b128 v[236:239], v20 offset:39936
s_waitcnt lgkmcnt(4)
v_mfma_f32_16x16x32_bf16 v[32:35], v[96:99], v[244:247], v[32:35]
v_mfma_f32_16x16x32_bf16 v[36:39], v[100:103], v[244:247], v[36:39]
ds_read_b128 v[240:243], v11 offset:32768
s_waitcnt lgkmcnt(4)
v_mfma_f32_16x16x32_bf16 v[24:27], v[120:123], v[248:251], v[24:27]
v_mfma_f32_16x16x32_bf16 v[28:31], v[124:127], v[248:251], v[28:31]
ds_read_b128 v[244:247], v11 offset:33792
s_waitcnt lgkmcnt(4)
v_mfma_f32_16x16x32_bf16 v[32:35], v[120:123], v[252:255], v[32:35]
v_mfma_f32_16x16x32_bf16 v[36:39], v[124:127], v[252:255], v[36:39]
ds_read_b128 v[248:251], v11 offset:34816
s_waitcnt lgkmcnt(4)
v_mfma_f32_16x16x32_bf16 v[24:27], v[128:131], v[232:235], v[24:27]
v_mfma_f32_16x16x32_bf16 v[28:31], v[132:135], v[232:235], v[28:31]
ds_read_b128 v[252:255], v11 offset:35840
s_waitcnt lgkmcnt(4)
v_mfma_f32_16x16x32_bf16 v[32:35], v[128:131], v[236:239], v[32:35]
v_mfma_f32_16x16x32_bf16 v[36:39], v[132:135], v[236:239], v[36:39]
ds_read_b128 v[232:235], v11 offset:36864
s_waitcnt lgkmcnt(4)
v_mfma_f32_16x16x32_bf16 v[24:27], v[136:139], v[240:243], v[24:27]
v_mfma_f32_16x16x32_bf16 v[28:31], v[140:143], v[240:243], v[28:31]
ds_read_b128 v[236:239], v11 offset:37888
s_waitcnt lgkmcnt(4)
v_mfma_f32_16x16x32_bf16 v[32:35], v[136:139], v[244:247], v[32:35]
v_mfma_f32_16x16x32_bf16 v[36:39], v[140:143], v[244:247], v[36:39]
ds_read_b128 v[240:243], v11 offset:38912
s_waitcnt lgkmcnt(4)
v_mfma_f32_16x16x32_bf16 v[24:27], v[144:147], v[248:251], v[24:27]
v_mfma_f32_16x16x32_bf16 v[28:31], v[148:151], v[248:251], v[28:31]
ds_read_b128 v[244:247], v11 offset:39936
s_waitcnt lgkmcnt(4)
v_mfma_f32_16x16x32_bf16 v[32:35], v[144:147], v[252:255], v[32:35]
v_mfma_f32_16x16x32_bf16 v[36:39], v[148:151], v[252:255], v[36:39]
ds_read_b128 v[248:251], v20 offset:49152
s_waitcnt lgkmcnt(4)
v_mfma_f32_16x16x32_bf16 v[24:27], v[152:155], v[232:235], v[24:27]
v_mfma_f32_16x16x32_bf16 v[28:31], v[156:159], v[232:235], v[28:31]
ds_read_b128 v[252:255], v20 offset:50176
s_waitcnt lgkmcnt(4)
v_mfma_f32_16x16x32_bf16 v[32:35], v[152:155], v[236:239], v[32:35]
v_mfma_f32_16x16x32_bf16 v[36:39], v[156:159], v[236:239], v[36:39]
ds_read_b128 v[232:235], v20 offset:51200
s_waitcnt lgkmcnt(4)
v_mfma_f32_16x16x32_bf16 v[24:27], v[160:163], v[240:243], v[24:27]
v_mfma_f32_16x16x32_bf16 v[28:31], v[164:167], v[240:243], v[28:31]
ds_read_b128 v[236:239], v20 offset:52224
s_waitcnt lgkmcnt(4)
v_mfma_f32_16x16x32_bf16 v[32:35], v[160:163], v[244:247], v[32:35]
v_mfma_f32_16x16x32_bf16 v[36:39], v[164:167], v[244:247], v[36:39]
ds_read_b128 v[240:243], v20 offset:53248
s_waitcnt lgkmcnt(4)
v_mfma_f32_16x16x32_bf16 v[24:27], v[184:187], v[248:251], v[24:27]
v_mfma_f32_16x16x32_bf16 v[28:31], v[188:191], v[248:251], v[28:31]
ds_read_b128 v[244:247], v20 offset:54272
s_waitcnt lgkmcnt(4)
v_mfma_f32_16x16x32_bf16 v[32:35], v[184:187], v[252:255], v[32:35]
v_mfma_f32_16x16x32_bf16 v[36:39], v[188:191], v[252:255], v[36:39]
ds_read_b128 v[248:251], v20 offset:55296
s_waitcnt lgkmcnt(4)
v_mfma_f32_16x16x32_bf16 v[24:27], v[192:195], v[232:235], v[24:27]
v_mfma_f32_16x16x32_bf16 v[28:31], v[196:199], v[232:235], v[28:31]
ds_read_b128 v[252:255], v20 offset:56320
s_waitcnt lgkmcnt(4)
v_mfma_f32_16x16x32_bf16 v[32:35], v[192:195], v[236:239], v[32:35]
v_mfma_f32_16x16x32_bf16 v[36:39], v[196:199], v[236:239], v[36:39]
ds_read_b128 v[232:235], v11 offset:16384
s_waitcnt lgkmcnt(4)
v_mfma_f32_16x16x32_bf16 v[24:27], v[200:203], v[240:243], v[24:27]
v_mfma_f32_16x16x32_bf16 v[28:31], v[204:207], v[240:243], v[28:31]
ds_read_b128 v[236:239], v11 offset:17408
s_waitcnt lgkmcnt(4)
v_mfma_f32_16x16x32_bf16 v[32:35], v[200:203], v[244:247], v[32:35]
v_mfma_f32_16x16x32_bf16 v[36:39], v[204:207], v[244:247], v[36:39]
ds_read_b128 v[240:243], v11 offset:18432
s_waitcnt lgkmcnt(4)
v_mfma_f32_16x16x32_bf16 v[24:27], v[208:211], v[248:251], v[24:27]
v_mfma_f32_16x16x32_bf16 v[28:31], v[212:215], v[248:251], v[28:31]
ds_read_b128 v[244:247], v11 offset:19456
s_waitcnt lgkmcnt(4)
v_mfma_f32_16x16x32_bf16 v[32:35], v[208:211], v[252:255], v[32:35]
v_mfma_f32_16x16x32_bf16 v[36:39], v[212:215], v[252:255], v[36:39]
ds_read_b128 v[248:251], v11 offset:20480
s_waitcnt lgkmcnt(4)
v_mfma_f32_16x16x32_bf16 v[24:27], v[104:107], v[232:235], v[24:27]
v_mfma_f32_16x16x32_bf16 v[28:31], v[108:111], v[232:235], v[28:31]
s_waitcnt vmcnt(0)
s_mov_b64 exec, 7
buffer_store_dword v4, v3, s[24:27], 0 offen sc1
s_mov_b64 exec, -1
ds_read_b128 v[252:255], v11 offset:21504
s_waitcnt lgkmcnt(4)
v_mfma_f32_16x16x32_bf16 v[32:35], v[104:107], v[236:239], v[32:35]
v_mfma_f32_16x16x32_bf16 v[36:39], v[108:111], v[236:239], v[36:39]
ds_read_b128 v[232:235], v11 offset:22528
s_waitcnt lgkmcnt(4)
v_mfma_f32_16x16x32_bf16 v[24:27], v[112:115], v[240:243], v[24:27]
v_mfma_f32_16x16x32_bf16 v[28:31], v[116:119], v[240:243], v[28:31]
ds_read_b128 v[236:239], v11 offset:23552
s_waitcnt lgkmcnt(4)
v_mfma_f32_16x16x32_bf16 v[32:35], v[112:115], v[244:247], v[32:35]
v_mfma_f32_16x16x32_bf16 v[36:39], v[116:119], v[244:247], v[36:39]
s_waitcnt lgkmcnt(3)
v_mfma_f32_16x16x32_bf16 v[24:27], v[216:219], v[248:251], v[24:27]
v_mfma_f32_16x16x32_bf16 v[28:31], v[220:223], v[248:251], v[28:31]
s_waitcnt lgkmcnt(2)
v_mfma_f32_16x16x32_bf16 v[32:35], v[216:219], v[252:255], v[32:35]
v_mfma_f32_16x16x32_bf16 v[36:39], v[220:223], v[252:255], v[36:39]
s_waitcnt lgkmcnt(1)
v_mfma_f32_16x16x32_bf16 v[24:27], v[224:227], v[232:235], v[24:27]
v_mfma_f32_16x16x32_bf16 v[28:31], v[228:231], v[232:235], v[28:31]
s_waitcnt lgkmcnt(0)
v_mfma_f32_16x16x32_bf16 v[32:35], v[224:227], v[236:239], v[32:35]
v_mfma_f32_16x16x32_bf16 v[36:39], v[228:231], v[236:239], v[36:39]
LH_p2:
s_mov_b64 exec, 0x7
buffer_load_dword v19, v21, s[24:27], 0 offen offset:0 sc1
s_waitcnt vmcnt(0)
v_cmp_ne_u32 vcc, s7, v19
s_mov_b64 exec, -1
s_cbranch_vccnz LH_p2
buffer_load_dwordx4 v[168:171], v20, s[24:27], s96 offen offset:0 sc1
buffer_load_dwordx4 v[172:175], v20, s[24:27], s96 offen offset:1024 sc1
buffer_load_dwordx4 v[184:187], v20, s[24:27], s97 offen offset:0 sc1
buffer_load_dwordx4 v[188:191], v20, s[24:27], s97 offen offset:1024 sc1
buffer_load_dwordx4 v[200:203], v20, s[24:27], s98 offen offset:0 sc1
buffer_load_dwordx4 v[204:207], v20, s[24:27], s98 offen offset:1024 sc1
v_and_b32 v2, 15, v1
v_lshlrev_b32 v2, 10, v2
v_lshrrev_b32 v3, 4, v1
v_lshl_add_u32 v2, v3, 4, v2
s_bfe_u32 s38, s2, 0x20003
s_lshl_b32 s36, s32, 17
s_lshl_b32 s37, s34, 15
s_add_u32 s36, s36, s37
s_lshl_b32 s37, s38, 8
s_add_u32 s36, s36, s37
s_lshl_b32 s37, s4, 6
s_add_u32 s36, s36, s37
s_add_u32 s37, s36, 16384
s_waitcnt vmcnt(5)
v_lshlrev_b32 v88, 16, v168
v_and_b32 v168, 0xffff0000, v168
v_add_f32 v24, v24, v88
v_add_f32 v25, v25, v168
v_lshlrev_b32 v89, 16, v169
v_and_b32 v169, 0xffff0000, v169
v_add_f32 v26, v26, v89
v_add_f32 v27, v27, v169
v_lshlrev_b32 v90, 16, v170
v_and_b32 v170, 0xffff0000, v170
v_add_f32 v28, v28, v90
v_add_f32 v29, v29, v170
v_lshlrev_b32 v91, 16, v171
v_and_b32 v171, 0xffff0000, v171
v_add_f32 v30, v30, v91
v_add_f32 v31, v31, v171
s_waitcnt vmcnt(4)
v_lshlrev_b32 v92, 16, v172
v_and_b32 v172, 0xffff0000, v172
v_add_f32 v32, v32, v92
v_add_f32 v33, v33, v172
v_lshlrev_b32 v93, 16, v173
v_and_b32 v173, 0xffff0000, v173
v_add_f32 v34, v34, v93
v_add_f32 v35, v35, v173
v_lshlrev_b32 v94, 16, v174
v_and_b32 v174, 0xffff0000, v174
v_add_f32 v36, v36, v94
v_add_f32 v37, v37, v174
v_lshlrev_b32 v95, 16, v175
v_and_b32 v175, 0xffff0000, v175
v_add_f32 v38, v38, v95
v_add_f32 v39, v39, v175
s_waitcnt vmcnt(3)
v_lshlrev_b32 v88, 16, v184
v_and_b32 v184, 0xffff0000, v184
v_add_f32 v24, v24, v88
v_add_f32 v25, v25, v184
v_lshlrev_b32 v89, 16, v185
v_and_b32 v185, 0xffff0000, v185
v_add_f32 v26, v26, v89
v_add_f32 v27, v27, v185
v_lshlrev_b32 v90, 16, v186
v_and_b32 v186, 0xffff0000, v186
v_add_f32 v28, v28, v90
v_add_f32 v29, v29, v186
v_lshlrev_b32 v91, 16, v187
v_and_b32 v187, 0xffff0000, v187
v_add_f32 v30, v30, v91
v_add_f32 v31, v31, v187
s_waitcnt vmcnt(2)
v_lshlrev_b32 v92, 16, v188
v_and_b32 v188, 0xffff0000, v188
v_add_f32 v32, v32, v92
v_add_f32 v33, v33, v188
v_lshlrev_b32 v93, 16, v189
v_and_b32 v189, 0xffff0000, v189
v_add_f32 v34, v34, v93
v_add_f32 v35, v35, v189
v_lshlrev_b32 v94, 16, v190
v_and_b32 v190, 0xffff0000, v190
v_add_f32 v36, v36, v94
v_add_f32 v37, v37, v190
v_lshlrev_b32 v95, 16, v191
v_and_b32 v191, 0xffff0000, v191
v_add_f32 v38, v38, v95
v_add_f32 v39, v39, v191
s_waitcnt vmcnt(1)
v_lshlrev_b32 v88, 16, v200
v_and_b32 v200, 0xffff0000, v200
v_add_f32 v24, v24, v88
v_add_f32 v25, v25, v200
v_lshlrev_b32 v89, 16, v201
v_and_b32 v201, 0xffff0000, v201
v_add_f32 v26, v26, v89
v_add_f32 v27, v27, v201
v_lshlrev_b32 v90, 16, v202
v_and_b32 v202, 0xffff0000, v202
v_add_f32 v28, v28, v90
v_add_f32 v29, v29, v202
v_lshlrev_b32 v91, 16, v203
v_and_b32 v203, 0xffff0000, v203
v_add_f32 v30, v30, v91
v_add_f32 v31, v31, v203
s_waitcnt vmcnt(0)
v_lshlrev_b32 v92, 16, v204
v_and_b32 v204, 0xffff0000, v204
v_add_f32 v32, v32, v92
v_add_f32 v33, v33, v204
v_lshlrev_b32 v93, 16, v205
v_and_b32 v205, 0xffff0000, v205
v_add_f32 v34, v34, v93
v_add_f32 v35, v35, v205
v_lshlrev_b32 v94, 16, v206
v_and_b32 v206, 0xffff0000, v206
v_add_f32 v36, v36, v94
v_add_f32 v37, v37, v206
v_lshlrev_b32 v95, 16, v207
v_and_b32 v207, 0xffff0000, v207
v_add_f32 v38, v38, v95
v_add_f32 v39, v39, v207
v_cvt_pk_bf16_f32 v232, v24, v25
v_cvt_pk_bf16_f32 v233, v26, v27
v_cvt_pk_bf16_f32 v234, v28, v29
v_cvt_pk_bf16_f32 v235, v30, v31
v_cvt_pk_bf16_f32 v236, v32, v33
v_cvt_pk_bf16_f32 v237, v34, v35
v_cvt_pk_bf16_f32 v238, v36, v37
v_cvt_pk_bf16_f32 v239, v38, v39
v_permlane32_swap_b32 v232, v234
v_permlane32_swap_b32 v233, v235
s_nop 0
v_permlane16_swap_b32 v232, v234
v_permlane16_swap_b32 v233, v235
v_permlane32_swap_b32 v236, v238
v_permlane32_swap_b32 v237, v239
s_nop 0
v_permlane16_swap_b32 v236, v238
v_permlane16_swap_b32 v237, v239
buffer_store_dwordx4 v[232:235], v2, s[76:79], s36 offen
buffer_store_dwordx4 v[236:239], v2, s[76:79], s37 offen
L_end:
s_endpgm
L_code_end:
.section .rodata,"a"
.p2align 6
.amdhsa_kernel standalone__mha_block_cached__near_ridge_kernel
  .amdhsa_next_free_vgpr 256
  .amdhsa_next_free_sgpr 102
  .amdhsa_accum_offset 256
  .amdhsa_group_segment_fixed_size 0
  .amdhsa_kernarg_size 64
  .amdhsa_user_sgpr_count 2
  .amdhsa_user_sgpr_kernarg_segment_ptr 1
  .amdhsa_system_sgpr_workgroup_id_x 1
  .amdhsa_float_denorm_mode_32 3
.end_amdhsa_kernel
```
